```python
import torch

def _softmax(x, axis=-1):
    return torch.softmax(x, dim=axis)

def _gelu(x):
    return torch.nn.functional.gelu(x, approximate='tanh')

def _silu(x):
    return torch.nn.functional.silu(x)

def _sigmoid(x):
    return torch.sigmoid(x)

def _layernorm(x, axis=-1, eps=1e-05):
    m = x.mean(dim=axis, keepdim=True)
    v = x.var(dim=axis, keepdim=True, unbiased=False)
    return (x - m) / torch.sqrt(v + eps)

def _scatter_add(tgt, idx, src, axis=0):
    return tgt.clone().index_add_(axis, idx, src)

def _segment_sum(src, seg, n):
    out = torch.zeros((n,) + src.shape[1:], dtype=src.dtype)
    return out.index_add_(0, seg, src)

def _pad(x, pw):
    flat = tuple((v for pair in reversed(pw) for v in pair))
    return torch.nn.functional.pad(x, flat)
kernel_name = 'adaLN_cond__mha_block__mixer_gmlp__prompt'

def setup_inputs():

    _w = lambda a: (lambda t: t.to(torch.bfloat16) if t.is_floating_point() else t)(torch.as_tensor(a))

    def _A_setup():
        B, S, D, H = (1, 2048, 1024, 32)
        return {'x': _w((lambda *s: torch.randn(*s, dtype=torch.bfloat16) * 0.05)(B, S, D)), 'wqkv': _w((lambda *s: torch.randn(*s, dtype=torch.bfloat16) * 0.05)(D, 3 * D)), 'wo': _w((lambda *s: torch.randn(*s, dtype=torch.bfloat16) * 0.05)(D, D))}
    _A_in = _A_setup()

    def _B_setup():
        B, S, D, F = (1, 2048, 1024, 3584)
        Fh = F // 2
        return {'x': _w((lambda *s: torch.randn(*s, dtype=torch.bfloat16) * 0.05)(B, S, D)), 'w_in': _w((lambda *s: torch.randn(*s, dtype=torch.bfloat16) * 0.8)(D, 2 * Fh)), 'w_sp': _w(0.01 * (lambda *s: torch.randn(*s, dtype=torch.bfloat16) * 0.8)(S, S)), 'b_sp': _w(1.0 + 0.01 * (lambda *s: torch.randn(*s, dtype=torch.bfloat16) * 0.05)(S)), 'w_out': _w((lambda *s: torch.randn(*s, dtype=torch.bfloat16) * 0.05)(Fh, D))}
    _B_in = _B_setup()
    return {'A_x': _A_in['x'], 'A_wqkv': _A_in['wqkv'], 'A_wo': _A_in['wo'], 'B_x': _B_in['x'], 'B_w_in': _B_in['w_in'], 'B_w_sp': _B_in['w_sp'], 'B_b_sp': _B_in['b_sp'], 'B_w_out': _B_in['w_out'], 'c': _w((lambda *s: torch.randn(*s, dtype=torch.bfloat16) * 0.2)(1, 1024) * 8.0), 'w_mod': _w((lambda *s: torch.randn(*s, dtype=torch.bfloat16) * 0.2)(1024, 6 * 1024) * 1024 ** (-0.5) * 8.0)}

def reference(A_x, A_wqkv, A_wo, B_x, B_w_in, B_w_sp, B_b_sp, B_w_out, c, w_mod):

    def _A_ref(x, wqkv, wo):
        B, S, D = x.shape
        H = 32
        Dh = D // H
        qkv = (lambda x, *d: x.permute(*d))((x @ wqkv).reshape(B, S, 3, H, Dh), 2, 0, 3, 1, 4)
        q, k, v = (qkv[0], qkv[1], qkv[2])
        scores = torch.einsum('bhqd,bhkd->bhqk', q, k) * Dh ** (-0.5)
        p = _softmax(scores, axis=-1)
        o = torch.einsum('bhqk,bhkd->bhqd', p, v)
        return (lambda x, *d: x.permute(*d))(o, 0, 2, 1, 3).reshape(B, S, D) @ wo

    def _B_ref(x, w_in, w_sp, b_sp, w_out):
        B, S, D = x.shape
        F = w_in.shape[-1]
        Fh = F // 2
        z = _gelu(torch.einsum('bsd,df->bsf', x, w_in))
        z1 = z[..., :Fh].clone()
        z2 = _layernorm(z[..., Fh:], axis=-1)
        g = torch.einsum('ts,bsf->btf', w_sp, z2) + b_sp[None, :, None]
        return torch.einsum('bsf,fd->bsd', z1 * g, w_out)
    x = A_x
    mod = (_silu(c) @ w_mod).reshape(c.shape[0], 6, 1, -1)
    sa, ca, ga, sb, cb, gb = (mod[:, 0].clone(), mod[:, 1].clone(), mod[:, 2].clone(), mod[:, 3].clone(), mod[:, 4].clone(), mod[:, 5].clone())
    h = _layernorm(x, axis=-1) * (1 + ca) + sa
    x = x + ga * _A_ref(h, A_wqkv, A_wo)
    h = _layernorm(x, axis=-1) * (1 + cb) + sb
    x = x + gb * _B_ref(h, B_w_in, B_w_sp, B_b_sp, B_w_out)
    return x
```

```asm
; @launch grid=(256,1,1) block=(512,1,1) lds=163840
.amdgcn_target "amdgcn-amd-amdhsa--gfx950"
.text
.globl adaLN_cond__mha_block__mixer_gmlp__prompt_kernel
.p2align 8
.type adaLN_cond__mha_block__mixer_gmlp__prompt_kernel,@function
adaLN_cond__mha_block__mixer_gmlp__prompt_kernel:
    s_cmp_ge_u32 s2, 256
    s_cbranch_scc0 adaLN_cond__mha_block__mixer_gmlp__prompt_kernel_go
    s_endpgm
adaLN_cond__mha_block__mixer_gmlp__prompt_kernel_go:
    s_load_dwordx16 s[76:91], s[0:1], 0
    s_load_dwordx4 s[28:31], s[0:1], 64
    s_load_dwordx4 s[32:35], s[0:1], 80
    s_load_dwordx2 s[36:37], s[0:1], 96
    v_lshrrev_b32 v1, 6, v0
    s_nop 0
    v_readfirstlane_b32 s100, v1
    v_and_b32 v1, 63, v0
    s_and_b32 s4, s2, 15
    s_lshr_b32 s5, s2, 4
    s_lshl_b32 s6, s5, 3
    s_add_u32 s6, s6, s100
    s_lshl_b32 s22, s4, 7
    s_add_u32 s22, s22, s6
    s_lshl_b32 s6, s6, 3
    s_mul_i32 s20, s6, 12288
    s_lshl_b32 s21, s4, 8
    s_add_u32 s20, s20, s21
    v_lshrrev_b32 v3, 5, v1
    v_mul_u32_u24 v4, 12288, v3
    v_and_b32 v5, 31, v1
    v_lshl_add_u32 v4, v5, 3, v4
    v_lshlrev_b32 v5, 1, v3
    s_lshl_b32 s7, s6, 1
    v_lshlrev_b32 v2, 4, v1
    s_lshl_b32 s26, s22, 11
    s_waitcnt lgkmcnt(0)
    s_mov_b32 s12, s30
    s_mov_b32 s13, s31
    s_mov_b32 s14, 12582912
    s_mov_b32 s15, 0x20000
    buffer_load_dwordx2 v[16:17], v4, s[12:15], s20 offen nt
    s_add_u32 s20, s20, 24576
    buffer_load_dwordx2 v[18:19], v4, s[12:15], s20 offen nt
    s_add_u32 s20, s20, 24576
    buffer_load_dwordx2 v[20:21], v4, s[12:15], s20 offen nt
    s_add_u32 s20, s20, 24576
    buffer_load_dwordx2 v[22:23], v4, s[12:15], s20 offen nt
    s_mov_b32 s40, s76
    s_mov_b32 s41, s77
    s_mov_b32 s42, 4194304
    s_mov_b32 s43, 0x20000
    s_mov_b32 s8, s28
    s_mov_b32 s9, s29
    s_mov_b32 s10, 2048
    s_mov_b32 s11, 0x20000
    buffer_load_dwordx4 v[8:11], v2, s[40:43], s26 offen
    buffer_load_dwordx4 v[12:15], v2, s[40:43], s26 offen offset:1024
    buffer_load_ushort v24, v5, s[8:11], s7 offen offset:0
    buffer_load_ushort v25, v5, s[8:11], s7 offen offset:4
    buffer_load_ushort v26, v5, s[8:11], s7 offen offset:8
    buffer_load_ushort v27, v5, s[8:11], s7 offen offset:12
    s_mov_b32 s44, s34
    s_mov_b32 s45, s35
    s_mov_b32 s46, 256
    s_mov_b32 s47, 0x20000
    v_mov_b32 v48, 0
    s_or_b32 s20, s2, s100
    s_cbranch_scc1 adaLN_cond__mha_block__mixer_gmlp__prompt_kernel_k_nn
    s_memrealtime s[20:21]
    s_waitcnt lgkmcnt(0)
    s_or_b32 s20, s20, 0x80000000
    v_mov_b32 v52, s20
    s_mov_b64 exec, 1
    buffer_store_dword v52, v48, s[44:47], 0 offen sc1
    s_mov_b64 exec, -1
    s_waitcnt vmcnt(0)
adaLN_cond__mha_block__mixer_gmlp__prompt_kernel_k_nn:
    s_mov_b32 s16, s36
    s_mov_b32 s17, s37
    s_mov_b32 s18, 1048576
    s_mov_b32 s19, 0x20000
    s_add_u32 s96, s36, 71303168
    s_addc_u32 s97, s37, 0
    s_mov_b32 s98, 557056
    s_mov_b32 s99, 0x20000
    s_lshl_b32 s25, s2, 3
    s_add_u32 s25, s25, s100
    v_lshlrev_b32 v49, 2, v1
    s_lshl_b32 s23, s25, 6
    s_add_u32 s24, s23, 65536
    s_sub_u32 s23, s23, 73728
    s_cmp_lt_u32 s25, 1280
    s_cselect_b32 s23, s24, s23
    s_cmp_lt_u32 s25, 1536
    s_cselect_b32 s23, s23, 1048576
    s_bfm_b64 exec, 16, 0
    buffer_store_dword v48, v49, s[16:19], s23 offen sc1
    s_mov_b64 exec, -1
    s_mov_b32 s48, s78
    s_mov_b32 s49, s79
    s_mov_b32 s50, 6291456
    s_mov_b32 s51, 0x20000
    v_lshlrev_b32 v53, 7, v1
    s_lshl_b32 s23, s2, 2
    s_add_u32 s23, s23, s100
    s_sub_u32 s23, s23, 4
    s_mul_i32 s23, s23, 6144
    s_waitcnt vmcnt(1)
    buffer_load_dword v52, v48, s[44:47], 0 offen sc1
    s_cmp_ge_u32 s100, 4
    s_cbranch_scc0 adaLN_cond__mha_block__mixer_gmlp__prompt_kernel_k_nt
    s_bfm_b64 exec, 48, 0
    buffer_load_dword v54, v53, s[48:51], s23 offen
    s_mov_b64 exec, -1
    s_sub_u32 s23, s100, 4
    s_getpc_b64 s[20:21]
adaLN_cond__mha_block__mixer_gmlp__prompt_kernel_k_pc:
    s_add_u32 s20, s20, adaLN_cond__mha_block__mixer_gmlp__prompt_kernel_k_nt - adaLN_cond__mha_block__mixer_gmlp__prompt_kernel_k_pc
    s_addc_u32 s21, s21, 0
    s_mov_b32 s25, code_end - adaLN_cond__mha_block__mixer_gmlp__prompt_kernel_k_nt - 4
    s_mul_i32 s24, s23, 16384
    v_lshlrev_b32 v55, 7, v1
    v_add_u32 v55, s24, v55
    v_min_u32 v60, s25, v55
    global_load_dword v54, v60, s[20:21]
    v_add_u32 v55, 8192, v55
    v_min_u32 v60, s25, v55
    global_load_dword v54, v60, s[20:21]
adaLN_cond__mha_block__mixer_gmlp__prompt_kernel_k_nt:
    v_lshlrev_b32 v24, 16, v24
    v_mul_f32 v50, 0xbfb8aa3b, v24
    v_exp_f32 v50, v50
    s_nop 0
    v_add_f32 v50, 1.0, v50
    v_rcp_f32 v50, v50
    s_nop 0
    v_mul_f32 v24, v24, v50
    v_cvt_pk_bf16_f32 v24, v24, v24
    v_and_b32 v24, 0xffff0000, v24
    v_lshlrev_b32 v25, 16, v25
    v_mul_f32 v50, 0xbfb8aa3b, v25
    v_exp_f32 v50, v50
    s_nop 0
    v_add_f32 v50, 1.0, v50
    v_rcp_f32 v50, v50
    s_nop 0
    v_mul_f32 v25, v25, v50
    v_cvt_pk_bf16_f32 v25, v25, v25
    v_and_b32 v25, 0xffff0000, v25
    v_lshlrev_b32 v26, 16, v26
    v_mul_f32 v50, 0xbfb8aa3b, v26
    v_exp_f32 v50, v50
    s_nop 0
    v_add_f32 v50, 1.0, v50
    v_rcp_f32 v50, v50
    s_nop 0
    v_mul_f32 v26, v26, v50
    v_cvt_pk_bf16_f32 v26, v26, v26
    v_and_b32 v26, 0xffff0000, v26
    v_lshlrev_b32 v27, 16, v27
    v_mul_f32 v50, 0xbfb8aa3b, v27
    v_exp_f32 v50, v50
    s_nop 0
    v_add_f32 v50, 1.0, v50
    v_rcp_f32 v50, v50
    s_nop 0
    v_mul_f32 v27, v27, v50
    v_cvt_pk_bf16_f32 v27, v27, v27
    v_and_b32 v27, 0xffff0000, v27
    v_mov_b32 v56, 0
    v_mov_b32 v57, 0
    v_mov_b32 v58, 0
    v_mov_b32 v59, 0
    v_lshlrev_b32 v50, 16, v16
    v_and_b32 v51, 0xffff0000, v16
    v_fmac_f32 v56, v24, v50
    v_fmac_f32 v57, v24, v51
    v_lshlrev_b32 v50, 16, v17
    v_and_b32 v51, 0xffff0000, v17
    v_fmac_f32 v58, v24, v50
    v_fmac_f32 v59, v24, v51
    v_lshlrev_b32 v50, 16, v18
    v_and_b32 v51, 0xffff0000, v18
    v_fmac_f32 v56, v25, v50
    v_fmac_f32 v57, v25, v51
    v_lshlrev_b32 v50, 16, v19
    v_and_b32 v51, 0xffff0000, v19
    v_fmac_f32 v58, v25, v50
    v_fmac_f32 v59, v25, v51
    v_lshlrev_b32 v50, 16, v20
    v_and_b32 v51, 0xffff0000, v20
    v_fmac_f32 v56, v26, v50
    v_fmac_f32 v57, v26, v51
    v_lshlrev_b32 v50, 16, v21
    v_and_b32 v51, 0xffff0000, v21
    v_fmac_f32 v58, v26, v50
    v_fmac_f32 v59, v26, v51
    v_lshlrev_b32 v50, 16, v22
    v_and_b32 v51, 0xffff0000, v22
    v_fmac_f32 v56, v27, v50
    v_fmac_f32 v57, v27, v51
    v_lshlrev_b32 v50, 16, v23
    v_and_b32 v51, 0xffff0000, v23
    v_fmac_f32 v58, v27, v50
    v_fmac_f32 v59, v27, v51
    s_lshl_b32 s21, s100, 10
    s_add_u32 s21, s21, 124928
    v_add_u32 v4, s21, v2
    ds_write_b128 v4, v[56:59]
    v_lshlrev_b32 v16, 16, v8
    v_and_b32 v17, 0xffff0000, v8
    v_lshlrev_b32 v18, 16, v9
    v_and_b32 v19, 0xffff0000, v9
    v_lshlrev_b32 v20, 16, v10
    v_and_b32 v21, 0xffff0000, v10
    v_lshlrev_b32 v22, 16, v11
    v_and_b32 v23, 0xffff0000, v11
    v_lshlrev_b32 v24, 16, v12
    v_and_b32 v25, 0xffff0000, v12
    v_lshlrev_b32 v26, 16, v13
    v_and_b32 v27, 0xffff0000, v13
    v_lshlrev_b32 v28, 16, v14
    v_and_b32 v29, 0xffff0000, v14
    v_lshlrev_b32 v30, 16, v15
    v_and_b32 v31, 0xffff0000, v15
    v_add_f32 v4, v16, v17
    v_add_f32 v4, v4, v18
    v_add_f32 v4, v4, v19
    v_add_f32 v4, v4, v20
    v_add_f32 v4, v4, v21
    v_add_f32 v4, v4, v22
    v_add_f32 v4, v4, v23
    v_add_f32 v4, v4, v24
    v_add_f32 v4, v4, v25
    v_add_f32 v4, v4, v26
    v_add_f32 v4, v4, v27
    v_add_f32 v4, v4, v28
    v_add_f32 v4, v4, v29
    v_add_f32 v4, v4, v30
    v_add_f32 v4, v4, v31
    s_nop 1
    v_add_f32_dpp v4, v4, v4 quad_perm:[1,0,3,2] row_mask:0xf bank_mask:0xf
    s_nop 1
    v_add_f32_dpp v4, v4, v4 quad_perm:[2,3,0,1] row_mask:0xf bank_mask:0xf
    s_nop 1
    v_add_f32_dpp v4, v4, v4 row_half_mirror row_mask:0xf bank_mask:0xf
    s_nop 1
    v_add_f32_dpp v4, v4, v4 row_mirror row_mask:0xf bank_mask:0xf
    s_nop 0
    v_mov_b32 v5, v4
    s_nop 1
    v_permlane16_swap_b32 v4, v5
    s_nop 0
    v_add_f32 v4, v4, v5
    v_mov_b32 v5, v4
    s_nop 1
    v_permlane32_swap_b32 v4, v5
    s_nop 0
    v_add_f32 v4, v4, v5
    v_mul_f32 v4, 0x3a800000, v4
    v_sub_f32 v16, v16, v4
    v_sub_f32 v17, v17, v4
    v_sub_f32 v18, v18, v4
    v_sub_f32 v19, v19, v4
    v_sub_f32 v20, v20, v4
    v_sub_f32 v21, v21, v4
    v_sub_f32 v22, v22, v4
    v_sub_f32 v23, v23, v4
    v_sub_f32 v24, v24, v4
    v_sub_f32 v25, v25, v4
    v_sub_f32 v26, v26, v4
    v_sub_f32 v27, v27, v4
    v_sub_f32 v28, v28, v4
    v_sub_f32 v29, v29, v4
    v_sub_f32 v30, v30, v4
    v_sub_f32 v31, v31, v4
    v_mul_f32 v8, v16, v16
    v_fmac_f32 v8, v17, v17
    v_fmac_f32 v8, v18, v18
    v_fmac_f32 v8, v19, v19
    v_fmac_f32 v8, v20, v20
    v_fmac_f32 v8, v21, v21
    v_fmac_f32 v8, v22, v22
    v_fmac_f32 v8, v23, v23
    v_fmac_f32 v8, v24, v24
    v_fmac_f32 v8, v25, v25
    v_fmac_f32 v8, v26, v26
    v_fmac_f32 v8, v27, v27
    v_fmac_f32 v8, v28, v28
    v_fmac_f32 v8, v29, v29
    v_fmac_f32 v8, v30, v30
    v_fmac_f32 v8, v31, v31
    s_nop 1
    v_add_f32_dpp v8, v8, v8 quad_perm:[1,0,3,2] row_mask:0xf bank_mask:0xf
    s_nop 1
    v_add_f32_dpp v8, v8, v8 quad_perm:[2,3,0,1] row_mask:0xf bank_mask:0xf
    s_nop 1
    v_add_f32_dpp v8, v8, v8 row_half_mirror row_mask:0xf bank_mask:0xf
    s_nop 1
    v_add_f32_dpp v8, v8, v8 row_mirror row_mask:0xf bank_mask:0xf
    s_nop 0
    v_mov_b32 v5, v8
    s_nop 1
    v_permlane16_swap_b32 v8, v5
    s_nop 0
    v_add_f32 v8, v8, v5
    v_mov_b32 v5, v8
    s_nop 1
    v_permlane32_swap_b32 v8, v5
    s_nop 0
    v_add_f32 v8, v8, v5
    v_mov_b32 v5, 0x3727c5ac
    v_fmac_f32 v5, 0x3a800000, v8
    v_rsq_f32 v8, v5
    s_nop 0
    v_mul_f32_e64 v9, -v4, v8
    s_lshl_b32 s21, s100, 3
    s_add_u32 s21, s21, 133120
    v_mov_b32 v10, s21
    ds_write_b64 v10, v[8:9]
    s_waitcnt lgkmcnt(0)
    s_barrier
    s_cmp_ge_u32 s100, 3
    s_cbranch_scc1 adaLN_cond__mha_block__mixer_gmlp__prompt_kernel_k_f2
    s_cmp_eq_u32 s100, 2
    s_cbranch_scc1 adaLN_cond__mha_block__mixer_gmlp__prompt_kernel_k_f1
    v_lshlrev_b32 v6, 2, v0
    v_add_u32 v7, 124928, v6
    ds_read_b32 v8, v7 offset:0
    ds_read_b32 v9, v7 offset:512
    ds_read_b32 v10, v7 offset:1024
    ds_read_b32 v11, v7 offset:1536
    ds_read_b32 v12, v7 offset:2048
    ds_read_b32 v13, v7 offset:2560
    ds_read_b32 v14, v7 offset:3072
    ds_read_b32 v15, v7 offset:3584
    ds_read_b32 v16, v7 offset:4096
    ds_read_b32 v17, v7 offset:4608
    ds_read_b32 v18, v7 offset:5120
    ds_read_b32 v19, v7 offset:5632
    ds_read_b32 v20, v7 offset:6144
    ds_read_b32 v21, v7 offset:6656
    ds_read_b32 v22, v7 offset:7168
    ds_read_b32 v23, v7 offset:7680
    s_lshl_b32 s21, s5, 13
    s_lshl_b32 s20, s4, 9
    s_add_u32 s21, s21, s20
    s_add_u32 s21, s21, 262144
    s_waitcnt lgkmcnt(0)
    v_add_f32 v8, v8, v9
    v_add_f32 v8, v8, v10
    v_add_f32 v8, v8, v11
    v_add_f32 v8, v8, v12
    v_add_f32 v8, v8, v13
    v_add_f32 v8, v8, v14
    v_add_f32 v8, v8, v15
    v_add_f32 v8, v8, v16
    v_add_f32 v8, v8, v17
    v_add_f32 v8, v8, v18
    v_add_f32 v8, v8, v19
    v_add_f32 v8, v8, v20
    v_add_f32 v8, v8, v21
    v_add_f32 v8, v8, v22
    v_add_f32 v8, v8, v23
    buffer_store_dword v8, v6, s[16:19], s21 offen sc1
    s_branch adaLN_cond__mha_block__mixer_gmlp__prompt_kernel_k_f2
adaLN_cond__mha_block__mixer_gmlp__prompt_kernel_k_f1:
    v_add_u32 v7, 133120, v49
    ds_read_b32 v8, v7
    s_sub_u32 s23, s22, 2
    s_lshl_b32 s23, s23, 3
    s_add_u32 s23, s23, 229376
    s_bfm_b64 exec, 16, 0
    s_waitcnt lgkmcnt(0)
    buffer_store_dword v8, v49, s[16:19], s23 offen sc1
    s_mov_b64 exec, -1
adaLN_cond__mha_block__mixer_gmlp__prompt_kernel_k_f2:
    s_mov_b32 s19, 0x80000
    s_cmp_ge_u32 s100, 4
    s_cbranch_scc0 adaLN_cond__mha_block__mixer_gmlp__prompt_kernel_k_nw
    s_waitcnt vmcnt(3)
    s_branch adaLN_cond__mha_block__mixer_gmlp__prompt_kernel_k_nc
adaLN_cond__mha_block__mixer_gmlp__prompt_kernel_k_nl:
    buffer_load_dword v52, v48, s[44:47], 0 offen sc1
adaLN_cond__mha_block__mixer_gmlp__prompt_kernel_k_nw:
    s_waitcnt vmcnt(0)
adaLN_cond__mha_block__mixer_gmlp__prompt_kernel_k_nc:
    v_readfirstlane_b32 s101, v52
    s_sub_u32 s19, s19, 1
    s_cmp_eq_u32 s19, 0
    s_cbranch_scc1 adaLN_cond__mha_block__mixer_gmlp__prompt_kernel_k_nd
    s_cmp_eq_u32 s101, 0
    s_cbranch_scc1 adaLN_cond__mha_block__mixer_gmlp__prompt_kernel_k_nl
adaLN_cond__mha_block__mixer_gmlp__prompt_kernel_k_nd:
    s_barrier
    s_cmp_eq_u32 s100, 0
    s_cbranch_scc0 adaLN_cond__mha_block__mixer_gmlp__prompt_kernel_k_ns
    s_mov_b32 s21, s5
    s_add_u32 s20, s4, 112
    s_mul_i32 s20, s20, 4352
    s_lshl_b32 s21, s21, 7
    s_add_u32 s20, s20, s21
    v_mov_b32 v2, s101
    v_mov_b32 v3, 0
    s_mov_b64 exec, 1
    buffer_store_dword v2, v3, s[96:99], s20 offen sc1
    s_mov_b64 exec, -1
adaLN_cond__mha_block__mixer_gmlp__prompt_kernel_k_ns:
    s_mov_b32 s92, s32
    s_mov_b32 s93, s33
    s_and_b32 s3, s100, 3
    s_cmp_ge_u32 s100, 4
    s_cbranch_scc0 adaLN_cond__mha_block__mixer_gmlp__prompt_kernel_comp
    s_and_b32 s20, s2, 7
    s_lshr_b32 s21, s2, 3
    s_and_b32 s4, s20, 1
    s_lshl_b32 s4, s4, 3
    s_and_b32 s22, s21, 7
    s_add_u32 s4, s4, s22
    s_lshr_b32 s5, s20, 1
    s_mul_i32 s5, s5, 4
    s_lshr_b32 s22, s21, 3
    s_add_u32 s5, s5, s22
    s_setprio 0
    s_add_u32 s8, s36, 2097152
    s_addc_u32 s9, s37, 0
    s_mov_b32 s10, 4194304
    s_mov_b32 s11, 0x20000
    s_mov_b32 s12, s78
    s_mov_b32 s13, s79
    s_mov_b32 s14, 6291456
    s_mov_b32 s15, 0x20000
    v_and_b32 v1, 63, v0
    s_mul_i32 s20, s4, 8
    s_lshr_b32 s21, s3, 1
    s_add_u32 s20, s20, s21
    s_mul_i32 s20, s20, 32768
    s_and_b32 s21, s3, 1
    s_lshl_b32 s21, s21, 10
    s_add_u32 s20, s20, s21
    v_lshlrev_b32 v2, 4, v1
    v_add_u32 v8, s20, v2
    v_add_u32 v9, 65536, v8
    v_add_u32 v10, 131072, v8
    v_add_u32 v11, 196608, v8
    v_bfe_u32 v2, v1, 4, 1
    s_and_b32 s21, s3, 1
    s_lshl_b32 s21, s21, 1
    v_or_b32 v2, s21, v2
    v_bfe_u32 v3, v1, 1, 2
    v_xor_b32 v2, v2, v3
    v_lshlrev_b32 v2, 5, v2
    v_and_b32 v3, 1, v1
    v_lshl_add_u32 v2, v3, 4, v2
    v_lshrrev_b32 v3, 3, v1
    s_lshl_b32 s21, s3, 3
    v_add_u32 v3, s21, v3
    s_mov_b32 s21, 6144
    v_mul_lo_u32 v3, v3, s21
    v_add_u32 v2, v2, v3
    s_add_u32 s20, s5, 0
    s_and_b32 s20, s20, 15
    s_lshl_b32 s20, s20, 7
    s_add_u32 s20, s20, 0
    v_add_u32 v12, s20, v2
    v_add_u32 v13, 196608, v12
    s_add_u32 s20, s5, 0
    s_and_b32 s20, s20, 15
    s_lshl_b32 s20, s20, 7
    s_add_u32 s20, s20, 2048
    v_add_u32 v14, s20, v2
    v_add_u32 v15, 196608, v14
    s_add_u32 s20, s5, 0
    s_and_b32 s20, s20, 15
    s_lshl_b32 s20, s20, 7
    s_add_u32 s20, s20, 4096
    v_add_u32 v16, s20, v2
    v_add_u32 v17, 196608, v16
    s_mov_b32 s16, 0
    s_mov_b32 s17, 0
    s_lshl_b32 s18, s3, 10
    s_add_u32 s23, s18, 122880
    s_add_u32 s22, s18, 0
    s_add_u32 m0, s22, 16384
    s_nop 0
    buffer_load_dwordx4 v12, s[12:15], s17 offen lds
    s_add_u32 m0, s22, 20480
    s_nop 0
    buffer_load_dwordx4 v13, s[12:15], s17 offen lds
    s_add_u32 m0, s22, 24576
    s_nop 0
    buffer_load_dwordx4 v14, s[12:15], s17 offen lds
    s_add_u32 m0, s22, 28672
    s_nop 0
    buffer_load_dwordx4 v15, s[12:15], s17 offen lds
    s_add_u32 m0, s22, 32768
    s_nop 0
    buffer_load_dwordx4 v16, s[12:15], s17 offen lds
    s_add_u32 m0, s22, 36864
    s_nop 0
    buffer_load_dwordx4 v17, s[12:15], s17 offen lds
    s_add_u32 s17, s17, 393216
    s_barrier
    s_mov_b32 s40, s30
    s_mov_b32 s41, s31
    s_mov_b32 s42, 12582912
    s_mov_b32 s43, 0x20000
    s_mov_b32 s44, s28
    s_mov_b32 s45, s29
    s_mov_b32 s46, 2048
    s_mov_b32 s47, 0x20000
    s_mov_b32 s48, s36
    s_mov_b32 s49, s37
    s_mov_b32 s50, 24576
    s_mov_b32 s51, 0x20000
    s_lshl_b32 s20, s4, 2
    s_add_u32 s20, s20, s3
    s_lshl_b32 s20, s20, 4
    s_lshl_b32 s21, s20, 1
    v_and_b32 v2, 15, v1
    v_lshlrev_b32 v3, 1, v2
    buffer_load_ushort v61, v3, s[44:47], s21 offen
    s_mul_i32 s20, s20, 12288
    s_lshl_b32 s21, s5, 7
    s_add_u32 s20, s20, s21
    s_add_u32 s20, s20, 4096
    v_lshrrev_b32 v3, 4, v1
    v_lshlrev_b32 v62, 11, v3
    v_lshl_add_u32 v62, v2, 3, v62
    buffer_load_dwordx2 v[64:65], v62, s[40:43], s20 offen nt
    s_add_u32 s20, s20, 12288
    buffer_load_dwordx2 v[66:67], v62, s[40:43], s20 offen nt
    s_add_u32 s20, s20, 12288
    buffer_load_dwordx2 v[68:69], v62, s[40:43], s20 offen nt
    s_add_u32 s20, s20, 12288
    buffer_load_dwordx2 v[70:71], v62, s[40:43], s20 offen nt
    s_add_u32 s20, s20, 12288
    buffer_load_dwordx2 v[72:73], v62, s[40:43], s20 offen nt
    s_add_u32 s20, s20, 12288
    buffer_load_dwordx2 v[74:75], v62, s[40:43], s20 offen nt
    s_add_u32 s20, s20, 12288
    buffer_load_dwordx2 v[76:77], v62, s[40:43], s20 offen nt
    s_add_u32 s20, s20, 12288
    buffer_load_dwordx2 v[78:79], v62, s[40:43], s20 offen nt
    s_add_u32 s20, s20, 12288
    buffer_load_dwordx2 v[80:81], v62, s[40:43], s20 offen nt
    s_add_u32 s20, s20, 12288
    buffer_load_dwordx2 v[82:83], v62, s[40:43], s20 offen nt
    s_add_u32 s20, s20, 12288
    buffer_load_dwordx2 v[84:85], v62, s[40:43], s20 offen nt
    s_add_u32 s20, s20, 12288
    buffer_load_dwordx2 v[86:87], v62, s[40:43], s20 offen nt
    s_add_u32 s20, s20, 12288
    buffer_load_dwordx2 v[88:89], v62, s[40:43], s20 offen nt
    s_add_u32 s20, s20, 12288
    buffer_load_dwordx2 v[90:91], v62, s[40:43], s20 offen nt
    s_add_u32 s20, s20, 12288
    buffer_load_dwordx2 v[92:93], v62, s[40:43], s20 offen nt
    s_add_u32 s20, s20, 12288
    buffer_load_dwordx2 v[94:95], v62, s[40:43], s20 offen nt
    s_barrier
    s_barrier
    s_add_u32 s22, s18, 40960
    s_add_u32 m0, s22, 16384
    s_nop 0
    buffer_load_dwordx4 v12, s[12:15], s17 offen lds
    s_add_u32 m0, s22, 20480
    s_nop 0
    buffer_load_dwordx4 v13, s[12:15], s17 offen lds
    s_add_u32 m0, s22, 24576
    s_nop 0
    buffer_load_dwordx4 v14, s[12:15], s17 offen lds
    s_add_u32 m0, s22, 28672
    s_nop 0
    buffer_load_dwordx4 v15, s[12:15], s17 offen lds
    s_add_u32 m0, s22, 32768
    s_nop 0
    buffer_load_dwordx4 v16, s[12:15], s17 offen lds
    s_add_u32 m0, s22, 36864
    s_nop 0
    buffer_load_dwordx4 v17, s[12:15], s17 offen lds
    s_add_u32 s17, s17, 393216
    s_add_u32 s22, s18, 81920
    s_add_u32 m0, s22, 16384
    s_nop 0
    buffer_load_dwordx4 v12, s[12:15], s17 offen lds
    s_add_u32 m0, s22, 20480
    s_nop 0
    buffer_load_dwordx4 v13, s[12:15], s17 offen lds
    s_add_u32 m0, s22, 24576
    s_nop 0
    buffer_load_dwordx4 v14, s[12:15], s17 offen lds
    s_add_u32 m0, s22, 28672
    s_nop 0
    buffer_load_dwordx4 v15, s[12:15], s17 offen lds
    s_add_u32 m0, s22, 32768
    s_nop 0
    buffer_load_dwordx4 v16, s[12:15], s17 offen lds
    s_add_u32 m0, s22, 36864
    s_nop 0
    buffer_load_dwordx4 v17, s[12:15], s17 offen lds
    s_add_u32 s17, s17, 393216
    s_barrier
    s_add_u32 s22, s18, 0
    s_add_u32 m0, s22, 0
    s_nop 0
    buffer_load_dwordx4 v8, s[8:11], s16 offen sc1 lds
    s_add_u32 m0, s22, 4096
    s_nop 0
    buffer_load_dwordx4 v9, s[8:11], s16 offen sc1 lds
    s_add_u32 m0, s22, 8192
    s_nop 0
    buffer_load_dwordx4 v10, s[8:11], s16 offen sc1 lds
    s_add_u32 m0, s22, 12288
    s_nop 0
    buffer_load_dwordx4 v11, s[8:11], s16 offen sc1 lds
    s_add_u32 s16, s16, 2048
    s_add_u32 s22, s18, 40960
    s_add_u32 m0, s22, 0
    s_nop 0
    buffer_load_dwordx4 v8, s[8:11], s16 offen sc1 lds
    s_add_u32 m0, s22, 4096
    s_nop 0
    buffer_load_dwordx4 v9, s[8:11], s16 offen sc1 lds
    s_add_u32 m0, s22, 8192
    s_nop 0
    buffer_load_dwordx4 v10, s[8:11], s16 offen sc1 lds
    s_add_u32 m0, s22, 12288
    s_nop 0
    buffer_load_dwordx4 v11, s[8:11], s16 offen sc1 lds
    s_add_u32 s16, s16, 2048
    s_add_u32 s22, s18, 81920
    s_add_u32 m0, s22, 0
    s_nop 0
    buffer_load_dwordx4 v8, s[8:11], s16 offen sc1 lds
    s_add_u32 m0, s22, 4096
    s_nop 0
    buffer_load_dwordx4 v9, s[8:11], s16 offen sc1 lds
    s_add_u32 m0, s22, 8192
    s_nop 0
    buffer_load_dwordx4 v10, s[8:11], s16 offen sc1 lds
    s_add_u32 m0, s22, 12288
    s_nop 0
    buffer_load_dwordx4 v11, s[8:11], s16 offen sc1 lds
    s_add_u32 s16, s16, 2048
    s_waitcnt vmcnt(8)
    s_barrier
    s_waitcnt vmcnt(4)
    s_barrier
    s_add_u32 m0, s18, 0
    s_nop 0
    buffer_load_dwordx4 v8, s[8:11], s16 offen sc1 lds
    s_add_u32 m0, s18, 4096
    s_nop 0
    buffer_load_dwordx4 v9, s[8:11], s16 offen sc1 lds
    s_add_u32 m0, s18, 8192
    s_nop 0
    buffer_load_dwordx4 v10, s[8:11], s16 offen sc1 lds
    s_add_u32 m0, s18, 12288
    s_nop 0
    buffer_load_dwordx4 v11, s[8:11], s16 offen sc1 lds
    s_add_u32 s16, s16, 2048
    s_add_u32 m0, s18, 16384
    s_nop 0
    buffer_load_dwordx4 v12, s[12:15], s17 offen lds
    s_add_u32 m0, s18, 20480
    s_nop 0
    buffer_load_dwordx4 v13, s[12:15], s17 offen lds
    s_add_u32 m0, s18, 24576
    s_nop 0
    buffer_load_dwordx4 v14, s[12:15], s17 offen lds
    s_add_u32 m0, s18, 28672
    s_nop 0
    buffer_load_dwordx4 v15, s[12:15], s17 offen lds
    s_add_u32 m0, s18, 32768
    s_nop 0
    buffer_load_dwordx4 v16, s[12:15], s17 offen lds
    s_add_u32 m0, s18, 36864
    s_nop 0
    buffer_load_dwordx4 v17, s[12:15], s17 offen lds
    s_add_u32 s17, s17, 393216
    s_add_u32 s18, s18, 40960
    s_cmp_ge_u32 s18, s23
    s_cselect_b32 s20, 122880, 0
    s_sub_u32 s18, s18, s20
    s_mov_b32 s19, 12
adaLN_cond__mha_block__mixer_gmlp__prompt_kernel_q_ld_loop0:
    s_waitcnt vmcnt(10)
    s_barrier
    s_add_u32 m0, s18, 0
    s_nop 0
    buffer_load_dwordx4 v8, s[8:11], s16 offen sc1 lds
    s_add_u32 m0, s18, 4096
    s_nop 0
    buffer_load_dwordx4 v9, s[8:11], s16 offen sc1 lds
    s_add_u32 m0, s18, 8192
    s_nop 0
    buffer_load_dwordx4 v10, s[8:11], s16 offen sc1 lds
    s_add_u32 m0, s18, 12288
    s_nop 0
    buffer_load_dwordx4 v11, s[8:11], s16 offen sc1 lds
    s_add_u32 s16, s16, 2048
    s_add_u32 m0, s18, 16384
    s_nop 0
    buffer_load_dwordx4 v12, s[12:15], s17 offen lds
    s_add_u32 m0, s18, 20480
    s_nop 0
    buffer_load_dwordx4 v13, s[12:15], s17 offen lds
    s_add_u32 m0, s18, 24576
    s_nop 0
    buffer_load_dwordx4 v14, s[12:15], s17 offen lds
    s_add_u32 m0, s18, 28672
    s_nop 0
    buffer_load_dwordx4 v15, s[12:15], s17 offen lds
    s_add_u32 m0, s18, 32768
    s_nop 0
    buffer_load_dwordx4 v16, s[12:15], s17 offen lds
    s_add_u32 m0, s18, 36864
    s_nop 0
    buffer_load_dwordx4 v17, s[12:15], s17 offen lds
    s_add_u32 s17, s17, 393216
    s_add_u32 s18, s18, 40960
    s_cmp_ge_u32 s18, s23
    s_cselect_b32 s20, 122880, 0
    s_sub_u32 s18, s18, s20
    s_sub_u32 s19, s19, 1
    s_cmp_lg_u32 s19, 0
    s_cbranch_scc1 adaLN_cond__mha_block__mixer_gmlp__prompt_kernel_q_ld_loop0
    s_waitcnt vmcnt(10)
    s_barrier
    v_lshlrev_b32 v61, 16, v61
    v_mul_f32 v2, 0xbfb8aa3b, v61
    v_exp_f32 v2, v2
    s_nop 0
    v_add_f32 v2, 1.0, v2
    v_rcp_f32 v2, v2
    s_nop 0
    v_mul_f32 v61, v61, v2
    v_cvt_pk_bf16_f32 v61, v61, v61
    v_and_b32 v61, 0xffff0000, v61
    v_mov_b32 v56, 0
    v_mov_b32 v57, 0
    v_mov_b32 v58, 0
    v_mov_b32 v59, 0
    v_readlane_b32 s20, v61, 0
    v_lshlrev_b32 v2, 16, v64
    v_and_b32 v3, 0xffff0000, v64
    v_lshlrev_b32 v4, 16, v65
    v_and_b32 v5, 0xffff0000, v65
    v_fmac_f32 v56, s20, v2
    v_fmac_f32 v57, s20, v3
    v_fmac_f32 v58, s20, v4
    v_fmac_f32 v59, s20, v5
    v_readlane_b32 s20, v61, 1
    v_lshlrev_b32 v2, 16, v66
    v_and_b32 v3, 0xffff0000, v66
    v_lshlrev_b32 v4, 16, v67
    v_and_b32 v5, 0xffff0000, v67
    v_fmac_f32 v56, s20, v2
    v_fmac_f32 v57, s20, v3
    v_fmac_f32 v58, s20, v4
    v_fmac_f32 v59, s20, v5
    v_readlane_b32 s20, v61, 2
    v_lshlrev_b32 v2, 16, v68
    v_and_b32 v3, 0xffff0000, v68
    v_lshlrev_b32 v4, 16, v69
    v_and_b32 v5, 0xffff0000, v69
    v_fmac_f32 v56, s20, v2
    v_fmac_f32 v57, s20, v3
    v_fmac_f32 v58, s20, v4
    v_fmac_f32 v59, s20, v5
    v_readlane_b32 s20, v61, 3
    v_lshlrev_b32 v2, 16, v70
    v_and_b32 v3, 0xffff0000, v70
    v_lshlrev_b32 v4, 16, v71
    v_and_b32 v5, 0xffff0000, v71
    v_fmac_f32 v56, s20, v2
    v_fmac_f32 v57, s20, v3
    v_fmac_f32 v58, s20, v4
    v_fmac_f32 v59, s20, v5
    v_readlane_b32 s20, v61, 4
    v_lshlrev_b32 v2, 16, v72
    v_and_b32 v3, 0xffff0000, v72
    v_lshlrev_b32 v4, 16, v73
    v_and_b32 v5, 0xffff0000, v73
    v_fmac_f32 v56, s20, v2
    v_fmac_f32 v57, s20, v3
    v_fmac_f32 v58, s20, v4
    v_fmac_f32 v59, s20, v5
    v_readlane_b32 s20, v61, 5
    v_lshlrev_b32 v2, 16, v74
    v_and_b32 v3, 0xffff0000, v74
    v_lshlrev_b32 v4, 16, v75
    v_and_b32 v5, 0xffff0000, v75
    v_fmac_f32 v56, s20, v2
    v_fmac_f32 v57, s20, v3
    v_fmac_f32 v58, s20, v4
    v_fmac_f32 v59, s20, v5
    v_readlane_b32 s20, v61, 6
    v_lshlrev_b32 v2, 16, v76
    v_and_b32 v3, 0xffff0000, v76
    v_lshlrev_b32 v4, 16, v77
    v_and_b32 v5, 0xffff0000, v77
    v_fmac_f32 v56, s20, v2
    v_fmac_f32 v57, s20, v3
    v_fmac_f32 v58, s20, v4
    v_fmac_f32 v59, s20, v5
    v_readlane_b32 s20, v61, 7
    v_lshlrev_b32 v2, 16, v78
    v_and_b32 v3, 0xffff0000, v78
    v_lshlrev_b32 v4, 16, v79
    v_and_b32 v5, 0xffff0000, v79
    v_fmac_f32 v56, s20, v2
    v_fmac_f32 v57, s20, v3
    v_fmac_f32 v58, s20, v4
    v_fmac_f32 v59, s20, v5
    v_readlane_b32 s20, v61, 8
    v_lshlrev_b32 v2, 16, v80
    v_and_b32 v3, 0xffff0000, v80
    v_lshlrev_b32 v4, 16, v81
    v_and_b32 v5, 0xffff0000, v81
    v_fmac_f32 v56, s20, v2
    v_fmac_f32 v57, s20, v3
    v_fmac_f32 v58, s20, v4
    v_fmac_f32 v59, s20, v5
    v_readlane_b32 s20, v61, 9
    v_lshlrev_b32 v2, 16, v82
    v_and_b32 v3, 0xffff0000, v82
    v_lshlrev_b32 v4, 16, v83
    v_and_b32 v5, 0xffff0000, v83
    v_fmac_f32 v56, s20, v2
    v_fmac_f32 v57, s20, v3
    v_fmac_f32 v58, s20, v4
    v_fmac_f32 v59, s20, v5
    v_readlane_b32 s20, v61, 10
    v_lshlrev_b32 v2, 16, v84
    v_and_b32 v3, 0xffff0000, v84
    v_lshlrev_b32 v4, 16, v85
    v_and_b32 v5, 0xffff0000, v85
    v_fmac_f32 v56, s20, v2
    v_fmac_f32 v57, s20, v3
    v_fmac_f32 v58, s20, v4
    v_fmac_f32 v59, s20, v5
    v_readlane_b32 s20, v61, 11
    v_lshlrev_b32 v2, 16, v86
    v_and_b32 v3, 0xffff0000, v86
    v_lshlrev_b32 v4, 16, v87
    v_and_b32 v5, 0xffff0000, v87
    v_fmac_f32 v56, s20, v2
    v_fmac_f32 v57, s20, v3
    v_fmac_f32 v58, s20, v4
    v_fmac_f32 v59, s20, v5
    v_readlane_b32 s20, v61, 12
    v_lshlrev_b32 v2, 16, v88
    v_and_b32 v3, 0xffff0000, v88
    v_lshlrev_b32 v4, 16, v89
    v_and_b32 v5, 0xffff0000, v89
    v_fmac_f32 v56, s20, v2
    v_fmac_f32 v57, s20, v3
    v_fmac_f32 v58, s20, v4
    v_fmac_f32 v59, s20, v5
    v_readlane_b32 s20, v61, 13
    v_lshlrev_b32 v2, 16, v90
    v_and_b32 v3, 0xffff0000, v90
    v_lshlrev_b32 v4, 16, v91
    v_and_b32 v5, 0xffff0000, v91
    v_fmac_f32 v56, s20, v2
    v_fmac_f32 v57, s20, v3
    v_fmac_f32 v58, s20, v4
    v_fmac_f32 v59, s20, v5
    v_readlane_b32 s20, v61, 14
    v_lshlrev_b32 v2, 16, v92
    v_and_b32 v3, 0xffff0000, v92
    v_lshlrev_b32 v4, 16, v93
    v_and_b32 v5, 0xffff0000, v93
    v_fmac_f32 v56, s20, v2
    v_fmac_f32 v57, s20, v3
    v_fmac_f32 v58, s20, v4
    v_fmac_f32 v59, s20, v5
    v_readlane_b32 s20, v61, 15
    v_lshlrev_b32 v2, 16, v94
    v_and_b32 v3, 0xffff0000, v94
    v_lshlrev_b32 v4, 16, v95
    v_and_b32 v5, 0xffff0000, v95
    v_fmac_f32 v56, s20, v2
    v_fmac_f32 v57, s20, v3
    v_fmac_f32 v58, s20, v4
    v_fmac_f32 v59, s20, v5
    s_lshl_b32 s20, s3, 10
    s_add_u32 s20, s20, 40960
    v_lshl_add_u32 v2, v1, 4, s20
    ds_write_b128 v2, v[56:59]
    s_waitcnt lgkmcnt(0)
    s_waitcnt vmcnt(0)
    s_barrier
    s_waitcnt vmcnt(0)
    s_lshl_b32 s20, s3, 8
    s_add_u32 s20, s20, 40960
    v_lshl_add_u32 v2, v1, 2, s20
    ds_read_b32 v56, v2 offset:0
    ds_read_b32 v57, v2 offset:1024
    ds_read_b32 v58, v2 offset:2048
    ds_read_b32 v59, v2 offset:3072
    s_lshl_b32 s20, s3, 12
    s_lshl_b32 s21, s5, 8
    s_add_u32 s20, s20, s21
    s_add_u32 s20, s20, 8192
    v_lshlrev_b32 v2, 2, v1
    s_waitcnt lgkmcnt(0)
    v_add_f32 v56, v56, v57
    v_add_f32 v58, v58, v59
    v_add_f32 v56, v56, v58
    buffer_atomic_add_f32 v56, v2, s[48:51], s20 offen
    s_barrier
    s_waitcnt vmcnt(0)
    s_and_b32 s4, s2, 7
    s_lshl_b32 s4, s4, 2
    s_lshr_b32 s20, s2, 6
    s_add_u32 s4, s4, s20
    s_bfe_u32 s5, s2, 0x30003
    v_and_b32 v1, 63, v0
    v_lshlrev_b32 v4, 4, v1
    s_mov_b32 s33, 0
    s_setprio 0
    s_cmp_ge_u32 s3, 2
    s_cbranch_scc1 adaLN_cond__mha_block__mixer_gmlp__prompt_kernel_a_side
    s_lshl_b32 s6, s3, 14
    v_add_u32 v8, s6, v4
    v_add_u32 v9, 4096, v8
    v_add_u32 v10, 8192, v8
    v_add_u32 v11, 12288, v8
    s_lshl_b32 s21, s4, 18
    s_add_u32 s8, s36, 10485760
    s_addc_u32 s9, s37, 0
    s_mov_b32 s10, 262144
    s_mov_b32 s11, 0x20000
    s_add_u32 s8, s8, s21
    s_addc_u32 s9, s9, 0
    s_barrier
    s_barrier
    s_mov_b32 s16, 0
    s_add_u32 m0, s6, 0
    s_nop 0
    buffer_load_dwordx4 v8, s[8:11], s16 offen offset:0 sc1 lds
    buffer_load_dwordx4 v8, s[8:11], s16 offen offset:1024 sc1 lds
    buffer_load_dwordx4 v8, s[8:11], s16 offen offset:2048 sc1 lds
    buffer_load_dwordx4 v8, s[8:11], s16 offen offset:3072 sc1 lds
    s_add_u32 m0, s6, 4096
    s_nop 0
    buffer_load_dwordx4 v9, s[8:11], s16 offen offset:0 sc1 lds
    buffer_load_dwordx4 v9, s[8:11], s16 offen offset:1024 sc1 lds
    buffer_load_dwordx4 v9, s[8:11], s16 offen offset:2048 sc1 lds
    buffer_load_dwordx4 v9, s[8:11], s16 offen offset:3072 sc1 lds
    s_add_u32 m0, s6, 8192
    s_nop 0
    buffer_load_dwordx4 v10, s[8:11], s16 offen offset:0 sc1 lds
    buffer_load_dwordx4 v10, s[8:11], s16 offen offset:1024 sc1 lds
    buffer_load_dwordx4 v10, s[8:11], s16 offen offset:2048 sc1 lds
    buffer_load_dwordx4 v10, s[8:11], s16 offen offset:3072 sc1 lds
    s_add_u32 m0, s6, 12288
    s_nop 0
    buffer_load_dwordx4 v11, s[8:11], s16 offen offset:0 sc1 lds
    buffer_load_dwordx4 v11, s[8:11], s16 offen offset:1024 sc1 lds
    buffer_load_dwordx4 v11, s[8:11], s16 offen offset:2048 sc1 lds
    buffer_load_dwordx4 v11, s[8:11], s16 offen offset:3072 sc1 lds
    s_mov_b32 s16, 32768
    s_add_u32 m0, s6, 32768
    s_nop 0
    buffer_load_dwordx4 v8, s[8:11], s16 offen offset:0 sc1 lds
    buffer_load_dwordx4 v8, s[8:11], s16 offen offset:1024 sc1 lds
    buffer_load_dwordx4 v8, s[8:11], s16 offen offset:2048 sc1 lds
    buffer_load_dwordx4 v8, s[8:11], s16 offen offset:3072 sc1 lds
    s_add_u32 m0, s6, 36864
    s_nop 0
    buffer_load_dwordx4 v9, s[8:11], s16 offen offset:0 sc1 lds
    buffer_load_dwordx4 v9, s[8:11], s16 offen offset:1024 sc1 lds
    buffer_load_dwordx4 v9, s[8:11], s16 offen offset:2048 sc1 lds
    buffer_load_dwordx4 v9, s[8:11], s16 offen offset:3072 sc1 lds
    s_add_u32 m0, s6, 40960
    s_nop 0
    buffer_load_dwordx4 v10, s[8:11], s16 offen offset:0 sc1 lds
    buffer_load_dwordx4 v10, s[8:11], s16 offen offset:1024 sc1 lds
    buffer_load_dwordx4 v10, s[8:11], s16 offen offset:2048 sc1 lds
    buffer_load_dwordx4 v10, s[8:11], s16 offen offset:3072 sc1 lds
    s_add_u32 m0, s6, 45056
    s_nop 0
    buffer_load_dwordx4 v11, s[8:11], s16 offen offset:0 sc1 lds
    buffer_load_dwordx4 v11, s[8:11], s16 offen offset:1024 sc1 lds
    buffer_load_dwordx4 v11, s[8:11], s16 offen offset:2048 sc1 lds
    buffer_load_dwordx4 v11, s[8:11], s16 offen offset:3072 sc1 lds
    s_mov_b32 s16, 65536
    s_add_u32 m0, s6, 65536
    s_nop 0
    buffer_load_dwordx4 v8, s[8:11], s16 offen offset:0 sc1 lds
    buffer_load_dwordx4 v8, s[8:11], s16 offen offset:1024 sc1 lds
    buffer_load_dwordx4 v8, s[8:11], s16 offen offset:2048 sc1 lds
    buffer_load_dwordx4 v8, s[8:11], s16 offen offset:3072 sc1 lds
    s_add_u32 m0, s6, 69632
    s_nop 0
    buffer_load_dwordx4 v9, s[8:11], s16 offen offset:0 sc1 lds
    buffer_load_dwordx4 v9, s[8:11], s16 offen offset:1024 sc1 lds
    buffer_load_dwordx4 v9, s[8:11], s16 offen offset:2048 sc1 lds
    buffer_load_dwordx4 v9, s[8:11], s16 offen offset:3072 sc1 lds
    s_add_u32 m0, s6, 73728
    s_nop 0
    buffer_load_dwordx4 v10, s[8:11], s16 offen offset:0 sc1 lds
    buffer_load_dwordx4 v10, s[8:11], s16 offen offset:1024 sc1 lds
    buffer_load_dwordx4 v10, s[8:11], s16 offen offset:2048 sc1 lds
    buffer_load_dwordx4 v10, s[8:11], s16 offen offset:3072 sc1 lds
    s_add_u32 m0, s6, 77824
    s_nop 0
    buffer_load_dwordx4 v11, s[8:11], s16 offen offset:0 sc1 lds
    buffer_load_dwordx4 v11, s[8:11], s16 offen offset:1024 sc1 lds
    buffer_load_dwordx4 v11, s[8:11], s16 offen offset:2048 sc1 lds
    buffer_load_dwordx4 v11, s[8:11], s16 offen offset:3072 sc1 lds
    s_waitcnt vmcnt(32)
    s_barrier
    s_waitcnt vmcnt(16)
    s_barrier
    s_mov_b32 s16, 98304
    s_add_u32 m0, s6, 98304
    s_nop 0
    buffer_load_dwordx4 v8, s[8:11], s16 offen offset:0 sc1 lds
    buffer_load_dwordx4 v8, s[8:11], s16 offen offset:1024 sc1 lds
    buffer_load_dwordx4 v8, s[8:11], s16 offen offset:2048 sc1 lds
    buffer_load_dwordx4 v8, s[8:11], s16 offen offset:3072 sc1 lds
    s_add_u32 m0, s6, 102400
    s_nop 0
    buffer_load_dwordx4 v9, s[8:11], s16 offen offset:0 sc1 lds
    buffer_load_dwordx4 v9, s[8:11], s16 offen offset:1024 sc1 lds
    buffer_load_dwordx4 v9, s[8:11], s16 offen offset:2048 sc1 lds
    buffer_load_dwordx4 v9, s[8:11], s16 offen offset:3072 sc1 lds
    s_add_u32 m0, s6, 106496
    s_nop 0
    buffer_load_dwordx4 v10, s[8:11], s16 offen offset:0 sc1 lds
    buffer_load_dwordx4 v10, s[8:11], s16 offen offset:1024 sc1 lds
    buffer_load_dwordx4 v10, s[8:11], s16 offen offset:2048 sc1 lds
    buffer_load_dwordx4 v10, s[8:11], s16 offen offset:3072 sc1 lds
    s_add_u32 m0, s6, 110592
    s_nop 0
    buffer_load_dwordx4 v11, s[8:11], s16 offen offset:0 sc1 lds
    buffer_load_dwordx4 v11, s[8:11], s16 offen offset:1024 sc1 lds
    buffer_load_dwordx4 v11, s[8:11], s16 offen offset:2048 sc1 lds
    buffer_load_dwordx4 v11, s[8:11], s16 offen offset:3072 sc1 lds
    s_waitcnt vmcnt(16)
    s_barrier
    s_mov_b32 s16, 131072
    s_add_u32 m0, s6, 0
    s_nop 0
    buffer_load_dwordx4 v8, s[8:11], s16 offen offset:0 sc1 lds
    buffer_load_dwordx4 v8, s[8:11], s16 offen offset:1024 sc1 lds
    buffer_load_dwordx4 v8, s[8:11], s16 offen offset:2048 sc1 lds
    buffer_load_dwordx4 v8, s[8:11], s16 offen offset:3072 sc1 lds
    s_add_u32 m0, s6, 4096
    s_nop 0
    buffer_load_dwordx4 v9, s[8:11], s16 offen offset:0 sc1 lds
    buffer_load_dwordx4 v9, s[8:11], s16 offen offset:1024 sc1 lds
    buffer_load_dwordx4 v9, s[8:11], s16 offen offset:2048 sc1 lds
    buffer_load_dwordx4 v9, s[8:11], s16 offen offset:3072 sc1 lds
    s_add_u32 m0, s6, 8192
    s_nop 0
    buffer_load_dwordx4 v10, s[8:11], s16 offen offset:0 sc1 lds
    buffer_load_dwordx4 v10, s[8:11], s16 offen offset:1024 sc1 lds
    buffer_load_dwordx4 v10, s[8:11], s16 offen offset:2048 sc1 lds
    buffer_load_dwordx4 v10, s[8:11], s16 offen offset:3072 sc1 lds
    s_add_u32 m0, s6, 12288
    s_nop 0
    buffer_load_dwordx4 v11, s[8:11], s16 offen offset:0 sc1 lds
    buffer_load_dwordx4 v11, s[8:11], s16 offen offset:1024 sc1 lds
    buffer_load_dwordx4 v11, s[8:11], s16 offen offset:2048 sc1 lds
    buffer_load_dwordx4 v11, s[8:11], s16 offen offset:3072 sc1 lds
    s_waitcnt vmcnt(16)
    s_barrier
    s_mov_b32 s16, 163840
    s_add_u32 m0, s6, 32768
    s_nop 0
    buffer_load_dwordx4 v8, s[8:11], s16 offen offset:0 sc1 lds
    buffer_load_dwordx4 v8, s[8:11], s16 offen offset:1024 sc1 lds
    buffer_load_dwordx4 v8, s[8:11], s16 offen offset:2048 sc1 lds
    buffer_load_dwordx4 v8, s[8:11], s16 offen offset:3072 sc1 lds
    s_add_u32 m0, s6, 36864
    s_nop 0
    buffer_load_dwordx4 v9, s[8:11], s16 offen offset:0 sc1 lds
    buffer_load_dwordx4 v9, s[8:11], s16 offen offset:1024 sc1 lds
    buffer_load_dwordx4 v9, s[8:11], s16 offen offset:2048 sc1 lds
    buffer_load_dwordx4 v9, s[8:11], s16 offen offset:3072 sc1 lds
    s_add_u32 m0, s6, 40960
    s_nop 0
    buffer_load_dwordx4 v10, s[8:11], s16 offen offset:0 sc1 lds
    buffer_load_dwordx4 v10, s[8:11], s16 offen offset:1024 sc1 lds
    buffer_load_dwordx4 v10, s[8:11], s16 offen offset:2048 sc1 lds
    buffer_load_dwordx4 v10, s[8:11], s16 offen offset:3072 sc1 lds
    s_add_u32 m0, s6, 45056
    s_nop 0
    buffer_load_dwordx4 v11, s[8:11], s16 offen offset:0 sc1 lds
    buffer_load_dwordx4 v11, s[8:11], s16 offen offset:1024 sc1 lds
    buffer_load_dwordx4 v11, s[8:11], s16 offen offset:2048 sc1 lds
    buffer_load_dwordx4 v11, s[8:11], s16 offen offset:3072 sc1 lds
    s_waitcnt vmcnt(16)
    s_barrier
    s_mov_b32 s16, 196608
    s_add_u32 m0, s6, 65536
    s_nop 0
    buffer_load_dwordx4 v8, s[8:11], s16 offen offset:0 sc1 lds
    buffer_load_dwordx4 v8, s[8:11], s16 offen offset:1024 sc1 lds
    buffer_load_dwordx4 v8, s[8:11], s16 offen offset:2048 sc1 lds
    buffer_load_dwordx4 v8, s[8:11], s16 offen offset:3072 sc1 lds
    s_add_u32 m0, s6, 69632
    s_nop 0
    buffer_load_dwordx4 v9, s[8:11], s16 offen offset:0 sc1 lds
    buffer_load_dwordx4 v9, s[8:11], s16 offen offset:1024 sc1 lds
    buffer_load_dwordx4 v9, s[8:11], s16 offen offset:2048 sc1 lds
    buffer_load_dwordx4 v9, s[8:11], s16 offen offset:3072 sc1 lds
    s_add_u32 m0, s6, 73728
    s_nop 0
    buffer_load_dwordx4 v10, s[8:11], s16 offen offset:0 sc1 lds
    buffer_load_dwordx4 v10, s[8:11], s16 offen offset:1024 sc1 lds
    buffer_load_dwordx4 v10, s[8:11], s16 offen offset:2048 sc1 lds
    buffer_load_dwordx4 v10, s[8:11], s16 offen offset:3072 sc1 lds
    s_add_u32 m0, s6, 77824
    s_nop 0
    buffer_load_dwordx4 v11, s[8:11], s16 offen offset:0 sc1 lds
    buffer_load_dwordx4 v11, s[8:11], s16 offen offset:1024 sc1 lds
    buffer_load_dwordx4 v11, s[8:11], s16 offen offset:2048 sc1 lds
    buffer_load_dwordx4 v11, s[8:11], s16 offen offset:3072 sc1 lds
    s_waitcnt vmcnt(16)
    s_barrier
    s_mov_b32 s16, 229376
    s_add_u32 m0, s6, 98304
    s_nop 0
    buffer_load_dwordx4 v8, s[8:11], s16 offen offset:0 sc1 lds
    buffer_load_dwordx4 v8, s[8:11], s16 offen offset:1024 sc1 lds
    buffer_load_dwordx4 v8, s[8:11], s16 offen offset:2048 sc1 lds
    buffer_load_dwordx4 v8, s[8:11], s16 offen offset:3072 sc1 lds
    s_add_u32 m0, s6, 102400
    s_nop 0
    buffer_load_dwordx4 v9, s[8:11], s16 offen offset:0 sc1 lds
    buffer_load_dwordx4 v9, s[8:11], s16 offen offset:1024 sc1 lds
    buffer_load_dwordx4 v9, s[8:11], s16 offen offset:2048 sc1 lds
    buffer_load_dwordx4 v9, s[8:11], s16 offen offset:3072 sc1 lds
    s_add_u32 m0, s6, 106496
    s_nop 0
    buffer_load_dwordx4 v10, s[8:11], s16 offen offset:0 sc1 lds
    buffer_load_dwordx4 v10, s[8:11], s16 offen offset:1024 sc1 lds
    buffer_load_dwordx4 v10, s[8:11], s16 offen offset:2048 sc1 lds
    buffer_load_dwordx4 v10, s[8:11], s16 offen offset:3072 sc1 lds
    s_add_u32 m0, s6, 110592
    s_nop 0
    buffer_load_dwordx4 v11, s[8:11], s16 offen offset:0 sc1 lds
    buffer_load_dwordx4 v11, s[8:11], s16 offen offset:1024 sc1 lds
    buffer_load_dwordx4 v11, s[8:11], s16 offen offset:2048 sc1 lds
    buffer_load_dwordx4 v11, s[8:11], s16 offen offset:3072 sc1 lds
    s_waitcnt vmcnt(16)
    s_barrier
    s_waitcnt vmcnt(0)
    s_barrier
    s_waitcnt vmcnt(0)
    s_barrier
    s_lshl_b32 s20, s3, 3
    s_add_u32 s20, s20, 7
    s_add_u32 s20, s20, 96
    s_mul_i32 s20, s20, 4352
    v_and_b32 v2, 63, v0
    v_lshlrev_b32 v2, 7, v2
    s_bfm_b64 exec, 32, 0
    s_mov_b32 s19, 0x80000
adaLN_cond__mha_block__mixer_gmlp__prompt_kernel_a_sp:
    buffer_load_dword v240, v2, s[96:99], s20 offen sc1
    s_waitcnt vmcnt(0)
    v_cmp_ne_u32 vcc, s101, v240
    s_sub_u32 s19, s19, 1
    s_cmp_eq_u32 s19, 0
    s_cbranch_scc1 adaLN_cond__mha_block__mixer_gmlp__prompt_kernel_a_sp_d
    s_cbranch_vccz adaLN_cond__mha_block__mixer_gmlp__prompt_kernel_a_sp_d
    s_sleep 4
    s_branch adaLN_cond__mha_block__mixer_gmlp__prompt_kernel_a_sp
adaLN_cond__mha_block__mixer_gmlp__prompt_kernel_a_sp_d:
    s_mov_b64 exec, -1
adaLN_cond__mha_block__mixer_gmlp__prompt_kernel_a_hchk:
    s_barrier
    v_mov_b32 v7, 0
    ds_read_b128 v[12:15], v7
    s_waitcnt lgkmcnt(0)
    v_or3_b32 v12, v12, v13, v14
    v_or_b32 v12, v12, v15
    s_nop 0
    v_readfirstlane_b32 s20, v12
    s_nop 3
    s_cmp_eq_u32 s20, 0
    s_cbranch_scc1 adaLN_cond__mha_block__mixer_gmlp__prompt_kernel_a_hend
    s_mov_b32 s19, 2
adaLN_cond__mha_block__mixer_gmlp__prompt_kernel_a_hfb:
    s_barrier
    s_mov_b32 s16, 0
    s_add_u32 m0, s6, 0
    s_nop 0
    buffer_load_dwordx4 v8, s[8:11], s16 offen offset:0 sc1 lds
    buffer_load_dwordx4 v8, s[8:11], s16 offen offset:1024 sc1 lds
    buffer_load_dwordx4 v8, s[8:11], s16 offen offset:2048 sc1 lds
    buffer_load_dwordx4 v8, s[8:11], s16 offen offset:3072 sc1 lds
    s_add_u32 m0, s6, 4096
    s_nop 0
    buffer_load_dwordx4 v9, s[8:11], s16 offen offset:0 sc1 lds
    buffer_load_dwordx4 v9, s[8:11], s16 offen offset:1024 sc1 lds
    buffer_load_dwordx4 v9, s[8:11], s16 offen offset:2048 sc1 lds
    buffer_load_dwordx4 v9, s[8:11], s16 offen offset:3072 sc1 lds
    s_add_u32 m0, s6, 8192
    s_nop 0
    buffer_load_dwordx4 v10, s[8:11], s16 offen offset:0 sc1 lds
    buffer_load_dwordx4 v10, s[8:11], s16 offen offset:1024 sc1 lds
    buffer_load_dwordx4 v10, s[8:11], s16 offen offset:2048 sc1 lds
    buffer_load_dwordx4 v10, s[8:11], s16 offen offset:3072 sc1 lds
    s_add_u32 m0, s6, 12288
    s_nop 0
    buffer_load_dwordx4 v11, s[8:11], s16 offen offset:0 sc1 lds
    buffer_load_dwordx4 v11, s[8:11], s16 offen offset:1024 sc1 lds
    buffer_load_dwordx4 v11, s[8:11], s16 offen offset:2048 sc1 lds
    buffer_load_dwordx4 v11, s[8:11], s16 offen offset:3072 sc1 lds
    s_mov_b32 s16, 32768
    s_add_u32 m0, s6, 32768
    s_nop 0
    buffer_load_dwordx4 v8, s[8:11], s16 offen offset:0 sc1 lds
    buffer_load_dwordx4 v8, s[8:11], s16 offen offset:1024 sc1 lds
    buffer_load_dwordx4 v8, s[8:11], s16 offen offset:2048 sc1 lds
    buffer_load_dwordx4 v8, s[8:11], s16 offen offset:3072 sc1 lds
    s_add_u32 m0, s6, 36864
    s_nop 0
    buffer_load_dwordx4 v9, s[8:11], s16 offen offset:0 sc1 lds
    buffer_load_dwordx4 v9, s[8:11], s16 offen offset:1024 sc1 lds
    buffer_load_dwordx4 v9, s[8:11], s16 offen offset:2048 sc1 lds
    buffer_load_dwordx4 v9, s[8:11], s16 offen offset:3072 sc1 lds
    s_add_u32 m0, s6, 40960
    s_nop 0
    buffer_load_dwordx4 v10, s[8:11], s16 offen offset:0 sc1 lds
    buffer_load_dwordx4 v10, s[8:11], s16 offen offset:1024 sc1 lds
    buffer_load_dwordx4 v10, s[8:11], s16 offen offset:2048 sc1 lds
    buffer_load_dwordx4 v10, s[8:11], s16 offen offset:3072 sc1 lds
    s_add_u32 m0, s6, 45056
    s_nop 0
    buffer_load_dwordx4 v11, s[8:11], s16 offen offset:0 sc1 lds
    buffer_load_dwordx4 v11, s[8:11], s16 offen offset:1024 sc1 lds
    buffer_load_dwordx4 v11, s[8:11], s16 offen offset:2048 sc1 lds
    buffer_load_dwordx4 v11, s[8:11], s16 offen offset:3072 sc1 lds
    s_mov_b32 s16, 65536
    s_add_u32 m0, s6, 65536
    s_nop 0
    buffer_load_dwordx4 v8, s[8:11], s16 offen offset:0 sc1 lds
    buffer_load_dwordx4 v8, s[8:11], s16 offen offset:1024 sc1 lds
    buffer_load_dwordx4 v8, s[8:11], s16 offen offset:2048 sc1 lds
    buffer_load_dwordx4 v8, s[8:11], s16 offen offset:3072 sc1 lds
    s_add_u32 m0, s6, 69632
    s_nop 0
    buffer_load_dwordx4 v9, s[8:11], s16 offen offset:0 sc1 lds
    buffer_load_dwordx4 v9, s[8:11], s16 offen offset:1024 sc1 lds
    buffer_load_dwordx4 v9, s[8:11], s16 offen offset:2048 sc1 lds
    buffer_load_dwordx4 v9, s[8:11], s16 offen offset:3072 sc1 lds
    s_add_u32 m0, s6, 73728
    s_nop 0
    buffer_load_dwordx4 v10, s[8:11], s16 offen offset:0 sc1 lds
    buffer_load_dwordx4 v10, s[8:11], s16 offen offset:1024 sc1 lds
    buffer_load_dwordx4 v10, s[8:11], s16 offen offset:2048 sc1 lds
    buffer_load_dwordx4 v10, s[8:11], s16 offen offset:3072 sc1 lds
    s_add_u32 m0, s6, 77824
    s_nop 0
    buffer_load_dwordx4 v11, s[8:11], s16 offen offset:0 sc1 lds
    buffer_load_dwordx4 v11, s[8:11], s16 offen offset:1024 sc1 lds
    buffer_load_dwordx4 v11, s[8:11], s16 offen offset:2048 sc1 lds
    buffer_load_dwordx4 v11, s[8:11], s16 offen offset:3072 sc1 lds
    s_waitcnt vmcnt(32)
    s_barrier
    s_waitcnt vmcnt(16)
    s_barrier
    s_mov_b32 s16, 98304
    s_add_u32 m0, s6, 98304
    s_nop 0
    buffer_load_dwordx4 v8, s[8:11], s16 offen offset:0 sc1 lds
    buffer_load_dwordx4 v8, s[8:11], s16 offen offset:1024 sc1 lds
    buffer_load_dwordx4 v8, s[8:11], s16 offen offset:2048 sc1 lds
    buffer_load_dwordx4 v8, s[8:11], s16 offen offset:3072 sc1 lds
    s_add_u32 m0, s6, 102400
    s_nop 0
    buffer_load_dwordx4 v9, s[8:11], s16 offen offset:0 sc1 lds
    buffer_load_dwordx4 v9, s[8:11], s16 offen offset:1024 sc1 lds
    buffer_load_dwordx4 v9, s[8:11], s16 offen offset:2048 sc1 lds
    buffer_load_dwordx4 v9, s[8:11], s16 offen offset:3072 sc1 lds
    s_add_u32 m0, s6, 106496
    s_nop 0
    buffer_load_dwordx4 v10, s[8:11], s16 offen offset:0 sc1 lds
    buffer_load_dwordx4 v10, s[8:11], s16 offen offset:1024 sc1 lds
    buffer_load_dwordx4 v10, s[8:11], s16 offen offset:2048 sc1 lds
    buffer_load_dwordx4 v10, s[8:11], s16 offen offset:3072 sc1 lds
    s_add_u32 m0, s6, 110592
    s_nop 0
    buffer_load_dwordx4 v11, s[8:11], s16 offen offset:0 sc1 lds
    buffer_load_dwordx4 v11, s[8:11], s16 offen offset:1024 sc1 lds
    buffer_load_dwordx4 v11, s[8:11], s16 offen offset:2048 sc1 lds
    buffer_load_dwordx4 v11, s[8:11], s16 offen offset:3072 sc1 lds
    s_waitcnt vmcnt(16)
    s_barrier
    s_mov_b32 s16, 131072
    s_add_u32 m0, s6, 0
    s_nop 0
    buffer_load_dwordx4 v8, s[8:11], s16 offen offset:0 sc1 lds
    buffer_load_dwordx4 v8, s[8:11], s16 offen offset:1024 sc1 lds
    buffer_load_dwordx4 v8, s[8:11], s16 offen offset:2048 sc1 lds
    buffer_load_dwordx4 v8, s[8:11], s16 offen offset:3072 sc1 lds
    s_add_u32 m0, s6, 4096
    s_nop 0
    buffer_load_dwordx4 v9, s[8:11], s16 offen offset:0 sc1 lds
    buffer_load_dwordx4 v9, s[8:11], s16 offen offset:1024 sc1 lds
    buffer_load_dwordx4 v9, s[8:11], s16 offen offset:2048 sc1 lds
    buffer_load_dwordx4 v9, s[8:11], s16 offen offset:3072 sc1 lds
    s_add_u32 m0, s6, 8192
    s_nop 0
    buffer_load_dwordx4 v10, s[8:11], s16 offen offset:0 sc1 lds
    buffer_load_dwordx4 v10, s[8:11], s16 offen offset:1024 sc1 lds
    buffer_load_dwordx4 v10, s[8:11], s16 offen offset:2048 sc1 lds
    buffer_load_dwordx4 v10, s[8:11], s16 offen offset:3072 sc1 lds
    s_add_u32 m0, s6, 12288
    s_nop 0
    buffer_load_dwordx4 v11, s[8:11], s16 offen offset:0 sc1 lds
    buffer_load_dwordx4 v11, s[8:11], s16 offen offset:1024 sc1 lds
    buffer_load_dwordx4 v11, s[8:11], s16 offen offset:2048 sc1 lds
    buffer_load_dwordx4 v11, s[8:11], s16 offen offset:3072 sc1 lds
    s_waitcnt vmcnt(16)
    s_barrier
    s_mov_b32 s16, 163840
    s_add_u32 m0, s6, 32768
    s_nop 0
    buffer_load_dwordx4 v8, s[8:11], s16 offen offset:0 sc1 lds
    buffer_load_dwordx4 v8, s[8:11], s16 offen offset:1024 sc1 lds
    buffer_load_dwordx4 v8, s[8:11], s16 offen offset:2048 sc1 lds
    buffer_load_dwordx4 v8, s[8:11], s16 offen offset:3072 sc1 lds
    s_add_u32 m0, s6, 36864
    s_nop 0
    buffer_load_dwordx4 v9, s[8:11], s16 offen offset:0 sc1 lds
    buffer_load_dwordx4 v9, s[8:11], s16 offen offset:1024 sc1 lds
    buffer_load_dwordx4 v9, s[8:11], s16 offen offset:2048 sc1 lds
    buffer_load_dwordx4 v9, s[8:11], s16 offen offset:3072 sc1 lds
    s_add_u32 m0, s6, 40960
    s_nop 0
    buffer_load_dwordx4 v10, s[8:11], s16 offen offset:0 sc1 lds
    buffer_load_dwordx4 v10, s[8:11], s16 offen offset:1024 sc1 lds
    buffer_load_dwordx4 v10, s[8:11], s16 offen offset:2048 sc1 lds
    buffer_load_dwordx4 v10, s[8:11], s16 offen offset:3072 sc1 lds
    s_add_u32 m0, s6, 45056
    s_nop 0
    buffer_load_dwordx4 v11, s[8:11], s16 offen offset:0 sc1 lds
    buffer_load_dwordx4 v11, s[8:11], s16 offen offset:1024 sc1 lds
    buffer_load_dwordx4 v11, s[8:11], s16 offen offset:2048 sc1 lds
    buffer_load_dwordx4 v11, s[8:11], s16 offen offset:3072 sc1 lds
    s_waitcnt vmcnt(16)
    s_barrier
    s_mov_b32 s16, 196608
    s_add_u32 m0, s6, 65536
    s_nop 0
    buffer_load_dwordx4 v8, s[8:11], s16 offen offset:0 sc1 lds
    buffer_load_dwordx4 v8, s[8:11], s16 offen offset:1024 sc1 lds
    buffer_load_dwordx4 v8, s[8:11], s16 offen offset:2048 sc1 lds
    buffer_load_dwordx4 v8, s[8:11], s16 offen offset:3072 sc1 lds
    s_add_u32 m0, s6, 69632
    s_nop 0
    buffer_load_dwordx4 v9, s[8:11], s16 offen offset:0 sc1 lds
    buffer_load_dwordx4 v9, s[8:11], s16 offen offset:1024 sc1 lds
    buffer_load_dwordx4 v9, s[8:11], s16 offen offset:2048 sc1 lds
    buffer_load_dwordx4 v9, s[8:11], s16 offen offset:3072 sc1 lds
    s_add_u32 m0, s6, 73728
    s_nop 0
    buffer_load_dwordx4 v10, s[8:11], s16 offen offset:0 sc1 lds
    buffer_load_dwordx4 v10, s[8:11], s16 offen offset:1024 sc1 lds
    buffer_load_dwordx4 v10, s[8:11], s16 offen offset:2048 sc1 lds
    buffer_load_dwordx4 v10, s[8:11], s16 offen offset:3072 sc1 lds
    s_add_u32 m0, s6, 77824
    s_nop 0
    buffer_load_dwordx4 v11, s[8:11], s16 offen offset:0 sc1 lds
    buffer_load_dwordx4 v11, s[8:11], s16 offen offset:1024 sc1 lds
    buffer_load_dwordx4 v11, s[8:11], s16 offen offset:2048 sc1 lds
    buffer_load_dwordx4 v11, s[8:11], s16 offen offset:3072 sc1 lds
    s_waitcnt vmcnt(16)
    s_barrier
    s_mov_b32 s16, 229376
    s_add_u32 m0, s6, 98304
    s_nop 0
    buffer_load_dwordx4 v8, s[8:11], s16 offen offset:0 sc1 lds
    buffer_load_dwordx4 v8, s[8:11], s16 offen offset:1024 sc1 lds
    buffer_load_dwordx4 v8, s[8:11], s16 offen offset:2048 sc1 lds
    buffer_load_dwordx4 v8, s[8:11], s16 offen offset:3072 sc1 lds
    s_add_u32 m0, s6, 102400
    s_nop 0
    buffer_load_dwordx4 v9, s[8:11], s16 offen offset:0 sc1 lds
    buffer_load_dwordx4 v9, s[8:11], s16 offen offset:1024 sc1 lds
    buffer_load_dwordx4 v9, s[8:11], s16 offen offset:2048 sc1 lds
    buffer_load_dwordx4 v9, s[8:11], s16 offen offset:3072 sc1 lds
    s_add_u32 m0, s6, 106496
    s_nop 0
    buffer_load_dwordx4 v10, s[8:11], s16 offen offset:0 sc1 lds
    buffer_load_dwordx4 v10, s[8:11], s16 offen offset:1024 sc1 lds
    buffer_load_dwordx4 v10, s[8:11], s16 offen offset:2048 sc1 lds
    buffer_load_dwordx4 v10, s[8:11], s16 offen offset:3072 sc1 lds
    s_add_u32 m0, s6, 110592
    s_nop 0
    buffer_load_dwordx4 v11, s[8:11], s16 offen offset:0 sc1 lds
    buffer_load_dwordx4 v11, s[8:11], s16 offen offset:1024 sc1 lds
    buffer_load_dwordx4 v11, s[8:11], s16 offen offset:2048 sc1 lds
    buffer_load_dwordx4 v11, s[8:11], s16 offen offset:3072 sc1 lds
    s_waitcnt vmcnt(16)
    s_barrier
    s_waitcnt vmcnt(0)
    s_barrier
    s_waitcnt vmcnt(0)
    s_barrier
    s_sub_u32 s19, s19, 1
    s_cmp_lg_u32 s19, 0
    s_cbranch_scc1 adaLN_cond__mha_block__mixer_gmlp__prompt_kernel_a_hfb
    s_branch adaLN_cond__mha_block__mixer_gmlp__prompt_kernel_a_hchk
adaLN_cond__mha_block__mixer_gmlp__prompt_kernel_a_side:
    s_sub_u32 s30, s3, 2
    s_lshl_b32 s6, s30, 14
    s_lshl_b32 s22, s2, 1
    s_add_u32 s22, s22, s30
    s_lshr_b32 s38, s4, 1
    s_and_b32 s39, s4, 1
    s_lshl_b32 s20, s5, 1
    s_add_u32 s39, s39, s20
    s_lshl_b32 s39, s39, 1
    s_add_u32 s39, s39, s30
    s_lshl_b32 s39, s39, 1
    s_mul_i32 s31, s38, 56
    s_add_u32 s31, s31, s39
    s_lshl_b32 s23, s38, 3
    s_add_u32 s23, s23, s39
    s_sub_u32 s23, s23, 56
    s_cmp_lt_u32 s5, 7
    s_cselect_b32 s62, 1, 0
    s_cselect_b32 s31, s31, s23
    s_cselect_b32 s40, s84, s80
    s_cselect_b32 s41, s85, s81
    s_mov_b32 s42, 2097152
    s_cmov_b32 s42, 7340032
    s_mov_b32 s43, 0x20000
    s_cselect_b32 s44, s90, s80
    s_cselect_b32 s45, s91, s81
    s_mov_b32 s46, 2097152
    s_cmov_b32 s46, 3670016
    s_mov_b32 s47, 0x20000
    s_mov_b32 s54, 2048
    s_cmov_b32 s54, 7168
    s_cselect_b32 s56, 2097152, 0
    s_cselect_b32 s60, 10485760, 0
    s_mov_b32 s61, 32768
    s_cmov_b32 s61, 57344
    s_lshr_b32 s32, s31, 4
    s_and_b32 s31, s31, 15
    s_lshl_b32 s23, s32, 2
    s_add_u32 s34, s23, 2
    s_lshl_b32 s21, s38, 1
    s_cmp_lt_u32 s5, 7
    s_cselect_b32 s20, s39, s31
    s_cselect_b32 s21, s21, s23
    s_cselect_b32 s32, s32, s34
    s_lshl_b32 s63, s20, 8
    s_lshl_b32 s68, s21, 7
    s_mul_i32 s55, s21, s54
    s_lshl_b32 s55, s55, 5
    s_lshl_b32 s23, s20, 7
    s_add_u32 s55, s55, s23
    s_add_u32 s23, s23, s21
    s_lshl_b32 s23, s23, 10
    s_add_u32 s56, s56, s23
    s_mov_b32 s57, 32768
    s_lshl_b32 s59, s32, 16
    s_lshl_b32 s23, s31, 7
    s_add_u32 s59, s59, s23
    s_mul_i32 s23, s31, s61
    s_lshl_b32 s23, s23, 2
    s_add_u32 s60, s60, s23
    s_lshl_b32 s23, s32, 10
    s_add_u32 s60, s60, s23
    s_lshl_b32 s69, s22, 14
    s_lshl_b32 s35, s54, 3
    s_add_u32 s64, s36, 31457280
    s_addc_u32 s65, s37, 0
    s_mov_b32 s66, 14680064
    s_mov_b32 s67, 0x20000
    s_mov_b32 s72, s36
    s_mov_b32 s73, s37
    s_mov_b32 s74, 131072
    s_mov_b32 s75, 0x20000
    s_mov_b32 s12, s86
    s_mov_b32 s13, s87
    s_mov_b32 s14, 8388608
    s_mov_b32 s15, 0x20000
    v_and_b32 v8, 1, v1
    v_sub_u32 v8, 4, v8
    v_lshlrev_b32 v8, 12, v8
    v_lshrrev_b32 v7, 4, v1
    v_lshl_add_u32 v10, v7, 5, v8
    v_bfe_u32 v8, v1, 2, 2
    v_lshl_add_u32 v8, v7, 3, v8
    v_lshlrev_b32 v8, 7, v8
    v_and_b32 v9, 3, v1
    v_lshl_add_u32 v8, v9, 3, v8
    s_add_u32 s20, s6, 131072
    v_add_u32 v8, s20, v8
    v_bfe_u32 v9, v1, 3, 2
    v_xor_b32 v7, 0, v9
    v_lshl_add_u32 v140, v7, 5, v8
    v_xor_b32 v7, 1, v9
    v_lshl_add_u32 v141, v7, 5, v8
    v_xor_b32 v7, 2, v9
    v_lshl_add_u32 v142, v7, 5, v8
    v_xor_b32 v7, 3, v9
    v_lshl_add_u32 v143, v7, 5, v8
    v_bfe_u32 v8, v1, 4, 1
    v_bfe_u32 v7, v1, 1, 2
    v_xor_b32 v8, v8, v7
    v_and_b32 v7, 1, v1
    v_lshlrev_b32 v7, 4, v7
    v_lshl_add_u32 v8, v8, 5, v7
    v_xor_b32 v9, 64, v8
    v_lshrrev_b32 v7, 3, v1
    v_mul_lo_u32 v11, v7, s54
    v_add_u32 v136, v8, v11
    v_add_u32 v137, v9, v11
    v_lshl_add_u32 v138, v7, 11, v8
    v_lshl_add_u32 v139, v7, 11, v9
    s_barrier
    s_barrier
    s_barrier
    s_add_u32 s21, s55, 0
    s_add_u32 m0, s6, 131072
    s_nop 0
    buffer_load_dwordx4 v136, s[40:43], s21 offen nt lds
    s_add_u32 m0, s6, 132096
    s_add_u32 s21, s21, s35
    buffer_load_dwordx4 v137, s[40:43], s21 offen nt lds
    s_add_u32 m0, s6, 133120
    s_add_u32 s21, s21, s35
    buffer_load_dwordx4 v136, s[40:43], s21 offen nt lds
    s_add_u32 m0, s6, 134144
    s_add_u32 s21, s21, s35
    buffer_load_dwordx4 v137, s[40:43], s21 offen nt lds
    s_add_u32 m0, s6, 135168
    s_add_u32 s21, s21, s35
    buffer_load_dwordx4 v136, s[40:43], s21 offen nt lds
    s_add_u32 m0, s6, 136192
    s_add_u32 s21, s21, s35
    buffer_load_dwordx4 v137, s[40:43], s21 offen nt lds
    s_add_u32 m0, s6, 137216
    s_add_u32 s21, s21, s35
    buffer_load_dwordx4 v136, s[40:43], s21 offen nt lds
    s_add_u32 m0, s6, 138240
    s_add_u32 s21, s21, s35
    buffer_load_dwordx4 v137, s[40:43], s21 offen nt lds
    s_add_u32 s21, s55, 128
    s_add_u32 m0, s6, 139264
    s_nop 0
    buffer_load_dwordx4 v136, s[40:43], s21 offen nt lds
    s_add_u32 m0, s6, 140288
    s_add_u32 s21, s21, s35
    buffer_load_dwordx4 v137, s[40:43], s21 offen nt lds
    s_add_u32 m0, s6, 141312
    s_add_u32 s21, s21, s35
    buffer_load_dwordx4 v136, s[40:43], s21 offen nt lds
    s_add_u32 m0, s6, 142336
    s_add_u32 s21, s21, s35
    buffer_load_dwordx4 v137, s[40:43], s21 offen nt lds
    s_add_u32 m0, s6, 143360
    s_add_u32 s21, s21, s35
    buffer_load_dwordx4 v136, s[40:43], s21 offen nt lds
    s_add_u32 m0, s6, 144384
    s_add_u32 s21, s21, s35
    buffer_load_dwordx4 v137, s[40:43], s21 offen nt lds
    s_add_u32 m0, s6, 145408
    s_add_u32 s21, s21, s35
    buffer_load_dwordx4 v136, s[40:43], s21 offen nt lds
    s_add_u32 m0, s6, 146432
    s_add_u32 s21, s21, s35
    buffer_load_dwordx4 v137, s[40:43], s21 offen nt lds
    buffer_load_dwordx4 v[16:19], v10, s[72:75], s68 offen offset:0 sc1
    buffer_load_dwordx4 v[20:23], v10, s[72:75], s68 offen offset:16 sc1
    buffer_load_dwordx4 v[24:27], v10, s[72:75], s68 offen offset:128 sc1
    buffer_load_dwordx4 v[28:31], v10, s[72:75], s68 offen offset:144 sc1
    s_mov_b32 s18, 1
    s_mov_b32 s19, 8
adaLN_cond__mha_block__mixer_gmlp__prompt_kernel_a_sl:
    s_bitcmp1_b32 20, s18
    s_cbranch_scc1 adaLN_cond__mha_block__mixer_gmlp__prompt_kernel_a_sgo2
    s_cmp_eq_u32 s19, 0
    s_cbranch_scc1 adaLN_cond__mha_block__mixer_gmlp__prompt_kernel_a_sgo
    s_getreg_b32 s20, hwreg(HW_REG_IB_STS)
    s_and_b32 s20, s20, 0xc000000f
    s_cbranch_scc1 adaLN_cond__mha_block__mixer_gmlp__prompt_kernel_a_sbar
adaLN_cond__mha_block__mixer_gmlp__prompt_kernel_a_sgo:
    s_waitcnt vmcnt(0)
adaLN_cond__mha_block__mixer_gmlp__prompt_kernel_a_sgo2:
    s_cmp_eq_u32 s18, 1
    s_cbranch_scc0 adaLN_cond__mha_block__mixer_gmlp__prompt_kernel_a_st1
    v_and_b32 v7, 1, v1
    v_xor_b32 v7, 1, v7
    v_cvt_f32_u32 v7, v7
    v_cvt_pk_bf16_f32 v16, v16, v16
    v_and_b32 v16, 0xffff0000, v16
    v_add_f32 v16, v16, v7
    v_cvt_pk_bf16_f32 v17, v17, v17
    v_and_b32 v17, 0xffff0000, v17
    v_add_f32 v17, v17, v7
    v_cvt_pk_bf16_f32 v18, v18, v18
    v_and_b32 v18, 0xffff0000, v18
    v_add_f32 v18, v18, v7
    v_cvt_pk_bf16_f32 v19, v19, v19
    v_and_b32 v19, 0xffff0000, v19
    v_add_f32 v19, v19, v7
    v_cvt_pk_bf16_f32 v20, v20, v20
    v_and_b32 v20, 0xffff0000, v20
    v_add_f32 v20, v20, v7
    v_cvt_pk_bf16_f32 v21, v21, v21
    v_and_b32 v21, 0xffff0000, v21
    v_add_f32 v21, v21, v7
    v_cvt_pk_bf16_f32 v22, v22, v22
    v_and_b32 v22, 0xffff0000, v22
    v_add_f32 v22, v22, v7
    v_cvt_pk_bf16_f32 v23, v23, v23
    v_and_b32 v23, 0xffff0000, v23
    v_add_f32 v23, v23, v7
    v_cvt_pk_bf16_f32 v24, v24, v24
    v_and_b32 v24, 0xffff0000, v24
    v_add_f32 v24, v24, v7
    v_cvt_pk_bf16_f32 v25, v25, v25
    v_and_b32 v25, 0xffff0000, v25
    v_add_f32 v25, v25, v7
    v_cvt_pk_bf16_f32 v26, v26, v26
    v_and_b32 v26, 0xffff0000, v26
    v_add_f32 v26, v26, v7
    v_cvt_pk_bf16_f32 v27, v27, v27
    v_and_b32 v27, 0xffff0000, v27
    v_add_f32 v27, v27, v7
    v_cvt_pk_bf16_f32 v28, v28, v28
    v_and_b32 v28, 0xffff0000, v28
    v_add_f32 v28, v28, v7
    v_cvt_pk_bf16_f32 v29, v29, v29
    v_and_b32 v29, 0xffff0000, v29
    v_add_f32 v29, v29, v7
    v_cvt_pk_bf16_f32 v30, v30, v30
    v_and_b32 v30, 0xffff0000, v30
    v_add_f32 v30, v30, v7
    v_cvt_pk_bf16_f32 v31, v31, v31
    v_and_b32 v31, 0xffff0000, v31
    v_add_f32 v31, v31, v7
    v_cvt_pk_bf16_f32 v96, v16, v17
    v_cvt_pk_bf16_f32 v97, v18, v19
    v_cvt_pk_bf16_f32 v98, v20, v21
    v_cvt_pk_bf16_f32 v99, v22, v23
    v_cvt_pk_bf16_f32 v100, v24, v25
    v_cvt_pk_bf16_f32 v101, v26, v27
    v_cvt_pk_bf16_f32 v102, v28, v29
    v_cvt_pk_bf16_f32 v103, v30, v31
    ds_read_b64_tr_b16 v[32:33], v140 offset:0
    ds_read_b64_tr_b16 v[34:35], v140 offset:512
    ds_read_b64_tr_b16 v[36:37], v141 offset:0
    ds_read_b64_tr_b16 v[38:39], v141 offset:512
    ds_read_b64_tr_b16 v[40:41], v142 offset:0
    ds_read_b64_tr_b16 v[42:43], v142 offset:512
    ds_read_b64_tr_b16 v[44:45], v143 offset:0
    ds_read_b64_tr_b16 v[46:47], v143 offset:512
    ds_read_b64_tr_b16 v[48:49], v140 offset:4096
    ds_read_b64_tr_b16 v[50:51], v140 offset:4608
    ds_read_b64_tr_b16 v[52:53], v141 offset:4096
    ds_read_b64_tr_b16 v[54:55], v141 offset:4608
    ds_read_b64_tr_b16 v[56:57], v142 offset:4096
    ds_read_b64_tr_b16 v[58:59], v142 offset:4608
    ds_read_b64_tr_b16 v[60:61], v143 offset:4096
    ds_read_b64_tr_b16 v[62:63], v143 offset:4608
    ds_read_b64_tr_b16 v[64:65], v140 offset:8192
    ds_read_b64_tr_b16 v[66:67], v140 offset:8704
    ds_read_b64_tr_b16 v[68:69], v141 offset:8192
    ds_read_b64_tr_b16 v[70:71], v141 offset:8704
    ds_read_b64_tr_b16 v[72:73], v142 offset:8192
    ds_read_b64_tr_b16 v[74:75], v142 offset:8704
    ds_read_b64_tr_b16 v[76:77], v143 offset:8192
    ds_read_b64_tr_b16 v[78:79], v143 offset:8704
    ds_read_b64_tr_b16 v[80:81], v140 offset:12288
    ds_read_b64_tr_b16 v[82:83], v140 offset:12800
    ds_read_b64_tr_b16 v[84:85], v141 offset:12288
    ds_read_b64_tr_b16 v[86:87], v141 offset:12800
    ds_read_b64_tr_b16 v[88:89], v142 offset:12288
    ds_read_b64_tr_b16 v[90:91], v142 offset:12800
    ds_read_b64_tr_b16 v[92:93], v143 offset:12288
    ds_read_b64_tr_b16 v[94:95], v143 offset:12800
    s_waitcnt lgkmcnt(0)
    s_mov_b32 s70, s46
    s_cmp_eq_u32 s62, 0
    s_cselect_b32 s71, s70, 0
    s_add_u32 s21, s59, 0
    s_mov_b32 s46, s70
    s_add_u32 m0, s6, 131072
    s_nop 0
    buffer_load_dwordx4 v138, s[44:47], s21 offen nt lds
    s_add_u32 m0, s6, 132096
    s_add_u32 s21, s21, 16384
    buffer_load_dwordx4 v139, s[44:47], s21 offen nt lds
    s_add_u32 m0, s6, 133120
    s_add_u32 s21, s21, 16384
    buffer_load_dwordx4 v138, s[44:47], s21 offen nt lds
    s_add_u32 m0, s6, 134144
    s_add_u32 s21, s21, 16384
    buffer_load_dwordx4 v139, s[44:47], s21 offen nt lds
    s_mov_b32 s46, s71
    s_add_u32 m0, s6, 135168
    s_add_u32 s21, s21, 16384
    buffer_load_dwordx4 v138, s[44:47], s21 offen nt lds
    s_add_u32 m0, s6, 136192
    s_add_u32 s21, s21, 16384
    buffer_load_dwordx4 v139, s[44:47], s21 offen nt lds
    s_add_u32 m0, s6, 137216
    s_add_u32 s21, s21, 16384
    buffer_load_dwordx4 v138, s[44:47], s21 offen nt lds
    s_add_u32 m0, s6, 138240
    s_add_u32 s21, s21, 16384
    buffer_load_dwordx4 v139, s[44:47], s21 offen nt lds
    s_add_u32 s21, s59, 128
    s_mov_b32 s46, s70
    s_add_u32 m0, s6, 139264
    s_nop 0
    buffer_load_dwordx4 v138, s[44:47], s21 offen nt lds
    s_add_u32 m0, s6, 140288
    s_add_u32 s21, s21, 16384
    buffer_load_dwordx4 v139, s[44:47], s21 offen nt lds
    s_add_u32 m0, s6, 141312
    s_add_u32 s21, s21, 16384
    buffer_load_dwordx4 v138, s[44:47], s21 offen nt lds
    s_add_u32 m0, s6, 142336
    s_add_u32 s21, s21, 16384
    buffer_load_dwordx4 v139, s[44:47], s21 offen nt lds
    s_mov_b32 s46, s71
    s_add_u32 m0, s6, 143360
    s_add_u32 s21, s21, 16384
    buffer_load_dwordx4 v138, s[44:47], s21 offen nt lds
    s_add_u32 m0, s6, 144384
    s_add_u32 s21, s21, 16384
    buffer_load_dwordx4 v139, s[44:47], s21 offen nt lds
    s_add_u32 m0, s6, 145408
    s_add_u32 s21, s21, 16384
    buffer_load_dwordx4 v138, s[44:47], s21 offen nt lds
    s_add_u32 m0, s6, 146432
    s_add_u32 s21, s21, 16384
    buffer_load_dwordx4 v139, s[44:47], s21 offen nt lds
    s_mov_b32 s18, 2
    s_cmp_eq_u32 s19, 0
    s_cbranch_scc1 adaLN_cond__mha_block__mixer_gmlp__prompt_kernel_a_sl
    s_branch adaLN_cond__mha_block__mixer_gmlp__prompt_kernel_a_sbar
adaLN_cond__mha_block__mixer_gmlp__prompt_kernel_a_st1:
    s_cmp_eq_u32 s18, 2
    s_cbranch_scc0 adaLN_cond__mha_block__mixer_gmlp__prompt_kernel_a_st2
    s_add_u32 s20, s56, 0
    buffer_store_dwordx4 v[32:35], v4, s[64:67], s20 offen sc1
    s_add_u32 s20, s20, s57
    v_mfma_f32_16x16x32_bf16 v[104:107], v[96:99], v[32:35], 0
    buffer_store_dwordx4 v[36:39], v4, s[64:67], s20 offen sc1
    s_add_u32 s20, s20, s57
    v_mfma_f32_16x16x32_bf16 v[108:111], v[96:99], v[36:39], 0
    buffer_store_dwordx4 v[40:43], v4, s[64:67], s20 offen sc1
    s_add_u32 s20, s20, s57
    v_mfma_f32_16x16x32_bf16 v[112:115], v[96:99], v[40:43], 0
    buffer_store_dwordx4 v[44:47], v4, s[64:67], s20 offen sc1
    s_add_u32 s20, s20, s57
    v_mfma_f32_16x16x32_bf16 v[116:119], v[96:99], v[44:47], 0
    buffer_store_dwordx4 v[64:67], v4, s[64:67], s20 offen sc1
    s_add_u32 s20, s20, s57
    v_mfma_f32_16x16x32_bf16 v[120:123], v[96:99], v[64:67], 0
    buffer_store_dwordx4 v[68:71], v4, s[64:67], s20 offen sc1
    s_add_u32 s20, s20, s57
    v_mfma_f32_16x16x32_bf16 v[124:127], v[96:99], v[68:71], 0
    buffer_store_dwordx4 v[72:75], v4, s[64:67], s20 offen sc1
    s_add_u32 s20, s20, s57
    v_mfma_f32_16x16x32_bf16 v[128:131], v[96:99], v[72:75], 0
    buffer_store_dwordx4 v[76:79], v4, s[64:67], s20 offen sc1
    s_add_u32 s20, s20, s57
    v_mfma_f32_16x16x32_bf16 v[132:135], v[96:99], v[76:79], 0
    s_add_u32 s20, s56, 1024
    buffer_store_dwordx4 v[48:51], v4, s[64:67], s20 offen sc1
    s_add_u32 s20, s20, s57
    v_mfma_f32_16x16x32_bf16 v[104:107], v[100:103], v[48:51], v[104:107]
    buffer_store_dwordx4 v[52:55], v4, s[64:67], s20 offen sc1
    s_add_u32 s20, s20, s57
    v_mfma_f32_16x16x32_bf16 v[108:111], v[100:103], v[52:55], v[108:111]
    buffer_store_dwordx4 v[56:59], v4, s[64:67], s20 offen sc1
    s_add_u32 s20, s20, s57
    v_mfma_f32_16x16x32_bf16 v[112:115], v[100:103], v[56:59], v[112:115]
    buffer_store_dwordx4 v[60:63], v4, s[64:67], s20 offen sc1
    s_add_u32 s20, s20, s57
    v_mfma_f32_16x16x32_bf16 v[116:119], v[100:103], v[60:63], v[116:119]
    buffer_store_dwordx4 v[80:83], v4, s[64:67], s20 offen sc1
    s_add_u32 s20, s20, s57
    v_mfma_f32_16x16x32_bf16 v[120:123], v[100:103], v[80:83], v[120:123]
    buffer_store_dwordx4 v[84:87], v4, s[64:67], s20 offen sc1
    s_add_u32 s20, s20, s57
    v_mfma_f32_16x16x32_bf16 v[124:127], v[100:103], v[84:87], v[124:127]
    buffer_store_dwordx4 v[88:91], v4, s[64:67], s20 offen sc1
    s_add_u32 s20, s20, s57
    v_mfma_f32_16x16x32_bf16 v[128:131], v[100:103], v[88:91], v[128:131]
    buffer_store_dwordx4 v[92:95], v4, s[64:67], s20 offen sc1
    s_add_u32 s20, s20, s57
    v_mfma_f32_16x16x32_bf16 v[132:135], v[100:103], v[92:95], v[132:135]
    s_mov_b32 s18, 3
    s_cmp_eq_u32 s19, 0
    s_cbranch_scc1 adaLN_cond__mha_block__mixer_gmlp__prompt_kernel_a_sl
    s_branch adaLN_cond__mha_block__mixer_gmlp__prompt_kernel_a_sbar
adaLN_cond__mha_block__mixer_gmlp__prompt_kernel_a_st2:
    s_cmp_eq_u32 s18, 3
    s_cbranch_scc0 adaLN_cond__mha_block__mixer_gmlp__prompt_kernel_a_st3
    s_cmp_eq_u32 s62, 0
    s_cselect_b32 s74, 0, 131072
    v_lshlrev_b32 v7, 2, v1
    s_add_u32 s20, s63, 81920
    s_add_u32 s21, s20, 14336
    s_bfm_b64 vcc, 16, 16
    v_cndmask_b32 v104, v104, v108, vcc
    v_cndmask_b32 v105, v105, v109, vcc
    s_bfm_b64 vcc, 16, 48
    v_cndmask_b32 v112, v112, v116, vcc
    v_cndmask_b32 v113, v113, v117, vcc
    s_bfm_b64 vcc, 32, 32
    v_cndmask_b32 v104, v104, v112, vcc
    v_cndmask_b32 v105, v105, v113, vcc
    buffer_atomic_add_f32 v104, v7, s[72:75], s20 offen offset:0
    buffer_atomic_add_f32 v105, v7, s[72:75], s21 offen offset:0
    s_bfm_b64 vcc, 16, 16
    v_cndmask_b32 v120, v120, v124, vcc
    v_cndmask_b32 v121, v121, v125, vcc
    s_bfm_b64 vcc, 16, 48
    v_cndmask_b32 v128, v128, v132, vcc
    v_cndmask_b32 v129, v129, v133, vcc
    s_bfm_b64 vcc, 32, 32
    v_cndmask_b32 v120, v120, v128, vcc
    v_cndmask_b32 v121, v121, v129, vcc
    buffer_atomic_add_f32 v120, v7, s[72:75], s20 offen offset:256
    buffer_atomic_add_f32 v121, v7, s[72:75], s21 offen offset:256
    ds_read_b64_tr_b16 v[32:33], v140 offset:0
    ds_read_b64_tr_b16 v[34:35], v140 offset:512
    ds_read_b64_tr_b16 v[36:37], v141 offset:0
    ds_read_b64_tr_b16 v[38:39], v141 offset:512
    ds_read_b64_tr_b16 v[40:41], v142 offset:0
    ds_read_b64_tr_b16 v[42:43], v142 offset:512
    ds_read_b64_tr_b16 v[44:45], v143 offset:0
    ds_read_b64_tr_b16 v[46:47], v143 offset:512
    ds_read_b64_tr_b16 v[48:49], v140 offset:4096
    ds_read_b64_tr_b16 v[50:51], v140 offset:4608
    ds_read_b64_tr_b16 v[52:53], v141 offset:4096
    ds_read_b64_tr_b16 v[54:55], v141 offset:4608
    ds_read_b64_tr_b16 v[56:57], v142 offset:4096
    ds_read_b64_tr_b16 v[58:59], v142 offset:4608
    ds_read_b64_tr_b16 v[60:61], v143 offset:4096
    ds_read_b64_tr_b16 v[62:63], v143 offset:4608
    ds_read_b64_tr_b16 v[64:65], v140 offset:8192
    ds_read_b64_tr_b16 v[66:67], v140 offset:8704
    ds_read_b64_tr_b16 v[68:69], v141 offset:8192
    ds_read_b64_tr_b16 v[70:71], v141 offset:8704
    ds_read_b64_tr_b16 v[72:73], v142 offset:8192
    ds_read_b64_tr_b16 v[74:75], v142 offset:8704
    ds_read_b64_tr_b16 v[76:77], v143 offset:8192
    ds_read_b64_tr_b16 v[78:79], v143 offset:8704
    ds_read_b64_tr_b16 v[80:81], v140 offset:12288
    ds_read_b64_tr_b16 v[82:83], v140 offset:12800
    ds_read_b64_tr_b16 v[84:85], v141 offset:12288
    ds_read_b64_tr_b16 v[86:87], v141 offset:12800
    ds_read_b64_tr_b16 v[88:89], v142 offset:12288
    ds_read_b64_tr_b16 v[90:91], v142 offset:12800
    ds_read_b64_tr_b16 v[92:93], v143 offset:12288
    ds_read_b64_tr_b16 v[94:95], v143 offset:12800
    s_waitcnt lgkmcnt(0)
    s_mov_b32 s18, 4
    s_cmp_eq_u32 s19, 0
    s_cbranch_scc1 adaLN_cond__mha_block__mixer_gmlp__prompt_kernel_a_sl
    s_branch adaLN_cond__mha_block__mixer_gmlp__prompt_kernel_a_sbar
adaLN_cond__mha_block__mixer_gmlp__prompt_kernel_a_st3:
    s_cmp_eq_u32 s18, 4
    s_cbranch_scc0 adaLN_cond__mha_block__mixer_gmlp__prompt_kernel_a_st4
    s_add_u32 s20, s60, 0
    buffer_store_dwordx4 v[32:35], v4, s[64:67], s20 offen sc1
    s_add_u32 s20, s20, s61
    buffer_store_dwordx4 v[36:39], v4, s[64:67], s20 offen sc1
    s_add_u32 s20, s20, s61
    buffer_store_dwordx4 v[40:43], v4, s[64:67], s20 offen sc1
    s_add_u32 s20, s20, s61
    buffer_store_dwordx4 v[44:47], v4, s[64:67], s20 offen sc1
    s_add_u32 s20, s20, s61
    buffer_store_dwordx4 v[64:67], v4, s[64:67], s20 offen sc1
    s_add_u32 s20, s20, s61
    buffer_store_dwordx4 v[68:71], v4, s[64:67], s20 offen sc1
    s_add_u32 s20, s20, s61
    buffer_store_dwordx4 v[72:75], v4, s[64:67], s20 offen sc1
    s_add_u32 s20, s20, s61
    buffer_store_dwordx4 v[76:79], v4, s[64:67], s20 offen sc1
    s_add_u32 s20, s20, s61
    s_cmp_eq_u32 s62, 0
    s_cselect_b32 s66, 14680064, 0
    s_add_u32 s20, s60, 1024
    buffer_store_dwordx4 v[48:51], v4, s[64:67], s20 offen sc1
    s_add_u32 s20, s20, s61
    buffer_store_dwordx4 v[52:55], v4, s[64:67], s20 offen sc1
    s_add_u32 s20, s20, s61
    buffer_store_dwordx4 v[56:59], v4, s[64:67], s20 offen sc1
    s_add_u32 s20, s20, s61
    buffer_store_dwordx4 v[60:63], v4, s[64:67], s20 offen sc1
    s_add_u32 s20, s20, s61
    buffer_store_dwordx4 v[80:83], v4, s[64:67], s20 offen sc1
    s_add_u32 s20, s20, s61
    buffer_store_dwordx4 v[84:87], v4, s[64:67], s20 offen sc1
    s_add_u32 s20, s20, s61
    buffer_store_dwordx4 v[88:91], v4, s[64:67], s20 offen sc1
    s_add_u32 s20, s20, s61
    buffer_store_dwordx4 v[92:95], v4, s[64:67], s20 offen sc1
    s_add_u32 s20, s20, s61
    s_mov_b32 s18, 5
    s_cmp_eq_u32 s19, 0
    s_cbranch_scc1 adaLN_cond__mha_block__mixer_gmlp__prompt_kernel_a_sl
    s_branch adaLN_cond__mha_block__mixer_gmlp__prompt_kernel_a_sbar
adaLN_cond__mha_block__mixer_gmlp__prompt_kernel_a_st4:
    s_cmp_eq_u32 s18, 5
    s_cbranch_scc0 adaLN_cond__mha_block__mixer_gmlp__prompt_kernel_a_st5
    s_lshl_b32 s21, s30, 3
    s_add_u32 s20, s5, s21
    s_mov_b32 s21, s4
    s_add_u32 s20, s20, 96
    s_mul_i32 s20, s20, 4352
    s_lshl_b32 s21, s21, 7
    s_add_u32 s20, s20, s21
    v_mov_b32 v2, s101
    v_mov_b32 v3, 0
    s_mov_b64 exec, 1
    buffer_store_dword v2, v3, s[96:99], s20 offen sc1
    s_mov_b64 exec, -1
    v_lshlrev_b32 v7, 7, v1
    s_add_u32 s21, s69, 8192
    buffer_load_dword v12, v7, s[12:15], s69 offen
    buffer_load_dword v13, v7, s[12:15], s21 offen
    s_mov_b32 s18, 6
    s_cmp_eq_u32 s19, 0
    s_cbranch_scc1 adaLN_cond__mha_block__mixer_gmlp__prompt_kernel_a_sl
    s_branch adaLN_cond__mha_block__mixer_gmlp__prompt_kernel_a_sbar
adaLN_cond__mha_block__mixer_gmlp__prompt_kernel_a_st5:
    s_cmp_eq_u32 s18, 6
    s_cbranch_scc0 adaLN_cond__mha_block__mixer_gmlp__prompt_kernel_a_st6
    s_cmp_eq_u32 s19, 0
    s_cbranch_scc1 adaLN_cond__mha_block__mixer_gmlp__prompt_kernel_a_schk
    s_branch adaLN_cond__mha_block__mixer_gmlp__prompt_kernel_a_sbar
adaLN_cond__mha_block__mixer_gmlp__prompt_kernel_a_st6:
adaLN_cond__mha_block__mixer_gmlp__prompt_kernel_a_sbar:
    s_barrier
    s_sub_u32 s19, s19, 1
    s_branch adaLN_cond__mha_block__mixer_gmlp__prompt_kernel_a_sl
adaLN_cond__mha_block__mixer_gmlp__prompt_kernel_a_schk:
    s_barrier
    v_mov_b32 v7, 0
    ds_read_b128 v[12:15], v7
    s_waitcnt lgkmcnt(0)
    v_or3_b32 v12, v12, v13, v14
    v_or_b32 v12, v12, v15
    s_nop 0
    v_readfirstlane_b32 s20, v12
    s_nop 3
    s_cmp_eq_u32 s20, 0
    s_cbranch_scc1 adaLN_cond__mha_block__mixer_gmlp__prompt_kernel_a_hend
    s_barrier
    s_barrier
    s_barrier
    s_barrier
    s_barrier
    s_barrier
    s_barrier
    s_barrier
    s_barrier
    s_barrier
    s_barrier
    s_barrier
    s_barrier
    s_barrier
    s_barrier
    s_barrier
    s_barrier
    s_barrier
    s_barrier
    s_barrier
    s_branch adaLN_cond__mha_block__mixer_gmlp__prompt_kernel_a_schk
adaLN_cond__mha_block__mixer_gmlp__prompt_kernel_a_hend:
    s_and_b32 s20, s2, 7
    s_lshr_b32 s21, s2, 3
    s_and_b32 s4, s20, 3
    s_lshl_b32 s4, s4, 3
    s_and_b32 s22, s21, 7
    s_add_u32 s4, s4, s22
    s_lshr_b32 s5, s20, 2
    s_mul_i32 s5, s5, 4
    s_lshr_b32 s22, s21, 3
    s_add_u32 s5, s5, s22
    s_setprio 0
    s_add_u32 s8, s36, 6291456
    s_addc_u32 s9, s37, 0
    s_mov_b32 s10, 4194304
    s_mov_b32 s11, 0x20000
    s_add_u32 s12, s36, 31457280
    s_addc_u32 s13, s37, 0
    s_mov_b32 s14, 2097152
    s_mov_b32 s15, 0x20000
    v_and_b32 v1, 63, v0
    s_mul_i32 s20, s4, 4
    s_lshr_b32 s21, s3, 1
    s_add_u32 s20, s20, s21
    s_mul_i32 s20, s20, 32768
    s_and_b32 s21, s3, 1
    s_lshl_b32 s21, s21, 10
    s_add_u32 s20, s20, s21
    v_lshlrev_b32 v2, 4, v1
    v_add_u32 v8, s20, v2
    v_add_u32 v9, 65536, v8
    s_mul_i32 s20, s5, 8
    s_lshr_b32 s21, s3, 1
    s_add_u32 s20, s20, s21
    s_mul_i32 s20, s20, 32768
    s_and_b32 s21, s3, 1
    s_lshl_b32 s21, s21, 10
    s_add_u32 s20, s20, s21
    v_lshlrev_b32 v2, 4, v1
    v_add_u32 v10, s20, v2
    v_add_u32 v11, 65536, v10
    v_add_u32 v12, 131072, v10
    v_add_u32 v13, 196608, v10
    s_mov_b32 s16, 0
    s_mov_b32 s17, 0
    s_lshl_b32 s18, s3, 10
    s_add_u32 s23, s18, 147456
    s_mov_b32 s24, s76
    s_mov_b32 s25, s77
    s_mov_b32 s26, 4194304
    s_mov_b32 s27, 0x20000
    s_mov_b32 s40, s36
    s_mov_b32 s41, s37
    s_mov_b32 s42, 24576
    s_mov_b32 s43, 0x20000
    v_lshrrev_b32 v2, 4, v1
    v_and_b32 v3, 15, v1
    s_lshl_b32 s20, s4, 6
    s_lshl_b32 s21, s3, 4
    s_add_u32 s20, s20, s21
    s_lshl_b32 s20, s20, 11
    s_lshl_b32 s21, s5, 8
    s_add_u32 s20, s20, s21
    v_add_u32 v4, 0, v2
    v_xor_b32 v5, v4, v3
    v_lshlrev_b32 v5, 4, v5
    v_lshl_add_u32 v5, v4, 11, v5
    v_add_u32 v40, s20, v5
    v_add_u32 v4, 4, v2
    v_xor_b32 v5, v4, v3
    v_lshlrev_b32 v5, 4, v5
    v_lshl_add_u32 v5, v4, 11, v5
    v_add_u32 v41, s20, v5
    v_add_u32 v4, 8, v2
    v_xor_b32 v5, v4, v3
    v_lshlrev_b32 v5, 4, v5
    v_lshl_add_u32 v5, v4, 11, v5
    v_add_u32 v42, s20, v5
    v_add_u32 v4, 12, v2
    v_xor_b32 v5, v4, v3
    v_lshlrev_b32 v5, 4, v5
    v_lshl_add_u32 v5, v4, 11, v5
    v_add_u32 v43, s20, v5
    v_lshrrev_b32 v4, 5, v1
    v_lshlrev_b32 v4, 13, v4
    v_and_b32 v5, 31, v1
    v_lshl_add_u32 v4, v5, 4, v4
    s_lshl_b32 s21, s5, 9
    s_add_u32 s21, s21, 8192
    v_add_u32 v44, s21, v4
    s_add_u32 s22, s18, 0
    s_add_u32 m0, s22, 8192
    s_nop 0
    buffer_load_dwordx4 v10, s[12:15], s17 offen sc1 lds
    s_add_u32 m0, s22, 12288
    s_nop 0
    buffer_load_dwordx4 v11, s[12:15], s17 offen sc1 lds
    s_add_u32 m0, s22, 16384
    s_nop 0
    buffer_load_dwordx4 v12, s[12:15], s17 offen sc1 lds
    s_add_u32 m0, s22, 20480
    s_nop 0
    buffer_load_dwordx4 v13, s[12:15], s17 offen sc1 lds
    s_add_u32 s17, s17, 2048
    s_barrier
    s_add_u32 s22, s18, 24576
    s_add_u32 m0, s22, 8192
    s_nop 0
    buffer_load_dwordx4 v10, s[12:15], s17 offen sc1 lds
    s_add_u32 m0, s22, 12288
    s_nop 0
    buffer_load_dwordx4 v11, s[12:15], s17 offen sc1 lds
    s_add_u32 m0, s22, 16384
    s_nop 0
    buffer_load_dwordx4 v12, s[12:15], s17 offen sc1 lds
    s_add_u32 m0, s22, 20480
    s_nop 0
    buffer_load_dwordx4 v13, s[12:15], s17 offen sc1 lds
    s_add_u32 s17, s17, 2048
    s_add_u32 s22, s18, 49152
    s_add_u32 m0, s22, 8192
    s_nop 0
    buffer_load_dwordx4 v10, s[12:15], s17 offen sc1 lds
    s_add_u32 m0, s22, 12288
    s_nop 0
    buffer_load_dwordx4 v11, s[12:15], s17 offen sc1 lds
    s_add_u32 m0, s22, 16384
    s_nop 0
    buffer_load_dwordx4 v12, s[12:15], s17 offen sc1 lds
    s_add_u32 m0, s22, 20480
    s_nop 0
    buffer_load_dwordx4 v13, s[12:15], s17 offen sc1 lds
    s_add_u32 s17, s17, 2048
    s_add_u32 s22, s18, 73728
    s_add_u32 m0, s22, 8192
    s_nop 0
    buffer_load_dwordx4 v10, s[12:15], s17 offen sc1 lds
    s_add_u32 m0, s22, 12288
    s_nop 0
    buffer_load_dwordx4 v11, s[12:15], s17 offen sc1 lds
    s_add_u32 m0, s22, 16384
    s_nop 0
    buffer_load_dwordx4 v12, s[12:15], s17 offen sc1 lds
    s_add_u32 m0, s22, 20480
    s_nop 0
    buffer_load_dwordx4 v13, s[12:15], s17 offen sc1 lds
    s_add_u32 s17, s17, 2048
    s_add_u32 s22, s18, 98304
    s_add_u32 m0, s22, 8192
    s_nop 0
    buffer_load_dwordx4 v10, s[12:15], s17 offen sc1 lds
    s_add_u32 m0, s22, 12288
    s_nop 0
    buffer_load_dwordx4 v11, s[12:15], s17 offen sc1 lds
    s_add_u32 m0, s22, 16384
    s_nop 0
    buffer_load_dwordx4 v12, s[12:15], s17 offen sc1 lds
    s_add_u32 m0, s22, 20480
    s_nop 0
    buffer_load_dwordx4 v13, s[12:15], s17 offen sc1 lds
    s_add_u32 s17, s17, 2048
    s_add_u32 s22, s18, 122880
    s_add_u32 m0, s22, 8192
    s_nop 0
    buffer_load_dwordx4 v10, s[12:15], s17 offen sc1 lds
    s_add_u32 m0, s22, 12288
    s_nop 0
    buffer_load_dwordx4 v11, s[12:15], s17 offen sc1 lds
    s_add_u32 m0, s22, 16384
    s_nop 0
    buffer_load_dwordx4 v12, s[12:15], s17 offen sc1 lds
    s_add_u32 m0, s22, 20480
    s_nop 0
    buffer_load_dwordx4 v13, s[12:15], s17 offen sc1 lds
    s_add_u32 s17, s17, 2048
    s_barrier
    s_add_u32 s22, s18, 0
    s_add_u32 m0, s22, 0
    s_nop 0
    buffer_load_dwordx4 v8, s[8:11], s16 offen sc1 lds
    s_add_u32 m0, s22, 4096
    s_nop 0
    buffer_load_dwordx4 v9, s[8:11], s16 offen sc1 lds
    s_add_u32 s16, s16, 2048
    s_add_u32 s22, s18, 24576
    s_add_u32 m0, s22, 0
    s_nop 0
    buffer_load_dwordx4 v8, s[8:11], s16 offen sc1 lds
    s_add_u32 m0, s22, 4096
    s_nop 0
    buffer_load_dwordx4 v9, s[8:11], s16 offen sc1 lds
    s_add_u32 s16, s16, 2048
    s_add_u32 s22, s18, 49152
    s_add_u32 m0, s22, 0
    s_nop 0
    buffer_load_dwordx4 v8, s[8:11], s16 offen sc1 lds
    s_add_u32 m0, s22, 4096
    s_nop 0
    buffer_load_dwordx4 v9, s[8:11], s16 offen sc1 lds
    s_add_u32 s16, s16, 2048
    s_add_u32 s22, s18, 73728
    s_add_u32 m0, s22, 0
    s_nop 0
    buffer_load_dwordx4 v8, s[8:11], s16 offen sc1 lds
    s_add_u32 m0, s22, 4096
    s_nop 0
    buffer_load_dwordx4 v9, s[8:11], s16 offen sc1 lds
    s_add_u32 s16, s16, 2048
    s_add_u32 s22, s18, 98304
    s_add_u32 m0, s22, 0
    s_nop 0
    buffer_load_dwordx4 v8, s[8:11], s16 offen sc1 lds
    s_add_u32 m0, s22, 4096
    s_nop 0
    buffer_load_dwordx4 v9, s[8:11], s16 offen sc1 lds
    s_add_u32 s16, s16, 2048
    s_add_u32 s22, s18, 122880
    s_add_u32 m0, s22, 0
    s_nop 0
    buffer_load_dwordx4 v8, s[8:11], s16 offen sc1 lds
    s_add_u32 m0, s22, 4096
    s_nop 0
    buffer_load_dwordx4 v9, s[8:11], s16 offen sc1 lds
    s_add_u32 s16, s16, 2048
    s_waitcnt vmcnt(10)
    s_barrier
    s_waitcnt vmcnt(8)
    s_barrier
    s_add_u32 m0, s18, 0
    s_nop 0
    buffer_load_dwordx4 v8, s[8:11], s16 offen sc1 lds
    s_add_u32 m0, s18, 4096
    s_nop 0
    buffer_load_dwordx4 v9, s[8:11], s16 offen sc1 lds
    s_add_u32 s16, s16, 2048
    s_add_u32 m0, s18, 8192
    s_nop 0
    buffer_load_dwordx4 v10, s[12:15], s17 offen sc1 lds
    s_add_u32 m0, s18, 12288
    s_nop 0
    buffer_load_dwordx4 v11, s[12:15], s17 offen sc1 lds
    s_add_u32 m0, s18, 16384
    s_nop 0
    buffer_load_dwordx4 v12, s[12:15], s17 offen sc1 lds
    s_add_u32 m0, s18, 20480
    s_nop 0
    buffer_load_dwordx4 v13, s[12:15], s17 offen sc1 lds
    s_add_u32 s17, s17, 2048
    s_add_u32 s18, s18, 24576
    s_cmp_ge_u32 s18, s23
    s_cselect_b32 s20, 147456, 0
    s_sub_u32 s18, s18, s20
    s_waitcnt vmcnt(12)
    s_barrier
    s_add_u32 m0, s18, 0
    s_nop 0
    buffer_load_dwordx4 v8, s[8:11], s16 offen sc1 lds
    s_add_u32 m0, s18, 4096
    s_nop 0
    buffer_load_dwordx4 v9, s[8:11], s16 offen sc1 lds
    s_add_u32 s16, s16, 2048
    s_add_u32 m0, s18, 8192
    s_nop 0
    buffer_load_dwordx4 v10, s[12:15], s17 offen sc1 lds
    s_add_u32 m0, s18, 12288
    s_nop 0
    buffer_load_dwordx4 v11, s[12:15], s17 offen sc1 lds
    s_add_u32 m0, s18, 16384
    s_nop 0
    buffer_load_dwordx4 v12, s[12:15], s17 offen sc1 lds
    s_add_u32 m0, s18, 20480
    s_nop 0
    buffer_load_dwordx4 v13, s[12:15], s17 offen sc1 lds
    s_add_u32 s17, s17, 2048
    s_add_u32 s18, s18, 24576
    s_cmp_ge_u32 s18, s23
    s_cselect_b32 s20, 147456, 0
    s_sub_u32 s18, s18, s20
    s_waitcnt vmcnt(16)
    s_barrier
    s_add_u32 m0, s18, 0
    s_nop 0
    buffer_load_dwordx4 v8, s[8:11], s16 offen sc1 lds
    s_add_u32 m0, s18, 4096
    s_nop 0
    buffer_load_dwordx4 v9, s[8:11], s16 offen sc1 lds
    s_add_u32 s16, s16, 2048
    s_add_u32 m0, s18, 8192
    s_nop 0
    buffer_load_dwordx4 v10, s[12:15], s17 offen sc1 lds
    s_add_u32 m0, s18, 12288
    s_nop 0
    buffer_load_dwordx4 v11, s[12:15], s17 offen sc1 lds
    s_add_u32 m0, s18, 16384
    s_nop 0
    buffer_load_dwordx4 v12, s[12:15], s17 offen sc1 lds
    s_add_u32 m0, s18, 20480
    s_nop 0
    buffer_load_dwordx4 v13, s[12:15], s17 offen sc1 lds
    s_add_u32 s17, s17, 2048
    s_add_u32 s18, s18, 24576
    s_cmp_ge_u32 s18, s23
    s_cselect_b32 s20, 147456, 0
    s_sub_u32 s18, s18, s20
    s_waitcnt vmcnt(20)
    s_barrier
    s_add_u32 m0, s18, 0
    s_nop 0
    buffer_load_dwordx4 v8, s[8:11], s16 offen sc1 lds
    s_add_u32 m0, s18, 4096
    s_nop 0
    buffer_load_dwordx4 v9, s[8:11], s16 offen sc1 lds
    s_add_u32 s16, s16, 2048
    s_add_u32 m0, s18, 8192
    s_nop 0
    buffer_load_dwordx4 v10, s[12:15], s17 offen sc1 lds
    s_add_u32 m0, s18, 12288
    s_nop 0
    buffer_load_dwordx4 v11, s[12:15], s17 offen sc1 lds
    s_add_u32 m0, s18, 16384
    s_nop 0
    buffer_load_dwordx4 v12, s[12:15], s17 offen sc1 lds
    s_add_u32 m0, s18, 20480
    s_nop 0
    buffer_load_dwordx4 v13, s[12:15], s17 offen sc1 lds
    s_add_u32 s17, s17, 2048
    s_add_u32 s18, s18, 24576
    s_cmp_ge_u32 s18, s23
    s_cselect_b32 s20, 147456, 0
    s_sub_u32 s18, s18, s20
    s_mov_b32 s19, 6
adaLN_cond__mha_block__mixer_gmlp__prompt_kernel_p_ld_loop0:
    s_waitcnt vmcnt(24)
    s_barrier
    s_add_u32 m0, s18, 0
    s_nop 0
    buffer_load_dwordx4 v8, s[8:11], s16 offen sc1 lds
    s_add_u32 m0, s18, 4096
    s_nop 0
    buffer_load_dwordx4 v9, s[8:11], s16 offen sc1 lds
    s_add_u32 s16, s16, 2048
    s_add_u32 m0, s18, 8192
    s_nop 0
    buffer_load_dwordx4 v10, s[12:15], s17 offen sc1 lds
    s_add_u32 m0, s18, 12288
    s_nop 0
    buffer_load_dwordx4 v11, s[12:15], s17 offen sc1 lds
    s_add_u32 m0, s18, 16384
    s_nop 0
    buffer_load_dwordx4 v12, s[12:15], s17 offen sc1 lds
    s_add_u32 m0, s18, 20480
    s_nop 0
    buffer_load_dwordx4 v13, s[12:15], s17 offen sc1 lds
    s_add_u32 s17, s17, 2048
    s_add_u32 s18, s18, 24576
    s_cmp_ge_u32 s18, s23
    s_cselect_b32 s20, 147456, 0
    s_sub_u32 s18, s18, s20
    s_sub_u32 s19, s19, 1
    s_cmp_lg_u32 s19, 0
    s_cbranch_scc1 adaLN_cond__mha_block__mixer_gmlp__prompt_kernel_p_ld_loop0
    s_waitcnt vmcnt(24)
    s_barrier
    s_lshl_b32 s20, s3, 12
    s_add_u32 m0, s20, 98304
    s_nop 0
    buffer_load_dwordx4 v40, s[24:27], 0 offen sc1 lds
    s_add_u32 m0, s20, 99328
    s_nop 0
    buffer_load_dwordx4 v41, s[24:27], 0 offen sc1 lds
    s_add_u32 m0, s20, 100352
    s_nop 0
    buffer_load_dwordx4 v42, s[24:27], 0 offen sc1 lds
    s_add_u32 m0, s20, 101376
    s_nop 0
    buffer_load_dwordx4 v43, s[24:27], 0 offen sc1 lds
    buffer_load_dwordx4 v[48:51], v44, s[40:43], 0 offen sc1
    s_waitcnt vmcnt(23)
    s_barrier
    s_waitcnt vmcnt(17)
    s_barrier
    s_waitcnt vmcnt(11)
    s_barrier
    s_waitcnt vmcnt(5)
    s_barrier
    s_waitcnt vmcnt(0)
    v_lshrrev_b32 v2, 5, v1
    v_cvt_f32_u32 v2, v2
    v_cvt_pk_bf16_f32 v48, v48, v48
    v_and_b32 v48, 0xffff0000, v48
    v_add_f32 v48, v48, v2
    v_cvt_pk_bf16_f32 v48, v48, v48
    v_and_b32 v48, 0xffff0000, v48
    v_cvt_pk_bf16_f32 v49, v49, v49
    v_and_b32 v49, 0xffff0000, v49
    v_add_f32 v49, v49, v2
    v_cvt_pk_bf16_f32 v49, v49, v49
    v_and_b32 v49, 0xffff0000, v49
    v_cvt_pk_bf16_f32 v50, v50, v50
    v_and_b32 v50, 0xffff0000, v50
    v_add_f32 v50, v50, v2
    v_cvt_pk_bf16_f32 v50, v50, v50
    v_and_b32 v50, 0xffff0000, v50
    v_cvt_pk_bf16_f32 v51, v51, v51
    v_and_b32 v51, 0xffff0000, v51
    v_add_f32 v51, v51, v2
    v_cvt_pk_bf16_f32 v51, v51, v51
    v_and_b32 v51, 0xffff0000, v51
    v_lshlrev_b32 v2, 4, v1
    v_add_u32 v2, 114688, v2
    ds_write_b128 v2, v[48:51]
    s_waitcnt lgkmcnt(0)
    s_barrier
    s_barrier
    s_and_b32 s20, s2, 7
    s_lshr_b32 s21, s2, 3
    s_and_b32 s4, s20, 1
    s_lshl_b32 s4, s4, 3
    s_and_b32 s22, s21, 7
    s_add_u32 s4, s4, s22
    s_lshr_b32 s5, s20, 1
    s_mul_i32 s5, s5, 4
    s_lshr_b32 s22, s21, 3
    s_add_u32 s5, s5, s22
    s_setprio 0
    s_add_u32 s8, s36, 2097152
    s_addc_u32 s9, s37, 0
    s_mov_b32 s10, 4194304
    s_mov_b32 s11, 0x20000
    s_add_u32 s12, s36, 33554432
    s_addc_u32 s13, s37, 0
    s_mov_b32 s14, 7340032
    s_mov_b32 s15, 0x20000
    v_and_b32 v1, 63, v0
    s_mul_i32 s20, s4, 8
    s_lshr_b32 s21, s3, 1
    s_add_u32 s20, s20, s21
    s_mul_i32 s20, s20, 32768
    s_and_b32 s21, s3, 1
    s_lshl_b32 s21, s21, 10
    s_add_u32 s20, s20, s21
    v_lshlrev_b32 v2, 4, v1
    v_add_u32 v8, s20, v2
    v_add_u32 v9, 65536, v8
    v_add_u32 v10, 131072, v8
    v_add_u32 v11, 196608, v8
    s_mul_i32 s20, s5, 14
    s_lshr_b32 s21, s3, 1
    s_add_u32 s20, s20, s21
    s_mul_i32 s20, s20, 32768
    s_and_b32 s21, s3, 1
    s_lshl_b32 s21, s21, 10
    s_add_u32 s20, s20, s21
    v_lshlrev_b32 v2, 4, v1
    v_add_u32 v12, s20, v2
    v_add_u32 v13, 65536, v12
    v_add_u32 v14, 131072, v12
    v_add_u32 v15, 196608, v12
    v_add_u32 v16, 262144, v12
    v_add_u32 v17, 327680, v12
    v_add_u32 v18, 393216, v12
    s_cmp_lt_u32 s3, 2
    s_mov_b32 s20, 113
    s_cmov_b32 s20, 112
    s_mul_i32 s22, s5, 7
    s_add_u32 s20, s20, s22
    s_mul_i32 s20, s20, 32768
    s_add_u32 s20, s20, s21
    v_add_u32 v12, s20, v2
    s_cmp_lt_u32 s3, 2
    s_mov_b32 s20, 115
    s_cmov_b32 s20, 114
    s_mul_i32 s22, s5, 7
    s_add_u32 s20, s20, s22
    s_mul_i32 s20, s20, 32768
    s_add_u32 s20, s20, s21
    v_add_u32 v13, s20, v2
    s_cmp_lt_u32 s3, 2
    s_cselect_b32 s20, 0, 1
    s_mul_i32 s22, s5, 7
    s_add_u32 s20, s20, s22
    s_mul_i32 s20, s20, 32768
    s_add_u32 s20, s20, s21
    v_add_u32 v14, s20, v2
    s_cmp_lt_u32 s3, 2
    s_cselect_b32 s20, 2, 116
    s_mul_i32 s22, s5, 7
    s_add_u32 s20, s20, s22
    s_mul_i32 s20, s20, 32768
    s_add_u32 s20, s20, s21
    v_add_u32 v15, s20, v2
    s_cmp_lt_u32 s3, 2
    s_mov_b32 s20, 118
    s_cmov_b32 s20, 117
    s_mul_i32 s22, s5, 7
    s_add_u32 s20, s20, s22
    s_mul_i32 s20, s20, 32768
    s_add_u32 s20, s20, s21
    v_add_u32 v16, s20, v2
    s_cmp_lt_u32 s3, 2
    s_cselect_b32 s20, 3, 4
    s_mul_i32 s22, s5, 7
    s_add_u32 s20, s20, s22
    s_mul_i32 s20, s20, 32768
    s_add_u32 s20, s20, s21
    v_add_u32 v17, s20, v2
    s_cmp_lt_u32 s3, 2
    s_cselect_b32 s20, 5, 6
    s_mul_i32 s22, s5, 7
    s_add_u32 s20, s20, s22
    s_mul_i32 s20, s20, 32768
    s_add_u32 s20, s20, s21
    v_add_u32 v18, s20, v2
    s_mov_b32 s16, 0
    s_mov_b32 s17, 0
    s_lshl_b32 s18, s3, 10
    s_add_u32 s23, s18, 135168
    s_add_u32 s22, s18, 0
    s_add_u32 m0, s22, 16384
    s_nop 0
    buffer_load_dwordx4 v12, s[12:15], s17 offen sc1 lds
    s_add_u32 m0, s22, 20480
    s_nop 0
    buffer_load_dwordx4 v13, s[12:15], s17 offen sc1 lds
    s_add_u32 m0, s22, 24576
    s_nop 0
    buffer_load_dwordx4 v14, s[12:15], s17 offen sc1 lds
    s_add_u32 m0, s22, 28672
    s_nop 0
    buffer_load_dwordx4 v15, s[12:15], s17 offen sc1 lds
    s_add_u32 m0, s22, 32768
    s_nop 0
    buffer_load_dwordx4 v16, s[12:15], s17 offen sc1 lds
    s_add_u32 m0, s22, 36864
    s_nop 0
    buffer_load_dwordx4 v17, s[12:15], s17 offen sc1 lds
    s_add_u32 m0, s22, 40960
    s_nop 0
    buffer_load_dwordx4 v18, s[12:15], s17 offen sc1 lds
    s_add_u32 s17, s17, 2048
    s_barrier
    s_add_u32 s22, s18, 45056
    s_add_u32 m0, s22, 16384
    s_nop 0
    buffer_load_dwordx4 v12, s[12:15], s17 offen sc1 lds
    s_add_u32 m0, s22, 20480
    s_nop 0
    buffer_load_dwordx4 v13, s[12:15], s17 offen sc1 lds
    s_add_u32 m0, s22, 24576
    s_nop 0
    buffer_load_dwordx4 v14, s[12:15], s17 offen sc1 lds
    s_add_u32 m0, s22, 28672
    s_nop 0
    buffer_load_dwordx4 v15, s[12:15], s17 offen sc1 lds
    s_add_u32 m0, s22, 32768
    s_nop 0
    buffer_load_dwordx4 v16, s[12:15], s17 offen sc1 lds
    s_add_u32 m0, s22, 36864
    s_nop 0
    buffer_load_dwordx4 v17, s[12:15], s17 offen sc1 lds
    s_add_u32 m0, s22, 40960
    s_nop 0
    buffer_load_dwordx4 v18, s[12:15], s17 offen sc1 lds
    s_add_u32 s17, s17, 2048
    s_add_u32 s22, s18, 90112
    s_add_u32 m0, s22, 16384
    s_nop 0
    buffer_load_dwordx4 v12, s[12:15], s17 offen sc1 lds
    s_add_u32 m0, s22, 20480
    s_nop 0
    buffer_load_dwordx4 v13, s[12:15], s17 offen sc1 lds
    s_add_u32 m0, s22, 24576
    s_nop 0
    buffer_load_dwordx4 v14, s[12:15], s17 offen sc1 lds
    s_add_u32 m0, s22, 28672
    s_nop 0
    buffer_load_dwordx4 v15, s[12:15], s17 offen sc1 lds
    s_add_u32 m0, s22, 32768
    s_nop 0
    buffer_load_dwordx4 v16, s[12:15], s17 offen sc1 lds
    s_add_u32 m0, s22, 36864
    s_nop 0
    buffer_load_dwordx4 v17, s[12:15], s17 offen sc1 lds
    s_add_u32 m0, s22, 40960
    s_nop 0
    buffer_load_dwordx4 v18, s[12:15], s17 offen sc1 lds
    s_add_u32 s17, s17, 2048
    s_barrier
    s_mov_b32 s40, s36
    s_mov_b32 s41, s37
    s_mov_b32 s42, 131072
    s_mov_b32 s43, 0x20000
    s_cmp_ge_u32 s3, 2
    s_cbranch_scc1 adaLN_cond__mha_block__mixer_gmlp__prompt_kernel_w_lp1
    s_mul_i32 s20, s3, 14336
    s_mul_i32 s21, s5, 448
    s_add_u32 s20, s20, s21
    s_add_u32 s20, s20, 81920
    v_lshlrev_b32 v30, 4, v1
    v_add_u32 v31, 7168, v30
    v_cmp_le_u32 vcc, 16, v1
    v_add_u32 v29, 4294967040, v30
    s_nop 0
    v_cndmask_b32 v31, v31, v29, vcc
    v_cmp_le_u32 vcc, 28, v1
    v_add_u32 v29, 6976, v30
    s_nop 0
    v_cndmask_b32 v31, v31, v29, vcc
    v_cmp_le_u32 vcc, 40, v1
    v_add_u32 v29, 4294966848, v30
    s_nop 0
    v_cndmask_b32 v31, v31, v29, vcc
    buffer_load_dwordx4 v[32:35], v31, s[40:43], s20 offen sc1
    s_branch adaLN_cond__mha_block__mixer_gmlp__prompt_kernel_w_lp2
adaLN_cond__mha_block__mixer_gmlp__prompt_kernel_w_lp1:
    s_lshl_b32 s20, s4, 1
    s_add_u32 s20, s20, s3
    s_sub_u32 s20, s20, 2
    s_lshl_b32 s20, s20, 9
    s_add_u32 s20, s20, 65536
    v_lshlrev_b32 v30, 3, v1
    buffer_load_dwordx2 v[32:33], v30, s[40:43], s20 offen sc1
adaLN_cond__mha_block__mixer_gmlp__prompt_kernel_w_lp2:
    s_add_u32 s22, s18, 0
    s_add_u32 m0, s22, 0
    s_nop 0
    buffer_load_dwordx4 v8, s[8:11], s16 offen sc1 lds
    s_add_u32 m0, s22, 4096
    s_nop 0
    buffer_load_dwordx4 v9, s[8:11], s16 offen sc1 lds
    s_add_u32 m0, s22, 8192
    s_nop 0
    buffer_load_dwordx4 v10, s[8:11], s16 offen sc1 lds
    s_add_u32 m0, s22, 12288
    s_nop 0
    buffer_load_dwordx4 v11, s[8:11], s16 offen sc1 lds
    s_add_u32 s16, s16, 2048
    s_add_u32 s22, s18, 45056
    s_add_u32 m0, s22, 0
    s_nop 0
    buffer_load_dwordx4 v8, s[8:11], s16 offen sc1 lds
    s_add_u32 m0, s22, 4096
    s_nop 0
    buffer_load_dwordx4 v9, s[8:11], s16 offen sc1 lds
    s_add_u32 m0, s22, 8192
    s_nop 0
    buffer_load_dwordx4 v10, s[8:11], s16 offen sc1 lds
    s_add_u32 m0, s22, 12288
    s_nop 0
    buffer_load_dwordx4 v11, s[8:11], s16 offen sc1 lds
    s_add_u32 s16, s16, 2048
    s_add_u32 s22, s18, 90112
    s_add_u32 m0, s22, 0
    s_nop 0
    buffer_load_dwordx4 v8, s[8:11], s16 offen sc1 lds
    s_add_u32 m0, s22, 4096
    s_nop 0
    buffer_load_dwordx4 v9, s[8:11], s16 offen sc1 lds
    s_add_u32 m0, s22, 8192
    s_nop 0
    buffer_load_dwordx4 v10, s[8:11], s16 offen sc1 lds
    s_add_u32 m0, s22, 12288
    s_nop 0
    buffer_load_dwordx4 v11, s[8:11], s16 offen sc1 lds
    s_add_u32 s16, s16, 2048
    s_waitcnt vmcnt(8)
    s_barrier
    s_cmp_ge_u32 s3, 2
    s_cbranch_scc1 adaLN_cond__mha_block__mixer_gmlp__prompt_kernel_w_lq1
    s_mul_i32 s20, s3, 896
    s_add_u32 s20, s20, 135168
    v_add_u32 v30, s20, v30
    s_bfm_b64 exec, 56, 0
    ds_write_b128 v30, v[32:35]
    s_mov_b64 exec, -1
    s_branch adaLN_cond__mha_block__mixer_gmlp__prompt_kernel_w_lq2
adaLN_cond__mha_block__mixer_gmlp__prompt_kernel_w_lq1:
    v_mul_f32 v32, 0x3a800000, v32
    v_mul_f32 v33, 0x3a800000, v33
    v_fma_f32 v33, -v32, v32, v33
    v_max_f32 v33, 0, v33
    v_add_f32 v33, 0x3727c5ac, v33
    v_rsq_f32 v34, v33
    s_nop 0
    v_mul_f32_e64 v33, -v32, v34
    v_mov_b32 v32, v34
    s_lshl_b32 s20, s3, 9
    s_add_u32 s20, s20, 136192
    v_add_u32 v30, s20, v30
    ds_write_b64 v30, v[32:33]
adaLN_cond__mha_block__mixer_gmlp__prompt_kernel_w_lq2:
    s_waitcnt lgkmcnt(0)
    s_waitcnt vmcnt(4)
    s_barrier
    s_add_u32 m0, s18, 0
    s_nop 0
    buffer_load_dwordx4 v8, s[8:11], s16 offen sc1 lds
    s_add_u32 m0, s18, 4096
    s_nop 0
    buffer_load_dwordx4 v9, s[8:11], s16 offen sc1 lds
    s_add_u32 m0, s18, 8192
    s_nop 0
    buffer_load_dwordx4 v10, s[8:11], s16 offen sc1 lds
    s_add_u32 m0, s18, 12288
    s_nop 0
    buffer_load_dwordx4 v11, s[8:11], s16 offen sc1 lds
    s_add_u32 s16, s16, 2048
    s_add_u32 m0, s18, 16384
    s_nop 0
    buffer_load_dwordx4 v12, s[12:15], s17 offen sc1 lds
    s_add_u32 m0, s18, 20480
    s_nop 0
    buffer_load_dwordx4 v13, s[12:15], s17 offen sc1 lds
    s_add_u32 m0, s18, 24576
    s_nop 0
    buffer_load_dwordx4 v14, s[12:15], s17 offen sc1 lds
    s_add_u32 m0, s18, 28672
    s_nop 0
    buffer_load_dwordx4 v15, s[12:15], s17 offen sc1 lds
    s_add_u32 m0, s18, 32768
    s_nop 0
    buffer_load_dwordx4 v16, s[12:15], s17 offen sc1 lds
    s_add_u32 m0, s18, 36864
    s_nop 0
    buffer_load_dwordx4 v17, s[12:15], s17 offen sc1 lds
    s_add_u32 m0, s18, 40960
    s_nop 0
    buffer_load_dwordx4 v18, s[12:15], s17 offen sc1 lds
    s_add_u32 s17, s17, 2048
    s_add_u32 s18, s18, 45056
    s_cmp_ge_u32 s18, s23
    s_cselect_b32 s20, 135168, 0
    s_sub_u32 s18, s18, s20
    s_mov_b32 s19, 12
adaLN_cond__mha_block__mixer_gmlp__prompt_kernel_w_ld_loop0:
    s_waitcnt vmcnt(11)
    s_barrier
    s_add_u32 m0, s18, 0
    s_nop 0
    buffer_load_dwordx4 v8, s[8:11], s16 offen sc1 lds
    s_add_u32 m0, s18, 4096
    s_nop 0
    buffer_load_dwordx4 v9, s[8:11], s16 offen sc1 lds
    s_add_u32 m0, s18, 8192
    s_nop 0
    buffer_load_dwordx4 v10, s[8:11], s16 offen sc1 lds
    s_add_u32 m0, s18, 12288
    s_nop 0
    buffer_load_dwordx4 v11, s[8:11], s16 offen sc1 lds
    s_add_u32 s16, s16, 2048
    s_add_u32 m0, s18, 16384
    s_nop 0
    buffer_load_dwordx4 v12, s[12:15], s17 offen sc1 lds
    s_add_u32 m0, s18, 20480
    s_nop 0
    buffer_load_dwordx4 v13, s[12:15], s17 offen sc1 lds
    s_add_u32 m0, s18, 24576
    s_nop 0
    buffer_load_dwordx4 v14, s[12:15], s17 offen sc1 lds
    s_add_u32 m0, s18, 28672
    s_nop 0
    buffer_load_dwordx4 v15, s[12:15], s17 offen sc1 lds
    s_add_u32 m0, s18, 32768
    s_nop 0
    buffer_load_dwordx4 v16, s[12:15], s17 offen sc1 lds
    s_add_u32 m0, s18, 36864
    s_nop 0
    buffer_load_dwordx4 v17, s[12:15], s17 offen sc1 lds
    s_add_u32 m0, s18, 40960
    s_nop 0
    buffer_load_dwordx4 v18, s[12:15], s17 offen sc1 lds
    s_add_u32 s17, s17, 2048
    s_add_u32 s18, s18, 45056
    s_cmp_ge_u32 s18, s23
    s_cselect_b32 s20, 135168, 0
    s_sub_u32 s18, s18, s20
    s_sub_u32 s19, s19, 1
    s_cmp_lg_u32 s19, 0
    s_cbranch_scc1 adaLN_cond__mha_block__mixer_gmlp__prompt_kernel_w_ld_loop0
    s_waitcnt vmcnt(11)
    s_barrier
    v_and_b32 v58, 31, v1
    v_lshlrev_b32 v58, 7, v58
    v_lshrrev_b32 v59, 5, v1
    v_mul_u32_u24 v59, 4352, v59
    v_add_u32 v58, v58, v59
    s_mul_i32 s35, s3, 8704
    s_add_u32 s35, s35, 139264
    buffer_load_dword v59, v58, s[96:99], s35 offen sc1
    s_waitcnt vmcnt(1)
    s_barrier
    s_waitcnt vmcnt(0)
    s_mov_b32 s19, 0x80000
adaLN_cond__mha_block__mixer_gmlp__prompt_kernel_w_g_1:
    v_cmp_ne_u32 vcc, s101, v59
    s_sub_u32 s19, s19, 1
    s_cmp_eq_u32 s19, 0
    s_cbranch_scc1 adaLN_cond__mha_block__mixer_gmlp__prompt_kernel_w_g_1_d
    s_cbranch_vccz adaLN_cond__mha_block__mixer_gmlp__prompt_kernel_w_g_1_d
    s_sleep 4
    buffer_load_dword v59, v58, s[96:99], s35 offen sc1
    s_waitcnt vmcnt(0)
    s_branch adaLN_cond__mha_block__mixer_gmlp__prompt_kernel_w_g_1
adaLN_cond__mha_block__mixer_gmlp__prompt_kernel_w_g_1_d:
    s_barrier
    s_barrier
    s_cmp_ge_u32 s3, 2
    s_cbranch_scc1 adaLN_cond__mha_block__mixer_gmlp__prompt_kernel_w_lx
    s_add_u32 s44, s36, 114688
    s_addc_u32 s45, s37, 0
    s_mov_b32 s46, 32768
    s_mov_b32 s47, 0x20000
    s_lshl_b32 s20, s4, 1
    s_add_u32 s20, s20, s3
    s_lshl_b32 s20, s20, 10
    v_lshlrev_b32 v30, 4, v1
    s_mov_b32 s19, 0x80000
adaLN_cond__mha_block__mixer_gmlp__prompt_kernel_w_poll:
    buffer_load_dwordx3 v[32:34], v30, s[44:47], s20 offen sc1
    s_waitcnt vmcnt(0)
    v_cmp_gt_f32 vcc, 0x41fc0000, v34
    s_sub_u32 s19, s19, 1
    s_cmp_eq_u32 s19, 0
    s_cbranch_scc1 adaLN_cond__mha_block__mixer_gmlp__prompt_kernel_w_pd
    s_cbranch_vccz adaLN_cond__mha_block__mixer_gmlp__prompt_kernel_w_pd
    s_sleep 4
    s_branch adaLN_cond__mha_block__mixer_gmlp__prompt_kernel_w_poll
adaLN_cond__mha_block__mixer_gmlp__prompt_kernel_w_pd:
    v_mul_f32 v32, 0x3a124925, v32
    v_mul_f32 v33, 0x3a124925, v33
    v_fma_f32 v33, -v32, v32, v33
    v_max_f32 v33, 0, v33
    v_add_f32 v33, 0x3727c5ac, v33
    v_rsq_f32 v34, v33
    s_nop 0
    v_mul_f32_e64 v33, -v32, v34
    v_mov_b32 v32, v34
    s_lshl_b32 s20, s3, 9
    s_add_u32 s20, s20, 138240
    v_lshl_add_u32 v30, v1, 3, s20
    ds_write_b64 v30, v[32:33]
    s_waitcnt lgkmcnt(0)
adaLN_cond__mha_block__mixer_gmlp__prompt_kernel_w_lx:
    s_barrier
    s_barrier
    s_and_b32 s20, s2, 7
    s_lshr_b32 s21, s2, 3
    s_and_b32 s4, s20, 3
    s_lshl_b32 s4, s4, 2
    s_and_b32 s22, s21, 3
    s_add_u32 s4, s4, s22
    s_lshr_b32 s5, s20, 2
    s_mul_i32 s5, s5, 8
    s_lshr_b32 s22, s21, 2
    s_add_u32 s5, s5, s22
    s_setprio 0
    s_mov_b32 s8, s86
    s_mov_b32 s9, s87
    s_mov_b32 s10, 8388608
    s_mov_b32 s11, 0x20000
    s_add_u32 s12, s36, 10485760
    s_addc_u32 s13, s37, 0
    s_mov_b32 s14, 7340032
    s_mov_b32 s15, 0x20000
    v_and_b32 v1, 63, v0
    v_lshrrev_b32 v2, 4, v1
    s_and_b32 s21, s3, 1
    s_lshl_b32 s21, s21, 2
    v_or_b32 v2, s21, v2
    v_and_b32 v3, 7, v1
    v_xor_b32 v2, v2, v3
    v_lshlrev_b32 v2, 4, v2
    v_lshrrev_b32 v3, 3, v1
    s_mul_i32 s20, s4, 128
    s_lshl_b32 s21, s3, 3
    s_add_u32 s20, s20, s21
    v_add_u32 v3, s20, v3
    s_mov_b32 s21, 4096
    v_mul_lo_u32 v3, v3, s21
    v_add_u32 v8, v2, v3
    v_add_u32 v9, 131072, v8
    v_add_u32 v10, 262144, v8
    v_add_u32 v11, 393216, v8
    s_mul_i32 s20, s5, 7
    s_lshr_b32 s21, s3, 1
    s_add_u32 s20, s20, s21
    s_mul_i32 s20, s20, 65536
    s_and_b32 s21, s3, 1
    s_lshl_b32 s21, s21, 10
    s_add_u32 s20, s20, s21
    v_lshlrev_b32 v2, 4, v1
    v_add_u32 v12, s20, v2
    v_add_u32 v13, 131072, v12
    v_add_u32 v14, 262144, v12
    v_add_u32 v15, 393216, v12
    s_mov_b32 s16, 0
    s_mov_b32 s17, 0
    s_lshl_b32 s18, s3, 10
    s_add_u32 s23, s18, 153600
    s_add_u32 s24, s36, 46137344
    s_addc_u32 s25, s37, 0
    s_mov_b32 s26, 7340032
    s_mov_b32 s27, 0x20000
    s_mov_b32 s44, s88
    s_mov_b32 s45, s89
    s_mov_b32 s46, 4096
    s_mov_b32 s47, 0x20000
    s_lshl_b32 s20, s4, 3
    s_lshl_b32 s21, s3, 1
    s_add_u32 s20, s20, s21
    s_mul_i32 s20, s20, 57344
    s_mul_i32 s21, s5, 3584
    s_add_u32 s20, s20, s21
    v_lshl_add_u32 v4, v1, 4, s20
    v_add_u32 v40, 0, v4
    v_add_u32 v41, 1024, v4
    v_add_u32 v42, 2048, v4
    v_add_u32 v44, 57856, v4
    v_add_u32 v45, 58880, v4
    v_add_u32 v46, 59904, v4
    v_lshrrev_b32 v5, 5, v1
    v_mul_u32_u24 v5, 53760, v5
    v_add3_u32 v43, v4, v5, 0
    v_add_u32 v43, 3072, v43
    s_lshl_b32 s21, s4, 8
    v_lshl_add_u32 v47, v1, 4, s21
    s_cmp_ge_u32 s3, 2
    s_cbranch_scc1 adaLN_cond__mha_block__mixer_gmlp__prompt_kernel_s_ld_v1
    s_add_u32 s22, s18, 0
    s_add_u32 m0, s22, 0
    s_nop 0
    buffer_load_dwordx4 v8, s[8:11], s16 offen lds
    s_add_u32 m0, s22, 4096
    s_nop 0
    buffer_load_dwordx4 v9, s[8:11], s16 offen lds
    s_add_u32 m0, s22, 8192
    s_nop 0
    buffer_load_dwordx4 v10, s[8:11], s16 offen lds
    s_add_u32 m0, s22, 12288
    s_nop 0
    buffer_load_dwordx4 v11, s[8:11], s16 offen lds
    s_add_u32 s16, s16, 128
    s_barrier
    s_add_u32 s22, s18, 30720
    s_add_u32 m0, s22, 0
    s_nop 0
    buffer_load_dwordx4 v8, s[8:11], s16 offen lds
    s_add_u32 m0, s22, 4096
    s_nop 0
    buffer_load_dwordx4 v9, s[8:11], s16 offen lds
    s_add_u32 m0, s22, 8192
    s_nop 0
    buffer_load_dwordx4 v10, s[8:11], s16 offen lds
    s_add_u32 m0, s22, 12288
    s_nop 0
    buffer_load_dwordx4 v11, s[8:11], s16 offen lds
    s_add_u32 s16, s16, 128
    s_add_u32 s22, s18, 61440
    s_add_u32 m0, s22, 0
    s_nop 0
    buffer_load_dwordx4 v8, s[8:11], s16 offen lds
    s_add_u32 m0, s22, 4096
    s_nop 0
    buffer_load_dwordx4 v9, s[8:11], s16 offen lds
    s_add_u32 m0, s22, 8192
    s_nop 0
    buffer_load_dwordx4 v10, s[8:11], s16 offen lds
    s_add_u32 m0, s22, 12288
    s_nop 0
    buffer_load_dwordx4 v11, s[8:11], s16 offen lds
    s_add_u32 s16, s16, 128
    s_add_u32 s22, s18, 92160
    s_add_u32 m0, s22, 0
    s_nop 0
    buffer_load_dwordx4 v8, s[8:11], s16 offen lds
    s_add_u32 m0, s22, 4096
    s_nop 0
    buffer_load_dwordx4 v9, s[8:11], s16 offen lds
    s_add_u32 m0, s22, 8192
    s_nop 0
    buffer_load_dwordx4 v10, s[8:11], s16 offen lds
    s_add_u32 m0, s22, 12288
    s_nop 0
    buffer_load_dwordx4 v11, s[8:11], s16 offen lds
    s_add_u32 s16, s16, 128
    s_add_u32 s22, s18, 122880
    s_add_u32 m0, s22, 0
    s_nop 0
    buffer_load_dwordx4 v8, s[8:11], s16 offen lds
    s_add_u32 m0, s22, 4096
    s_nop 0
    buffer_load_dwordx4 v9, s[8:11], s16 offen lds
    s_add_u32 m0, s22, 8192
    s_nop 0
    buffer_load_dwordx4 v10, s[8:11], s16 offen lds
    s_add_u32 m0, s22, 12288
    s_nop 0
    buffer_load_dwordx4 v11, s[8:11], s16 offen lds
    s_add_u32 s16, s16, 128
    s_barrier
    s_add_u32 s22, s18, 0
    s_add_u32 m0, s22, 16384
    s_nop 0
    buffer_load_dwordx4 v12, s[12:15], s17 offen sc1 lds
    s_add_u32 m0, s22, 20480
    s_nop 0
    buffer_load_dwordx4 v13, s[12:15], s17 offen sc1 lds
    s_add_u32 m0, s22, 24576
    s_nop 0
    buffer_load_dwordx4 v14, s[12:15], s17 offen sc1 lds
    s_add_u32 m0, s22, 28672
    s_nop 0
    buffer_load_dwordx4 v15, s[12:15], s17 offen sc1 lds
    s_add_u32 s17, s17, 2048
    s_add_u32 s22, s18, 30720
    s_add_u32 m0, s22, 16384
    s_nop 0
    buffer_load_dwordx4 v12, s[12:15], s17 offen sc1 lds
    s_add_u32 m0, s22, 20480
    s_nop 0
    buffer_load_dwordx4 v13, s[12:15], s17 offen sc1 lds
    s_add_u32 m0, s22, 24576
    s_nop 0
    buffer_load_dwordx4 v14, s[12:15], s17 offen sc1 lds
    s_add_u32 m0, s22, 28672
    s_nop 0
    buffer_load_dwordx4 v15, s[12:15], s17 offen sc1 lds
    s_add_u32 s17, s17, 2048
    s_add_u32 s22, s18, 61440
    s_add_u32 m0, s22, 16384
    s_nop 0
    buffer_load_dwordx4 v12, s[12:15], s17 offen sc1 lds
    s_add_u32 m0, s22, 20480
    s_nop 0
    buffer_load_dwordx4 v13, s[12:15], s17 offen sc1 lds
    s_add_u32 m0, s22, 24576
    s_nop 0
    buffer_load_dwordx4 v14, s[12:15], s17 offen sc1 lds
    s_add_u32 m0, s22, 28672
    s_nop 0
    buffer_load_dwordx4 v15, s[12:15], s17 offen sc1 lds
    s_add_u32 s17, s17, 2048
    s_add_u32 s22, s18, 92160
    s_add_u32 m0, s22, 16384
    s_nop 0
    buffer_load_dwordx4 v12, s[12:15], s17 offen sc1 lds
    s_add_u32 m0, s22, 20480
    s_nop 0
    buffer_load_dwordx4 v13, s[12:15], s17 offen sc1 lds
    s_add_u32 m0, s22, 24576
    s_nop 0
    buffer_load_dwordx4 v14, s[12:15], s17 offen sc1 lds
    s_add_u32 m0, s22, 28672
    s_nop 0
    buffer_load_dwordx4 v15, s[12:15], s17 offen sc1 lds
    s_add_u32 s17, s17, 2048
    s_add_u32 s22, s18, 122880
    s_add_u32 m0, s22, 16384
    s_nop 0
    buffer_load_dwordx4 v12, s[12:15], s17 offen sc1 lds
    s_add_u32 m0, s22, 20480
    s_nop 0
    buffer_load_dwordx4 v13, s[12:15], s17 offen sc1 lds
    s_add_u32 m0, s22, 24576
    s_nop 0
    buffer_load_dwordx4 v14, s[12:15], s17 offen sc1 lds
    s_add_u32 m0, s22, 28672
    s_nop 0
    buffer_load_dwordx4 v15, s[12:15], s17 offen sc1 lds
    s_add_u32 s17, s17, 2048
    s_waitcnt vmcnt(16)
    s_barrier
    s_waitcnt vmcnt(12)
    s_barrier
    s_add_u32 m0, s18, 0
    s_nop 0
    buffer_load_dwordx4 v8, s[8:11], s16 offen lds
    s_add_u32 m0, s18, 4096
    s_nop 0
    buffer_load_dwordx4 v9, s[8:11], s16 offen lds
    s_add_u32 m0, s18, 8192
    s_nop 0
    buffer_load_dwordx4 v10, s[8:11], s16 offen lds
    s_add_u32 m0, s18, 12288
    s_nop 0
    buffer_load_dwordx4 v11, s[8:11], s16 offen lds
    s_add_u32 s16, s16, 128
    s_add_u32 m0, s18, 16384
    s_nop 0
    buffer_load_dwordx4 v12, s[12:15], s17 offen sc1 lds
    s_add_u32 m0, s18, 20480
    s_nop 0
    buffer_load_dwordx4 v13, s[12:15], s17 offen sc1 lds
    s_add_u32 m0, s18, 24576
    s_nop 0
    buffer_load_dwordx4 v14, s[12:15], s17 offen sc1 lds
    s_add_u32 m0, s18, 28672
    s_nop 0
    buffer_load_dwordx4 v15, s[12:15], s17 offen sc1 lds
    s_add_u32 s17, s17, 2048
    s_add_u32 s18, s18, 30720
    s_cmp_ge_u32 s18, s23
    s_cselect_b32 s20, 153600, 0
    s_sub_u32 s18, s18, s20
    s_waitcnt vmcnt(16)
    s_barrier
    s_add_u32 m0, s18, 0
    s_nop 0
    buffer_load_dwordx4 v8, s[8:11], s16 offen lds
    s_add_u32 m0, s18, 4096
    s_nop 0
    buffer_load_dwordx4 v9, s[8:11], s16 offen lds
    s_add_u32 m0, s18, 8192
    s_nop 0
    buffer_load_dwordx4 v10, s[8:11], s16 offen lds
    s_add_u32 m0, s18, 12288
    s_nop 0
    buffer_load_dwordx4 v11, s[8:11], s16 offen lds
    s_add_u32 s16, s16, 128
    s_add_u32 m0, s18, 16384
    s_nop 0
    buffer_load_dwordx4 v12, s[12:15], s17 offen sc1 lds
    s_add_u32 m0, s18, 20480
    s_nop 0
    buffer_load_dwordx4 v13, s[12:15], s17 offen sc1 lds
    s_add_u32 m0, s18, 24576
    s_nop 0
    buffer_load_dwordx4 v14, s[12:15], s17 offen sc1 lds
    s_add_u32 m0, s18, 28672
    s_nop 0
    buffer_load_dwordx4 v15, s[12:15], s17 offen sc1 lds
    s_add_u32 s17, s17, 2048
    s_add_u32 s18, s18, 30720
    s_cmp_ge_u32 s18, s23
    s_cselect_b32 s20, 153600, 0
    s_sub_u32 s18, s18, s20
    s_waitcnt vmcnt(20)
    s_barrier
    s_add_u32 m0, s18, 0
    s_nop 0
    buffer_load_dwordx4 v8, s[8:11], s16 offen lds
    s_add_u32 m0, s18, 4096
    s_nop 0
    buffer_load_dwordx4 v9, s[8:11], s16 offen lds
    s_add_u32 m0, s18, 8192
    s_nop 0
    buffer_load_dwordx4 v10, s[8:11], s16 offen lds
    s_add_u32 m0, s18, 12288
    s_nop 0
    buffer_load_dwordx4 v11, s[8:11], s16 offen lds
    s_add_u32 s16, s16, 128
    s_add_u32 m0, s18, 16384
    s_nop 0
    buffer_load_dwordx4 v12, s[12:15], s17 offen sc1 lds
    s_add_u32 m0, s18, 20480
    s_nop 0
    buffer_load_dwordx4 v13, s[12:15], s17 offen sc1 lds
    s_add_u32 m0, s18, 24576
    s_nop 0
    buffer_load_dwordx4 v14, s[12:15], s17 offen sc1 lds
    s_add_u32 m0, s18, 28672
    s_nop 0
    buffer_load_dwordx4 v15, s[12:15], s17 offen sc1 lds
    s_add_u32 s17, s17, 2048
    s_add_u32 s18, s18, 30720
    s_cmp_ge_u32 s18, s23
    s_cselect_b32 s20, 153600, 0
    s_sub_u32 s18, s18, s20
    s_mov_b32 s19, 24
adaLN_cond__mha_block__mixer_gmlp__prompt_kernel_s_ld_loop0:
    s_waitcnt vmcnt(24)
    s_barrier
    s_add_u32 m0, s18, 0
    s_nop 0
    buffer_load_dwordx4 v8, s[8:11], s16 offen lds
    s_add_u32 m0, s18, 4096
    s_nop 0
    buffer_load_dwordx4 v9, s[8:11], s16 offen lds
    s_add_u32 m0, s18, 8192
    s_nop 0
    buffer_load_dwordx4 v10, s[8:11], s16 offen lds
    s_add_u32 m0, s18, 12288
    s_nop 0
    buffer_load_dwordx4 v11, s[8:11], s16 offen lds
    s_add_u32 s16, s16, 128
    s_add_u32 m0, s18, 16384
    s_nop 0
    buffer_load_dwordx4 v12, s[12:15], s17 offen sc1 lds
    s_add_u32 m0, s18, 20480
    s_nop 0
    buffer_load_dwordx4 v13, s[12:15], s17 offen sc1 lds
    s_add_u32 m0, s18, 24576
    s_nop 0
    buffer_load_dwordx4 v14, s[12:15], s17 offen sc1 lds
    s_add_u32 m0, s18, 28672
    s_nop 0
    buffer_load_dwordx4 v15, s[12:15], s17 offen sc1 lds
    s_add_u32 s17, s17, 2048
    s_add_u32 s18, s18, 30720
    s_cmp_ge_u32 s18, s23
    s_cselect_b32 s20, 153600, 0
    s_sub_u32 s18, s18, s20
    s_sub_u32 s19, s19, 1
    s_cmp_lg_u32 s19, 0
    s_cbranch_scc1 adaLN_cond__mha_block__mixer_gmlp__prompt_kernel_s_ld_loop0
    s_waitcnt vmcnt(24)
    s_barrier
    s_mul_i32 s20, s3, 7168
    s_add_u32 m0, s20, 61440
    s_nop 0
    buffer_load_dwordx4 v40, s[24:27], 0 offen sc1 lds
    s_add_u32 m0, s20, 62464
    s_nop 0
    buffer_load_dwordx4 v41, s[24:27], 0 offen sc1 lds
    s_add_u32 m0, s20, 63488
    s_nop 0
    buffer_load_dwordx4 v42, s[24:27], 0 offen sc1 lds
    s_add_u32 m0, s20, 64512
    s_nop 0
    buffer_load_dwordx4 v43, s[24:27], 0 offen sc1 lds
    s_add_u32 m0, s20, 65536
    s_nop 0
    buffer_load_dwordx4 v44, s[24:27], 0 offen sc1 lds
    s_add_u32 m0, s20, 66560
    s_nop 0
    buffer_load_dwordx4 v45, s[24:27], 0 offen sc1 lds
    s_add_u32 m0, s20, 67584
    s_nop 0
    buffer_load_dwordx4 v46, s[24:27], 0 offen sc1 lds
    s_mov_b32 m0, 90112
    s_nop 0
    buffer_load_dwordx4 v47, s[44:47], 0 offen lds
    v_and_b32 v58, 15, v1
    v_lshlrev_b32 v58, 7, v58
    v_lshrrev_b32 v59, 4, v1
    v_mul_u32_u24 v59, 4352, v59
    v_add_u32 v58, v58, v59
    s_mul_i32 s35, s3, 17408
    s_add_u32 s35, s35, 278528
    buffer_load_dword v59, v58, s[96:99], s35 offen sc1
    s_waitcnt vmcnt(25)
    s_barrier
    s_waitcnt vmcnt(17)
    s_barrier
    s_waitcnt vmcnt(9)
    s_barrier
    s_waitcnt vmcnt(0)
    s_mov_b32 s19, 0x80000
adaLN_cond__mha_block__mixer_gmlp__prompt_kernel_s_g_2:
    v_cmp_ne_u32 vcc, s101, v59
    s_sub_u32 s19, s19, 1
    s_cmp_eq_u32 s19, 0
    s_cbranch_scc1 adaLN_cond__mha_block__mixer_gmlp__prompt_kernel_s_g_2_d
    s_cbranch_vccz adaLN_cond__mha_block__mixer_gmlp__prompt_kernel_s_g_2_d
    s_sleep 4
    buffer_load_dword v59, v58, s[96:99], s35 offen sc1
    s_waitcnt vmcnt(0)
    s_branch adaLN_cond__mha_block__mixer_gmlp__prompt_kernel_s_g_2
adaLN_cond__mha_block__mixer_gmlp__prompt_kernel_s_g_2_d:
    s_barrier
    s_branch adaLN_cond__mha_block__mixer_gmlp__prompt_kernel_s_ld_join
adaLN_cond__mha_block__mixer_gmlp__prompt_kernel_s_ld_v1:
    s_add_u32 s22, s18, 0
    s_add_u32 m0, s22, 0
    s_nop 0
    buffer_load_dwordx4 v8, s[8:11], s16 offen lds
    s_add_u32 m0, s22, 4096
    s_nop 0
    buffer_load_dwordx4 v9, s[8:11], s16 offen lds
    s_add_u32 m0, s22, 8192
    s_nop 0
    buffer_load_dwordx4 v10, s[8:11], s16 offen lds
    s_add_u32 m0, s22, 12288
    s_nop 0
    buffer_load_dwordx4 v11, s[8:11], s16 offen lds
    s_add_u32 s16, s16, 128
    s_barrier
    s_add_u32 s22, s18, 30720
    s_add_u32 m0, s22, 0
    s_nop 0
    buffer_load_dwordx4 v8, s[8:11], s16 offen lds
    s_add_u32 m0, s22, 4096
    s_nop 0
    buffer_load_dwordx4 v9, s[8:11], s16 offen lds
    s_add_u32 m0, s22, 8192
    s_nop 0
    buffer_load_dwordx4 v10, s[8:11], s16 offen lds
    s_add_u32 m0, s22, 12288
    s_nop 0
    buffer_load_dwordx4 v11, s[8:11], s16 offen lds
    s_add_u32 s16, s16, 128
    s_add_u32 s22, s18, 61440
    s_add_u32 m0, s22, 0
    s_nop 0
    buffer_load_dwordx4 v8, s[8:11], s16 offen lds
    s_add_u32 m0, s22, 4096
    s_nop 0
    buffer_load_dwordx4 v9, s[8:11], s16 offen lds
    s_add_u32 m0, s22, 8192
    s_nop 0
    buffer_load_dwordx4 v10, s[8:11], s16 offen lds
    s_add_u32 m0, s22, 12288
    s_nop 0
    buffer_load_dwordx4 v11, s[8:11], s16 offen lds
    s_add_u32 s16, s16, 128
    s_add_u32 s22, s18, 92160
    s_add_u32 m0, s22, 0
    s_nop 0
    buffer_load_dwordx4 v8, s[8:11], s16 offen lds
    s_add_u32 m0, s22, 4096
    s_nop 0
    buffer_load_dwordx4 v9, s[8:11], s16 offen lds
    s_add_u32 m0, s22, 8192
    s_nop 0
    buffer_load_dwordx4 v10, s[8:11], s16 offen lds
    s_add_u32 m0, s22, 12288
    s_nop 0
    buffer_load_dwordx4 v11, s[8:11], s16 offen lds
    s_add_u32 s16, s16, 128
    s_add_u32 s22, s18, 122880
    s_add_u32 m0, s22, 0
    s_nop 0
    buffer_load_dwordx4 v8, s[8:11], s16 offen lds
    s_add_u32 m0, s22, 4096
    s_nop 0
    buffer_load_dwordx4 v9, s[8:11], s16 offen lds
    s_add_u32 m0, s22, 8192
    s_nop 0
    buffer_load_dwordx4 v10, s[8:11], s16 offen lds
    s_add_u32 m0, s22, 12288
    s_nop 0
    buffer_load_dwordx4 v11, s[8:11], s16 offen lds
    s_add_u32 s16, s16, 128
    s_barrier
    s_add_u32 s22, s18, 0
    s_add_u32 m0, s22, 16384
    s_nop 0
    buffer_load_dwordx4 v12, s[12:15], s17 offen sc1 lds
    s_add_u32 m0, s22, 20480
    s_nop 0
    buffer_load_dwordx4 v13, s[12:15], s17 offen sc1 lds
    s_add_u32 m0, s22, 24576
    s_nop 0
    buffer_load_dwordx4 v14, s[12:15], s17 offen sc1 lds
    s_add_u32 s17, s17, 2048
    s_add_u32 s22, s18, 30720
    s_add_u32 m0, s22, 16384
    s_nop 0
    buffer_load_dwordx4 v12, s[12:15], s17 offen sc1 lds
    s_add_u32 m0, s22, 20480
    s_nop 0
    buffer_load_dwordx4 v13, s[12:15], s17 offen sc1 lds
    s_add_u32 m0, s22, 24576
    s_nop 0
    buffer_load_dwordx4 v14, s[12:15], s17 offen sc1 lds
    s_add_u32 s17, s17, 2048
    s_add_u32 s22, s18, 61440
    s_add_u32 m0, s22, 16384
    s_nop 0
    buffer_load_dwordx4 v12, s[12:15], s17 offen sc1 lds
    s_add_u32 m0, s22, 20480
    s_nop 0
    buffer_load_dwordx4 v13, s[12:15], s17 offen sc1 lds
    s_add_u32 m0, s22, 24576
    s_nop 0
    buffer_load_dwordx4 v14, s[12:15], s17 offen sc1 lds
    s_add_u32 s17, s17, 2048
    s_add_u32 s22, s18, 92160
    s_add_u32 m0, s22, 16384
    s_nop 0
    buffer_load_dwordx4 v12, s[12:15], s17 offen sc1 lds
    s_add_u32 m0, s22, 20480
    s_nop 0
    buffer_load_dwordx4 v13, s[12:15], s17 offen sc1 lds
    s_add_u32 m0, s22, 24576
    s_nop 0
    buffer_load_dwordx4 v14, s[12:15], s17 offen sc1 lds
    s_add_u32 s17, s17, 2048
    s_add_u32 s22, s18, 122880
    s_add_u32 m0, s22, 16384
    s_nop 0
    buffer_load_dwordx4 v12, s[12:15], s17 offen sc1 lds
    s_add_u32 m0, s22, 20480
    s_nop 0
    buffer_load_dwordx4 v13, s[12:15], s17 offen sc1 lds
    s_add_u32 m0, s22, 24576
    s_nop 0
    buffer_load_dwordx4 v14, s[12:15], s17 offen sc1 lds
    s_add_u32 s17, s17, 2048
    s_waitcnt vmcnt(12)
    s_barrier
    s_waitcnt vmcnt(9)
    s_barrier
    s_add_u32 m0, s18, 0
    s_nop 0
    buffer_load_dwordx4 v8, s[8:11], s16 offen lds
    s_add_u32 m0, s18, 4096
    s_nop 0
    buffer_load_dwordx4 v9, s[8:11], s16 offen lds
    s_add_u32 m0, s18, 8192
    s_nop 0
    buffer_load_dwordx4 v10, s[8:11], s16 offen lds
    s_add_u32 m0, s18, 12288
    s_nop 0
    buffer_load_dwordx4 v11, s[8:11], s16 offen lds
    s_add_u32 s16, s16, 128
    s_add_u32 m0, s18, 16384
    s_nop 0
    buffer_load_dwordx4 v12, s[12:15], s17 offen sc1 lds
    s_add_u32 m0, s18, 20480
    s_nop 0
    buffer_load_dwordx4 v13, s[12:15], s17 offen sc1 lds
    s_add_u32 m0, s18, 24576
    s_nop 0
    buffer_load_dwordx4 v14, s[12:15], s17 offen sc1 lds
    s_add_u32 s17, s17, 2048
    s_add_u32 s18, s18, 30720
    s_cmp_ge_u32 s18, s23
    s_cselect_b32 s20, 153600, 0
    s_sub_u32 s18, s18, s20
    s_waitcnt vmcnt(13)
    s_barrier
    s_add_u32 m0, s18, 0
    s_nop 0
    buffer_load_dwordx4 v8, s[8:11], s16 offen lds
    s_add_u32 m0, s18, 4096
    s_nop 0
    buffer_load_dwordx4 v9, s[8:11], s16 offen lds
    s_add_u32 m0, s18, 8192
    s_nop 0
    buffer_load_dwordx4 v10, s[8:11], s16 offen lds
    s_add_u32 m0, s18, 12288
    s_nop 0
    buffer_load_dwordx4 v11, s[8:11], s16 offen lds
    s_add_u32 s16, s16, 128
    s_add_u32 m0, s18, 16384
    s_nop 0
    buffer_load_dwordx4 v12, s[12:15], s17 offen sc1 lds
    s_add_u32 m0, s18, 20480
    s_nop 0
    buffer_load_dwordx4 v13, s[12:15], s17 offen sc1 lds
    s_add_u32 m0, s18, 24576
    s_nop 0
    buffer_load_dwordx4 v14, s[12:15], s17 offen sc1 lds
    s_add_u32 s17, s17, 2048
    s_add_u32 s18, s18, 30720
    s_cmp_ge_u32 s18, s23
    s_cselect_b32 s20, 153600, 0
    s_sub_u32 s18, s18, s20
    s_waitcnt vmcnt(17)
    s_barrier
    s_add_u32 m0, s18, 0
    s_nop 0
    buffer_load_dwordx4 v8, s[8:11], s16 offen lds
    s_add_u32 m0, s18, 4096
    s_nop 0
    buffer_load_dwordx4 v9, s[8:11], s16 offen lds
    s_add_u32 m0, s18, 8192
    s_nop 0
    buffer_load_dwordx4 v10, s[8:11], s16 offen lds
    s_add_u32 m0, s18, 12288
    s_nop 0
    buffer_load_dwordx4 v11, s[8:11], s16 offen lds
    s_add_u32 s16, s16, 128
    s_add_u32 m0, s18, 16384
    s_nop 0
    buffer_load_dwordx4 v12, s[12:15], s17 offen sc1 lds
    s_add_u32 m0, s18, 20480
    s_nop 0
    buffer_load_dwordx4 v13, s[12:15], s17 offen sc1 lds
    s_add_u32 m0, s18, 24576
    s_nop 0
    buffer_load_dwordx4 v14, s[12:15], s17 offen sc1 lds
    s_add_u32 s17, s17, 2048
    s_add_u32 s18, s18, 30720
    s_cmp_ge_u32 s18, s23
    s_cselect_b32 s20, 153600, 0
    s_sub_u32 s18, s18, s20
    s_mov_b32 s19, 24
adaLN_cond__mha_block__mixer_gmlp__prompt_kernel_s_ld_loop1:
    s_waitcnt vmcnt(21)
    s_barrier
    s_add_u32 m0, s18, 0
    s_nop 0
    buffer_load_dwordx4 v8, s[8:11], s16 offen lds
    s_add_u32 m0, s18, 4096
    s_nop 0
    buffer_load_dwordx4 v9, s[8:11], s16 offen lds
    s_add_u32 m0, s18, 8192
    s_nop 0
    buffer_load_dwordx4 v10, s[8:11], s16 offen lds
    s_add_u32 m0, s18, 12288
    s_nop 0
    buffer_load_dwordx4 v11, s[8:11], s16 offen lds
    s_add_u32 s16, s16, 128
    s_add_u32 m0, s18, 16384
    s_nop 0
    buffer_load_dwordx4 v12, s[12:15], s17 offen sc1 lds
    s_add_u32 m0, s18, 20480
    s_nop 0
    buffer_load_dwordx4 v13, s[12:15], s17 offen sc1 lds
    s_add_u32 m0, s18, 24576
    s_nop 0
    buffer_load_dwordx4 v14, s[12:15], s17 offen sc1 lds
    s_add_u32 s17, s17, 2048
    s_add_u32 s18, s18, 30720
    s_cmp_ge_u32 s18, s23
    s_cselect_b32 s20, 153600, 0
    s_sub_u32 s18, s18, s20
    s_sub_u32 s19, s19, 1
    s_cmp_lg_u32 s19, 0
    s_cbranch_scc1 adaLN_cond__mha_block__mixer_gmlp__prompt_kernel_s_ld_loop1
    s_waitcnt vmcnt(21)
    s_barrier
    s_mul_i32 s20, s3, 7168
    s_add_u32 m0, s20, 61440
    s_nop 0
    buffer_load_dwordx4 v40, s[24:27], 0 offen sc1 lds
    s_add_u32 m0, s20, 62464
    s_nop 0
    buffer_load_dwordx4 v41, s[24:27], 0 offen sc1 lds
    s_add_u32 m0, s20, 63488
    s_nop 0
    buffer_load_dwordx4 v42, s[24:27], 0 offen sc1 lds
    s_add_u32 m0, s20, 64512
    s_nop 0
    buffer_load_dwordx4 v43, s[24:27], 0 offen sc1 lds
    s_add_u32 m0, s20, 65536
    s_nop 0
    buffer_load_dwordx4 v44, s[24:27], 0 offen sc1 lds
    s_add_u32 m0, s20, 66560
    s_nop 0
    buffer_load_dwordx4 v45, s[24:27], 0 offen sc1 lds
    s_add_u32 m0, s20, 67584
    s_nop 0
    buffer_load_dwordx4 v46, s[24:27], 0 offen sc1 lds
    s_mov_b32 m0, 90112
    s_nop 0
    buffer_load_dwordx4 v47, s[44:47], 0 offen lds
    v_and_b32 v58, 15, v1
    v_lshlrev_b32 v58, 7, v58
    v_lshrrev_b32 v59, 4, v1
    v_mul_u32_u24 v59, 4352, v59
    v_add_u32 v58, v58, v59
    s_mul_i32 s35, s3, 17408
    s_add_u32 s35, s35, 278528
    buffer_load_dword v59, v58, s[96:99], s35 offen sc1
    s_waitcnt vmcnt(23)
    s_barrier
    s_waitcnt vmcnt(16)
    s_barrier
    s_waitcnt vmcnt(9)
    s_barrier
    s_waitcnt vmcnt(0)
    s_mov_b32 s19, 0x80000
adaLN_cond__mha_block__mixer_gmlp__prompt_kernel_s_g_3:
    v_cmp_ne_u32 vcc, s101, v59
    s_sub_u32 s19, s19, 1
    s_cmp_eq_u32 s19, 0
    s_cbranch_scc1 adaLN_cond__mha_block__mixer_gmlp__prompt_kernel_s_g_3_d
    s_cbranch_vccz adaLN_cond__mha_block__mixer_gmlp__prompt_kernel_s_g_3_d
    s_sleep 4
    buffer_load_dword v59, v58, s[96:99], s35 offen sc1
    s_waitcnt vmcnt(0)
    s_branch adaLN_cond__mha_block__mixer_gmlp__prompt_kernel_s_g_3
adaLN_cond__mha_block__mixer_gmlp__prompt_kernel_s_g_3_d:
    s_barrier
adaLN_cond__mha_block__mixer_gmlp__prompt_kernel_s_ld_join:
    s_barrier
    s_and_b32 s20, s2, 7
    s_lshr_b32 s21, s2, 3
    s_and_b32 s4, s20, 3
    s_lshl_b32 s4, s4, 3
    s_and_b32 s22, s21, 7
    s_add_u32 s4, s4, s22
    s_lshr_b32 s5, s20, 2
    s_mul_i32 s5, s5, 4
    s_lshr_b32 s22, s21, 3
    s_add_u32 s5, s5, s22
    s_setprio 0
    s_add_u32 s8, s36, 2097152
    s_addc_u32 s9, s37, 0
    s_mov_b32 s10, 7340032
    s_mov_b32 s11, 0x20000
    s_add_u32 s12, s36, 41943040
    s_addc_u32 s13, s37, 0
    s_mov_b32 s14, 3670016
    s_mov_b32 s15, 0x20000
    v_and_b32 v1, 63, v0
    s_mul_i32 s20, s4, 4
    s_lshr_b32 s21, s3, 1
    s_add_u32 s20, s20, s21
    s_mul_i32 s20, s20, 57344
    s_and_b32 s21, s3, 1
    s_lshl_b32 s21, s21, 10
    s_add_u32 s20, s20, s21
    v_lshlrev_b32 v2, 4, v1
    v_add_u32 v8, s20, v2
    v_add_u32 v9, 114688, v8
    s_mul_i32 s20, s5, 8
    s_lshr_b32 s21, s3, 1
    s_add_u32 s20, s20, s21
    s_mul_i32 s20, s20, 57344
    s_and_b32 s21, s3, 1
    s_lshl_b32 s21, s21, 10
    s_add_u32 s20, s20, s21
    v_lshlrev_b32 v2, 4, v1
    v_add_u32 v10, s20, v2
    v_add_u32 v11, 114688, v10
    v_add_u32 v12, 229376, v10
    v_add_u32 v13, 344064, v10
    s_mov_b32 s16, 0
    s_mov_b32 s17, 0
    s_lshl_b32 s18, s3, 10
    s_add_u32 s23, s18, 147456
    s_mov_b32 s40, s36
    s_mov_b32 s41, s37
    s_mov_b32 s42, 24576
    s_mov_b32 s43, 0x20000
    s_add_u32 s48, s36, 27262976
    s_addc_u32 s49, s37, 0
    s_mov_b32 s50, 4194304
    s_mov_b32 s51, 0x20000
    s_lshl_b32 s20, s4, 2
    s_add_u32 s20, s20, s3
    s_lshl_b32 s20, s20, 15
    s_lshl_b32 s21, s5, 12
    s_add_u32 s20, s20, s21
    v_lshl_add_u32 v40, v1, 4, s20
    s_lshl_b32 s21, s5, 9
    s_add_u32 s21, s21, 20480
    v_lshl_add_u32 v44, v1, 4, s21
    s_add_u32 s22, s18, 0
    s_add_u32 m0, s22, 8192
    s_nop 0
    buffer_load_dwordx4 v10, s[12:15], s17 offen sc1 lds
    s_add_u32 m0, s22, 12288
    s_nop 0
    buffer_load_dwordx4 v11, s[12:15], s17 offen sc1 lds
    s_add_u32 m0, s22, 16384
    s_nop 0
    buffer_load_dwordx4 v12, s[12:15], s17 offen sc1 lds
    s_add_u32 m0, s22, 20480
    s_nop 0
    buffer_load_dwordx4 v13, s[12:15], s17 offen sc1 lds
    s_add_u32 s17, s17, 2048
    s_barrier
    s_add_u32 s22, s18, 24576
    s_add_u32 m0, s22, 8192
    s_nop 0
    buffer_load_dwordx4 v10, s[12:15], s17 offen sc1 lds
    s_add_u32 m0, s22, 12288
    s_nop 0
    buffer_load_dwordx4 v11, s[12:15], s17 offen sc1 lds
    s_add_u32 m0, s22, 16384
    s_nop 0
    buffer_load_dwordx4 v12, s[12:15], s17 offen sc1 lds
    s_add_u32 m0, s22, 20480
    s_nop 0
    buffer_load_dwordx4 v13, s[12:15], s17 offen sc1 lds
    s_add_u32 s17, s17, 2048
    s_add_u32 s22, s18, 49152
    s_add_u32 m0, s22, 8192
    s_nop 0
    buffer_load_dwordx4 v10, s[12:15], s17 offen sc1 lds
    s_add_u32 m0, s22, 12288
    s_nop 0
    buffer_load_dwordx4 v11, s[12:15], s17 offen sc1 lds
    s_add_u32 m0, s22, 16384
    s_nop 0
    buffer_load_dwordx4 v12, s[12:15], s17 offen sc1 lds
    s_add_u32 m0, s22, 20480
    s_nop 0
    buffer_load_dwordx4 v13, s[12:15], s17 offen sc1 lds
    s_add_u32 s17, s17, 2048
    s_add_u32 s22, s18, 73728
    s_add_u32 m0, s22, 8192
    s_nop 0
    buffer_load_dwordx4 v10, s[12:15], s17 offen sc1 lds
    s_add_u32 m0, s22, 12288
    s_nop 0
    buffer_load_dwordx4 v11, s[12:15], s17 offen sc1 lds
    s_add_u32 m0, s22, 16384
    s_nop 0
    buffer_load_dwordx4 v12, s[12:15], s17 offen sc1 lds
    s_add_u32 m0, s22, 20480
    s_nop 0
    buffer_load_dwordx4 v13, s[12:15], s17 offen sc1 lds
    s_add_u32 s17, s17, 2048
    s_add_u32 s22, s18, 98304
    s_add_u32 m0, s22, 8192
    s_nop 0
    buffer_load_dwordx4 v10, s[12:15], s17 offen sc1 lds
    s_add_u32 m0, s22, 12288
    s_nop 0
    buffer_load_dwordx4 v11, s[12:15], s17 offen sc1 lds
    s_add_u32 m0, s22, 16384
    s_nop 0
    buffer_load_dwordx4 v12, s[12:15], s17 offen sc1 lds
    s_add_u32 m0, s22, 20480
    s_nop 0
    buffer_load_dwordx4 v13, s[12:15], s17 offen sc1 lds
    s_add_u32 s17, s17, 2048
    s_add_u32 s22, s18, 122880
    s_add_u32 m0, s22, 8192
    s_nop 0
    buffer_load_dwordx4 v10, s[12:15], s17 offen sc1 lds
    s_add_u32 m0, s22, 12288
    s_nop 0
    buffer_load_dwordx4 v11, s[12:15], s17 offen sc1 lds
    s_add_u32 m0, s22, 16384
    s_nop 0
    buffer_load_dwordx4 v12, s[12:15], s17 offen sc1 lds
    s_add_u32 m0, s22, 20480
    s_nop 0
    buffer_load_dwordx4 v13, s[12:15], s17 offen sc1 lds
    s_add_u32 s17, s17, 2048
    s_barrier
    s_add_u32 s22, s18, 0
    s_add_u32 m0, s22, 0
    s_nop 0
    buffer_load_dwordx4 v8, s[8:11], s16 offen sc1 lds
    s_add_u32 m0, s22, 4096
    s_nop 0
    buffer_load_dwordx4 v9, s[8:11], s16 offen sc1 lds
    s_add_u32 s16, s16, 2048
    s_add_u32 s22, s18, 24576
    s_add_u32 m0, s22, 0
    s_nop 0
    buffer_load_dwordx4 v8, s[8:11], s16 offen sc1 lds
    s_add_u32 m0, s22, 4096
    s_nop 0
    buffer_load_dwordx4 v9, s[8:11], s16 offen sc1 lds
    s_add_u32 s16, s16, 2048
    s_add_u32 s22, s18, 49152
    s_add_u32 m0, s22, 0
    s_nop 0
    buffer_load_dwordx4 v8, s[8:11], s16 offen sc1 lds
    s_add_u32 m0, s22, 4096
    s_nop 0
    buffer_load_dwordx4 v9, s[8:11], s16 offen sc1 lds
    s_add_u32 s16, s16, 2048
    s_add_u32 s22, s18, 73728
    s_add_u32 m0, s22, 0
    s_nop 0
    buffer_load_dwordx4 v8, s[8:11], s16 offen sc1 lds
    s_add_u32 m0, s22, 4096
    s_nop 0
    buffer_load_dwordx4 v9, s[8:11], s16 offen sc1 lds
    s_add_u32 s16, s16, 2048
    s_add_u32 s22, s18, 98304
    s_add_u32 m0, s22, 0
    s_nop 0
    buffer_load_dwordx4 v8, s[8:11], s16 offen sc1 lds
    s_add_u32 m0, s22, 4096
    s_nop 0
    buffer_load_dwordx4 v9, s[8:11], s16 offen sc1 lds
    s_add_u32 s16, s16, 2048
    s_add_u32 s22, s18, 122880
    s_add_u32 m0, s22, 0
    s_nop 0
    buffer_load_dwordx4 v8, s[8:11], s16 offen sc1 lds
    s_add_u32 m0, s22, 4096
    s_nop 0
    buffer_load_dwordx4 v9, s[8:11], s16 offen sc1 lds
    s_add_u32 s16, s16, 2048
    s_waitcnt vmcnt(10)
    s_barrier
    s_waitcnt vmcnt(8)
    s_barrier
    s_add_u32 m0, s18, 0
    s_nop 0
    buffer_load_dwordx4 v8, s[8:11], s16 offen sc1 lds
    s_add_u32 m0, s18, 4096
    s_nop 0
    buffer_load_dwordx4 v9, s[8:11], s16 offen sc1 lds
    s_add_u32 s16, s16, 2048
    s_add_u32 m0, s18, 8192
    s_nop 0
    buffer_load_dwordx4 v10, s[12:15], s17 offen sc1 lds
    s_add_u32 m0, s18, 12288
    s_nop 0
    buffer_load_dwordx4 v11, s[12:15], s17 offen sc1 lds
    s_add_u32 m0, s18, 16384
    s_nop 0
    buffer_load_dwordx4 v12, s[12:15], s17 offen sc1 lds
    s_add_u32 m0, s18, 20480
    s_nop 0
    buffer_load_dwordx4 v13, s[12:15], s17 offen sc1 lds
    s_add_u32 s17, s17, 2048
    s_add_u32 s18, s18, 24576
    s_cmp_ge_u32 s18, s23
    s_cselect_b32 s20, 147456, 0
    s_sub_u32 s18, s18, s20
    s_waitcnt vmcnt(12)
    s_barrier
    s_add_u32 m0, s18, 0
    s_nop 0
    buffer_load_dwordx4 v8, s[8:11], s16 offen sc1 lds
    s_add_u32 m0, s18, 4096
    s_nop 0
    buffer_load_dwordx4 v9, s[8:11], s16 offen sc1 lds
    s_add_u32 s16, s16, 2048
    s_add_u32 m0, s18, 8192
    s_nop 0
    buffer_load_dwordx4 v10, s[12:15], s17 offen sc1 lds
    s_add_u32 m0, s18, 12288
    s_nop 0
    buffer_load_dwordx4 v11, s[12:15], s17 offen sc1 lds
    s_add_u32 m0, s18, 16384
    s_nop 0
    buffer_load_dwordx4 v12, s[12:15], s17 offen sc1 lds
    s_add_u32 m0, s18, 20480
    s_nop 0
    buffer_load_dwordx4 v13, s[12:15], s17 offen sc1 lds
    s_add_u32 s17, s17, 2048
    s_add_u32 s18, s18, 24576
    s_cmp_ge_u32 s18, s23
    s_cselect_b32 s20, 147456, 0
    s_sub_u32 s18, s18, s20
    s_waitcnt vmcnt(16)
    s_barrier
    s_add_u32 m0, s18, 0
    s_nop 0
    buffer_load_dwordx4 v8, s[8:11], s16 offen sc1 lds
    s_add_u32 m0, s18, 4096
    s_nop 0
    buffer_load_dwordx4 v9, s[8:11], s16 offen sc1 lds
    s_add_u32 s16, s16, 2048
    s_add_u32 m0, s18, 8192
    s_nop 0
    buffer_load_dwordx4 v10, s[12:15], s17 offen sc1 lds
    s_add_u32 m0, s18, 12288
    s_nop 0
    buffer_load_dwordx4 v11, s[12:15], s17 offen sc1 lds
    s_add_u32 m0, s18, 16384
    s_nop 0
    buffer_load_dwordx4 v12, s[12:15], s17 offen sc1 lds
    s_add_u32 m0, s18, 20480
    s_nop 0
    buffer_load_dwordx4 v13, s[12:15], s17 offen sc1 lds
    s_add_u32 s17, s17, 2048
    s_add_u32 s18, s18, 24576
    s_cmp_ge_u32 s18, s23
    s_cselect_b32 s20, 147456, 0
    s_sub_u32 s18, s18, s20
    s_waitcnt vmcnt(20)
    s_barrier
    s_add_u32 m0, s18, 0
    s_nop 0
    buffer_load_dwordx4 v8, s[8:11], s16 offen sc1 lds
    s_add_u32 m0, s18, 4096
    s_nop 0
    buffer_load_dwordx4 v9, s[8:11], s16 offen sc1 lds
    s_add_u32 s16, s16, 2048
    s_add_u32 m0, s18, 8192
    s_nop 0
    buffer_load_dwordx4 v10, s[12:15], s17 offen sc1 lds
    s_add_u32 m0, s18, 12288
    s_nop 0
    buffer_load_dwordx4 v11, s[12:15], s17 offen sc1 lds
    s_add_u32 m0, s18, 16384
    s_nop 0
    buffer_load_dwordx4 v12, s[12:15], s17 offen sc1 lds
    s_add_u32 m0, s18, 20480
    s_nop 0
    buffer_load_dwordx4 v13, s[12:15], s17 offen sc1 lds
    s_add_u32 s17, s17, 2048
    s_add_u32 s18, s18, 24576
    s_cmp_ge_u32 s18, s23
    s_cselect_b32 s20, 147456, 0
    s_sub_u32 s18, s18, s20
    s_mov_b32 s19, 18
adaLN_cond__mha_block__mixer_gmlp__prompt_kernel_o_ld_loop0:
    s_waitcnt vmcnt(24)
    s_barrier
    s_add_u32 m0, s18, 0
    s_nop 0
    buffer_load_dwordx4 v8, s[8:11], s16 offen sc1 lds
    s_add_u32 m0, s18, 4096
    s_nop 0
    buffer_load_dwordx4 v9, s[8:11], s16 offen sc1 lds
    s_add_u32 s16, s16, 2048
    s_add_u32 m0, s18, 8192
    s_nop 0
    buffer_load_dwordx4 v10, s[12:15], s17 offen sc1 lds
    s_add_u32 m0, s18, 12288
    s_nop 0
    buffer_load_dwordx4 v11, s[12:15], s17 offen sc1 lds
    s_add_u32 m0, s18, 16384
    s_nop 0
    buffer_load_dwordx4 v12, s[12:15], s17 offen sc1 lds
    s_add_u32 m0, s18, 20480
    s_nop 0
    buffer_load_dwordx4 v13, s[12:15], s17 offen sc1 lds
    s_add_u32 s17, s17, 2048
    s_add_u32 s18, s18, 24576
    s_cmp_ge_u32 s18, s23
    s_cselect_b32 s20, 147456, 0
    s_sub_u32 s18, s18, s20
    s_sub_u32 s19, s19, 1
    s_cmp_lg_u32 s19, 0
    s_cbranch_scc1 adaLN_cond__mha_block__mixer_gmlp__prompt_kernel_o_ld_loop0
    s_waitcnt vmcnt(24)
    s_barrier
    s_lshl_b32 s20, s3, 12
    s_add_u32 m0, s20, 98304
    s_nop 0
    buffer_load_dwordx4 v40, s[48:51], 0 offen offset:0 sc1 lds
    buffer_load_dwordx4 v40, s[48:51], 0 offen offset:1024 sc1 lds
    buffer_load_dwordx4 v40, s[48:51], 0 offen offset:2048 sc1 lds
    buffer_load_dwordx4 v40, s[48:51], 0 offen offset:3072 sc1 lds
    buffer_load_dwordx4 v[48:51], v44, s[40:43], 0 offen sc1
    s_waitcnt vmcnt(23)
    s_barrier
    s_waitcnt vmcnt(17)
    s_barrier
    s_waitcnt vmcnt(11)
    s_barrier
    s_waitcnt vmcnt(5)
    s_barrier
    s_waitcnt vmcnt(0)
    v_cvt_pk_bf16_f32 v48, v48, v48
    v_and_b32 v48, 0xffff0000, v48
    v_cvt_pk_bf16_f32 v49, v49, v49
    v_and_b32 v49, 0xffff0000, v49
    v_cvt_pk_bf16_f32 v50, v50, v50
    v_and_b32 v50, 0xffff0000, v50
    v_cvt_pk_bf16_f32 v51, v51, v51
    v_and_b32 v51, 0xffff0000, v51
    v_lshlrev_b32 v2, 4, v1
    v_add_u32 v2, 114688, v2
    ds_write_b128 v2, v[48:51]
    s_waitcnt lgkmcnt(0)
    s_barrier
    s_endpgm
adaLN_cond__mha_block__mixer_gmlp__prompt_kernel_comp:
    v_and_b32 v1, 63, v0
    s_and_b32 s4, s2, 15
    s_lshr_b32 s5, s2, 4
    s_lshl_b32 s6, s5, 2
    s_add_u32 s6, s6, s3
    s_lshl_b32 s6, s6, 1
    v_and_b32 v2, 15, v1
    v_lshrrev_b32 v3, 4, v1
    v_lshlrev_b32 v4, 11, v2
    v_lshl_add_u32 v4, v3, 4, v4
    s_lshl_b32 s20, s6, 15
    s_lshl_b32 s21, s4, 7
    s_add_u32 s20, s20, s21
    s_add_u32 s21, s20, 32768
    v_lshlrev_b32 v5, 3, v2
    s_lshl_b32 s22, s6, 7
    s_add_u32 s22, s22, 229376
    s_lshl_b32 s7, s4, 6
    s_lshl_b32 s23, s3, 10
    s_add_u32 s7, s7, s23
    s_lshl_b32 s24, s7, 2
    v_lshlrev_b32 v6, 2, v1
    s_mov_b32 s8, s76
    s_mov_b32 s9, s77
    s_mov_b32 s10, 4194304
    s_mov_b32 s11, 0x20000
    s_mov_b32 s12, s36
    s_mov_b32 s13, s37
    s_mov_b32 s14, 1048576
    s_mov_b32 s15, 0x20000
    buffer_load_dwordx4 v[8:11], v4, s[8:11], s20 offen
    buffer_load_dwordx4 v[12:15], v4, s[8:11], s20 offen offset:64
    buffer_load_dwordx4 v[16:19], v4, s[8:11], s21 offen
    buffer_load_dwordx4 v[20:23], v4, s[8:11], s21 offen offset:64
    s_cmp_ge_u32 s3, 3
    s_cbranch_scc1 adaLN_cond__mha_block__mixer_gmlp__prompt_kernel_ln_np
    s_lshr_b32 s20, s4, 1
    s_lshl_b32 s21, s3, 3
    s_add_u32 s20, s20, s21
    s_cmp_eq_u32 s3, 2
    s_cselect_b32 s20, s5, s20
    s_add_u32 s20, s20, 112
    s_mul_i32 s20, s20, 4352
    v_and_b32 v2, 63, v0
    v_lshlrev_b32 v2, 7, v2
    s_bfm_b64 exec, 16, 0
    s_mov_b32 s19, 0x80000
adaLN_cond__mha_block__mixer_gmlp__prompt_kernel_ln_dp:
    buffer_load_dword v240, v2, s[96:99], s20 offen sc1
    s_waitcnt vmcnt(0)
    v_cmp_ne_u32 vcc, s101, v240
    s_sub_u32 s19, s19, 1
    s_cmp_eq_u32 s19, 0
    s_cbranch_scc1 adaLN_cond__mha_block__mixer_gmlp__prompt_kernel_ln_dp_d
    s_cbranch_vccz adaLN_cond__mha_block__mixer_gmlp__prompt_kernel_ln_dp_d
    s_sleep 4
    s_branch adaLN_cond__mha_block__mixer_gmlp__prompt_kernel_ln_dp
adaLN_cond__mha_block__mixer_gmlp__prompt_kernel_ln_dp_d:
    s_mov_b64 exec, -1
adaLN_cond__mha_block__mixer_gmlp__prompt_kernel_ln_np:
    s_barrier
    s_add_u32 s16, s36, 2097152
    s_addc_u32 s17, s37, 0
    s_mov_b32 s18, 4194304
    s_mov_b32 s19, 0x20000
    s_cmp_ge_u32 s3, 2
    s_cbranch_scc1 adaLN_cond__mha_block__mixer_gmlp__prompt_kernel_ln_nop
    s_add_u32 s25, s24, 262144
    buffer_load_dword v32, v6, s[12:15], s25 offen sc1
    s_add_u32 s25, s25, 8192
    buffer_load_dword v33, v6, s[12:15], s25 offen sc1
    s_add_u32 s25, s25, 8192
    buffer_load_dword v34, v6, s[12:15], s25 offen sc1
    s_add_u32 s25, s25, 8192
    buffer_load_dword v35, v6, s[12:15], s25 offen sc1
    s_add_u32 s25, s25, 8192
    buffer_load_dword v36, v6, s[12:15], s25 offen sc1
    s_add_u32 s25, s25, 8192
    buffer_load_dword v37, v6, s[12:15], s25 offen sc1
    s_add_u32 s25, s25, 8192
    buffer_load_dword v38, v6, s[12:15], s25 offen sc1
    s_add_u32 s25, s25, 8192
    buffer_load_dword v39, v6, s[12:15], s25 offen sc1
    s_add_u32 s25, s25, 8192
    buffer_load_dword v40, v6, s[12:15], s25 offen sc1
    s_add_u32 s25, s25, 8192
    buffer_load_dword v41, v6, s[12:15], s25 offen sc1
    s_add_u32 s25, s25, 8192
    buffer_load_dword v42, v6, s[12:15], s25 offen sc1
    s_add_u32 s25, s25, 8192
    buffer_load_dword v43, v6, s[12:15], s25 offen sc1
    s_add_u32 s25, s25, 8192
    buffer_load_dword v44, v6, s[12:15], s25 offen sc1
    s_add_u32 s25, s25, 8192
    buffer_load_dword v45, v6, s[12:15], s25 offen sc1
    s_add_u32 s25, s25, 8192
    buffer_load_dword v46, v6, s[12:15], s25 offen sc1
    s_add_u32 s25, s25, 8192
    buffer_load_dword v47, v6, s[12:15], s25 offen sc1
adaLN_cond__mha_block__mixer_gmlp__prompt_kernel_ln_nop:
    buffer_load_dwordx2 v[48:49], v5, s[12:15], s22 offen offset:0 sc1
    buffer_load_dwordx2 v[50:51], v5, s[12:15], s22 offen offset:128 sc1
    s_cmp_ge_u32 s3, 2
    s_cbranch_scc1 adaLN_cond__mha_block__mixer_gmlp__prompt_kernel_ln_bar
    s_waitcnt vmcnt(2)
    v_add_f32 v32, v32, v33
    v_add_f32 v32, v32, v34
    v_add_f32 v32, v32, v35
    v_add_f32 v32, v32, v36
    v_add_f32 v32, v32, v37
    v_add_f32 v32, v32, v38
    v_add_f32 v32, v32, v39
    v_add_f32 v32, v32, v40
    v_add_f32 v32, v32, v41
    v_add_f32 v32, v32, v42
    v_add_f32 v32, v32, v43
    v_add_f32 v32, v32, v44
    v_add_f32 v32, v32, v45
    v_add_f32 v32, v32, v46
    v_add_f32 v32, v32, v47
    v_cvt_pk_bf16_f32 v32, v32, v32
    v_and_b32 v32, 0xffff0000, v32
    s_cmp_eq_u32 s3, 0
    s_cbranch_scc1 adaLN_cond__mha_block__mixer_gmlp__prompt_kernel_ln_st
    v_add_f32 v32, 1.0, v32
    v_cvt_pk_bf16_f32 v32, v32, v32
    v_and_b32 v32, 0xffff0000, v32
adaLN_cond__mha_block__mixer_gmlp__prompt_kernel_ln_st:
    s_lshl_b32 s25, s3, 8
    s_add_u32 s25, s25, 122880
    v_add_u32 v7, s25, v6
    ds_write_b32 v7, v32
adaLN_cond__mha_block__mixer_gmlp__prompt_kernel_ln_bar:
    v_lshlrev_b32 v7, 5, v3
    v_add_u32 v7, 122880, v7
    s_waitcnt lgkmcnt(0)
    s_barrier
    ds_read_b128 v[32:35], v7 offset:0
    ds_read_b128 v[52:55], v7 offset:256
    ds_read_b128 v[36:39], v7 offset:16
    ds_read_b128 v[56:59], v7 offset:272
    ds_read_b128 v[40:43], v7 offset:128
    ds_read_b128 v[60:63], v7 offset:384
    ds_read_b128 v[44:47], v7 offset:144
    ds_read_b128 v[64:67], v7 offset:400
    v_lshlrev_b32 v5, 4, v1
    s_lshl_b32 s20, s6, 15
    s_lshl_b32 s21, s4, 11
    s_add_u32 s20, s20, s21
    s_add_u32 s21, s20, 32768
    s_waitcnt vmcnt(0) lgkmcnt(0)
    v_lshlrev_b32 v72, 16, v8
    v_and_b32 v73, 0xffff0000, v8
    v_lshlrev_b32 v74, 16, v9
    v_and_b32 v75, 0xffff0000, v9
    v_lshlrev_b32 v76, 16, v10
    v_and_b32 v77, 0xffff0000, v10
    v_lshlrev_b32 v78, 16, v11
    v_and_b32 v79, 0xffff0000, v11
    v_lshlrev_b32 v80, 16, v12
    v_and_b32 v81, 0xffff0000, v12
    v_lshlrev_b32 v82, 16, v13
    v_and_b32 v83, 0xffff0000, v13
    v_lshlrev_b32 v84, 16, v14
    v_and_b32 v85, 0xffff0000, v14
    v_lshlrev_b32 v86, 16, v15
    v_and_b32 v87, 0xffff0000, v15
    v_pk_fma_f32 v[72:73], v[72:73], v[48:49], v[48:49] op_sel:[0,0,1] op_sel_hi:[1,0,1]
    v_pk_fma_f32 v[74:75], v[74:75], v[48:49], v[48:49] op_sel:[0,0,1] op_sel_hi:[1,0,1]
    v_pk_fma_f32 v[76:77], v[76:77], v[48:49], v[48:49] op_sel:[0,0,1] op_sel_hi:[1,0,1]
    v_pk_fma_f32 v[78:79], v[78:79], v[48:49], v[48:49] op_sel:[0,0,1] op_sel_hi:[1,0,1]
    v_pk_fma_f32 v[80:81], v[80:81], v[48:49], v[48:49] op_sel:[0,0,1] op_sel_hi:[1,0,1]
    v_pk_fma_f32 v[82:83], v[82:83], v[48:49], v[48:49] op_sel:[0,0,1] op_sel_hi:[1,0,1]
    v_pk_fma_f32 v[84:85], v[84:85], v[48:49], v[48:49] op_sel:[0,0,1] op_sel_hi:[1,0,1]
    v_pk_fma_f32 v[86:87], v[86:87], v[48:49], v[48:49] op_sel:[0,0,1] op_sel_hi:[1,0,1]
    v_pk_fma_f32 v[72:73], v[72:73], v[52:53], v[32:33]
    v_pk_fma_f32 v[74:75], v[74:75], v[54:55], v[34:35]
    v_pk_fma_f32 v[76:77], v[76:77], v[56:57], v[36:37]
    v_pk_fma_f32 v[78:79], v[78:79], v[58:59], v[38:39]
    v_pk_fma_f32 v[80:81], v[80:81], v[60:61], v[40:41]
    v_pk_fma_f32 v[82:83], v[82:83], v[62:63], v[42:43]
    v_pk_fma_f32 v[84:85], v[84:85], v[64:65], v[44:45]
    v_pk_fma_f32 v[86:87], v[86:87], v[66:67], v[46:47]
    v_cvt_pk_bf16_f32 v88, v72, v73
    v_cvt_pk_bf16_f32 v89, v74, v75
    v_cvt_pk_bf16_f32 v90, v76, v77
    v_cvt_pk_bf16_f32 v91, v78, v79
    v_cvt_pk_bf16_f32 v92, v80, v81
    v_cvt_pk_bf16_f32 v93, v82, v83
    v_cvt_pk_bf16_f32 v94, v84, v85
    v_cvt_pk_bf16_f32 v95, v86, v87
    buffer_store_dwordx4 v[88:91], v5, s[16:19], s20 offen sc1
    buffer_store_dwordx4 v[92:95], v5, s[16:19], s20 offen offset:1024 sc1
    v_lshlrev_b32 v72, 16, v16
    v_and_b32 v73, 0xffff0000, v16
    v_lshlrev_b32 v74, 16, v17
    v_and_b32 v75, 0xffff0000, v17
    v_lshlrev_b32 v76, 16, v18
    v_and_b32 v77, 0xffff0000, v18
    v_lshlrev_b32 v78, 16, v19
    v_and_b32 v79, 0xffff0000, v19
    v_lshlrev_b32 v80, 16, v20
    v_and_b32 v81, 0xffff0000, v20
    v_lshlrev_b32 v82, 16, v21
    v_and_b32 v83, 0xffff0000, v21
    v_lshlrev_b32 v84, 16, v22
    v_and_b32 v85, 0xffff0000, v22
    v_lshlrev_b32 v86, 16, v23
    v_and_b32 v87, 0xffff0000, v23
    v_pk_fma_f32 v[72:73], v[72:73], v[50:51], v[50:51] op_sel:[0,0,1] op_sel_hi:[1,0,1]
    v_pk_fma_f32 v[74:75], v[74:75], v[50:51], v[50:51] op_sel:[0,0,1] op_sel_hi:[1,0,1]
    v_pk_fma_f32 v[76:77], v[76:77], v[50:51], v[50:51] op_sel:[0,0,1] op_sel_hi:[1,0,1]
    v_pk_fma_f32 v[78:79], v[78:79], v[50:51], v[50:51] op_sel:[0,0,1] op_sel_hi:[1,0,1]
    v_pk_fma_f32 v[80:81], v[80:81], v[50:51], v[50:51] op_sel:[0,0,1] op_sel_hi:[1,0,1]
    v_pk_fma_f32 v[82:83], v[82:83], v[50:51], v[50:51] op_sel:[0,0,1] op_sel_hi:[1,0,1]
    v_pk_fma_f32 v[84:85], v[84:85], v[50:51], v[50:51] op_sel:[0,0,1] op_sel_hi:[1,0,1]
    v_pk_fma_f32 v[86:87], v[86:87], v[50:51], v[50:51] op_sel:[0,0,1] op_sel_hi:[1,0,1]
    v_pk_fma_f32 v[72:73], v[72:73], v[52:53], v[32:33]
    v_pk_fma_f32 v[74:75], v[74:75], v[54:55], v[34:35]
    v_pk_fma_f32 v[76:77], v[76:77], v[56:57], v[36:37]
    v_pk_fma_f32 v[78:79], v[78:79], v[58:59], v[38:39]
    v_pk_fma_f32 v[80:81], v[80:81], v[60:61], v[40:41]
    v_pk_fma_f32 v[82:83], v[82:83], v[62:63], v[42:43]
    v_pk_fma_f32 v[84:85], v[84:85], v[64:65], v[44:45]
    v_pk_fma_f32 v[86:87], v[86:87], v[66:67], v[46:47]
    v_cvt_pk_bf16_f32 v96, v72, v73
    v_cvt_pk_bf16_f32 v97, v74, v75
    v_cvt_pk_bf16_f32 v98, v76, v77
    v_cvt_pk_bf16_f32 v99, v78, v79
    v_cvt_pk_bf16_f32 v100, v80, v81
    v_cvt_pk_bf16_f32 v101, v82, v83
    v_cvt_pk_bf16_f32 v102, v84, v85
    v_cvt_pk_bf16_f32 v103, v86, v87
    buffer_store_dwordx4 v[96:99], v5, s[16:19], s21 offen sc1
    buffer_store_dwordx4 v[100:103], v5, s[16:19], s21 offen offset:1024 sc1
    s_mov_b32 s21, s4
    s_add_u32 s20, s5, 0
    s_mul_i32 s20, s20, 4352
    s_lshl_b32 s21, s21, 7
    s_add_u32 s20, s20, s21
    v_mov_b32 v2, s101
    v_mov_b32 v3, 0
    s_cmp_eq_u32 s3, 0
    s_waitcnt vmcnt(0)
    s_barrier
    s_cbranch_scc0 adaLN_cond__mha_block__mixer_gmlp__prompt_kernel_ln_sig
    s_mov_b64 exec, 1
    buffer_store_dword v2, v3, s[96:99], s20 offen sc1
    s_mov_b64 exec, -1
adaLN_cond__mha_block__mixer_gmlp__prompt_kernel_ln_sig:
    s_and_b32 s20, s2, 7
    s_lshr_b32 s21, s2, 3
    s_and_b32 s4, s20, 1
    s_lshl_b32 s4, s4, 3
    s_and_b32 s22, s21, 7
    s_add_u32 s4, s4, s22
    s_lshr_b32 s5, s20, 1
    s_mul_i32 s5, s5, 4
    s_lshr_b32 s22, s21, 3
    s_add_u32 s5, s5, s22
    s_cmp_eq_u32 s3, 0
    s_cbranch_scc0 adaLN_cond__mha_block__mixer_gmlp__prompt_kernel_q_np
    s_add_u32 s20, s4, 0
    s_mul_i32 s20, s20, 4352
    v_and_b32 v2, 63, v0
    v_lshlrev_b32 v2, 7, v2
    s_bfm_b64 exec, 16, 0
    s_mov_b32 s19, 0x80000
adaLN_cond__mha_block__mixer_gmlp__prompt_kernel_q_dp:
    buffer_load_dword v240, v2, s[96:99], s20 offen sc1
    s_waitcnt vmcnt(0)
    v_cmp_ne_u32 vcc, s101, v240
    s_sub_u32 s19, s19, 1
    s_cmp_eq_u32 s19, 0
    s_cbranch_scc1 adaLN_cond__mha_block__mixer_gmlp__prompt_kernel_q_dp_d
    s_cbranch_vccz adaLN_cond__mha_block__mixer_gmlp__prompt_kernel_q_dp_d
    s_sleep 4
    s_branch adaLN_cond__mha_block__mixer_gmlp__prompt_kernel_q_dp
adaLN_cond__mha_block__mixer_gmlp__prompt_kernel_q_dp_d:
    s_mov_b64 exec, -1
adaLN_cond__mha_block__mixer_gmlp__prompt_kernel_q_np:
    s_barrier
    v_and_b32 v1, 63, v0
    s_and_b32 s6, s3, 1
    s_lshr_b32 s7, s3, 1
    v_lshlrev_b32 v184, 4, v1
    s_lshl_b32 s20, s6, 13
    v_add_u32 v184, s20, v184
    v_lshrrev_b32 v2, 4, v1
    v_bfe_u32 v3, v1, 2, 2
    v_lshl_add_u32 v4, v2, 3, v3
    v_and_b32 v5, 3, v1
    v_lshlrev_b32 v5, 3, v5
    v_and_b32 v2, 1, v2
    v_lshrrev_b32 v3, 1, v3
    v_lshl_or_b32 v3, v2, 1, v3
    s_mov_b32 s20, 0
    s_lshl_b32 s21, s7, 1
    s_add_u32 s21, s21, 0
    v_xor_b32 v6, s21, v3
    v_lshl_add_u32 v6, v6, 5, v5
    v_lshl_add_u32 v6, v4, 7, v6
    s_add_u32 s20, s20, 16384
    v_add_u32 v186, s20, v6
    s_mov_b32 s20, 0
    s_lshl_b32 s21, s7, 1
    s_add_u32 s21, s21, 1
    v_xor_b32 v6, s21, v3
    v_lshl_add_u32 v6, v6, 5, v5
    v_lshl_add_u32 v6, v4, 7, v6
    s_add_u32 s20, s20, 16384
    v_add_u32 v187, s20, v6
    s_mov_b32 s20, 8192
    s_lshl_b32 s21, s7, 1
    s_add_u32 s21, s21, 0
    v_xor_b32 v6, s21, v3
    v_lshl_add_u32 v6, v6, 5, v5
    v_lshl_add_u32 v6, v4, 7, v6
    s_add_u32 s20, s20, 16384
    v_add_u32 v188, s20, v6
    s_mov_b32 s20, 8192
    s_lshl_b32 s21, s7, 1
    s_add_u32 s21, s21, 1
    v_xor_b32 v6, s21, v3
    v_lshl_add_u32 v6, v6, 5, v5
    v_lshl_add_u32 v6, v4, 7, v6
    s_add_u32 s20, s20, 16384
    v_add_u32 v189, s20, v6
    s_mov_b32 s20, 16384
    s_lshl_b32 s21, s7, 1
    s_add_u32 s21, s21, 0
    v_xor_b32 v6, s21, v3
    v_lshl_add_u32 v6, v6, 5, v5
    v_lshl_add_u32 v6, v4, 7, v6
    s_add_u32 s20, s20, 16384
    v_add_u32 v190, s20, v6
    s_mov_b32 s20, 16384
    s_lshl_b32 s21, s7, 1
    s_add_u32 s21, s21, 1
    v_xor_b32 v6, s21, v3
    v_lshl_add_u32 v6, v6, 5, v5
    v_lshl_add_u32 v6, v4, 7, v6
    s_add_u32 s20, s20, 16384
    v_add_u32 v191, s20, v6
    v_mov_b32 v8, 0
    v_mov_b32 v9, 0
    v_mov_b32 v10, 0
    v_mov_b32 v11, 0
    v_mov_b32 v12, 0
    v_mov_b32 v13, 0
    v_mov_b32 v14, 0
    v_mov_b32 v15, 0
    v_mov_b32 v16, 0
    v_mov_b32 v17, 0
    v_mov_b32 v18, 0
    v_mov_b32 v19, 0
    v_mov_b32 v20, 0
    v_mov_b32 v21, 0
    v_mov_b32 v22, 0
    v_mov_b32 v23, 0
    v_mov_b32 v24, 0
    v_mov_b32 v25, 0
    v_mov_b32 v26, 0
    v_mov_b32 v27, 0
    v_mov_b32 v28, 0
    v_mov_b32 v29, 0
    v_mov_b32 v30, 0
    v_mov_b32 v31, 0
    v_mov_b32 v32, 0
    v_mov_b32 v33, 0
    v_mov_b32 v34, 0
    v_mov_b32 v35, 0
    v_mov_b32 v36, 0
    v_mov_b32 v37, 0
    v_mov_b32 v38, 0
    v_mov_b32 v39, 0
    v_mov_b32 v40, 0
    v_mov_b32 v41, 0
    v_mov_b32 v42, 0
    v_mov_b32 v43, 0
    v_mov_b32 v44, 0
    v_mov_b32 v45, 0
    v_mov_b32 v46, 0
    v_mov_b32 v47, 0
    v_mov_b32 v48, 0
    v_mov_b32 v49, 0
    v_mov_b32 v50, 0
    v_mov_b32 v51, 0
    v_mov_b32 v52, 0
    v_mov_b32 v53, 0
    v_mov_b32 v54, 0
    v_mov_b32 v55, 0
    v_mov_b32 v56, 0
    v_mov_b32 v57, 0
    v_mov_b32 v58, 0
    v_mov_b32 v59, 0
    v_mov_b32 v60, 0
    v_mov_b32 v61, 0
    v_mov_b32 v62, 0
    v_mov_b32 v63, 0
    v_mov_b32 v64, 0
    v_mov_b32 v65, 0
    v_mov_b32 v66, 0
    v_mov_b32 v67, 0
    v_mov_b32 v68, 0
    v_mov_b32 v69, 0
    v_mov_b32 v70, 0
    v_mov_b32 v71, 0
    v_mov_b32 v72, 0
    v_mov_b32 v73, 0
    v_mov_b32 v74, 0
    v_mov_b32 v75, 0
    v_mov_b32 v76, 0
    v_mov_b32 v77, 0
    v_mov_b32 v78, 0
    v_mov_b32 v79, 0
    v_mov_b32 v80, 0
    v_mov_b32 v81, 0
    v_mov_b32 v82, 0
    v_mov_b32 v83, 0
    v_mov_b32 v84, 0
    v_mov_b32 v85, 0
    v_mov_b32 v86, 0
    v_mov_b32 v87, 0
    v_mov_b32 v88, 0
    v_mov_b32 v89, 0
    v_mov_b32 v90, 0
    v_mov_b32 v91, 0
    v_mov_b32 v92, 0
    v_mov_b32 v93, 0
    v_mov_b32 v94, 0
    v_mov_b32 v95, 0
    v_mov_b32 v96, 0
    v_mov_b32 v97, 0
    v_mov_b32 v98, 0
    v_mov_b32 v99, 0
    v_mov_b32 v100, 0
    v_mov_b32 v101, 0
    v_mov_b32 v102, 0
    v_mov_b32 v103, 0
    s_add_u32 s24, s36, 6291456
    s_addc_u32 s25, s37, 0
    s_mov_b32 s26, 4194304
    s_mov_b32 s27, 0x20000
    s_add_u32 s40, s36, 10485760
    s_addc_u32 s41, s37, 0
    s_mov_b32 s42, 8388608
    s_mov_b32 s43, 0x20000
    v_bfe_u32 v198, v1, 4, 1
    v_mul_u32_u24 v198, 32768, v198
    v_lshrrev_b32 v3, 5, v1
    v_lshl_add_u32 v198, v3, 8, v198
    v_and_b32 v3, 15, v1
    v_lshl_add_u32 v198, v3, 4, v198
    v_and_b32 v199, 19, v1
    v_bfe_u32 v3, v1, 2, 1
    v_lshl_or_b32 v199, v3, 3, v199
    v_bfe_u32 v3, v1, 3, 1
    v_lshl_or_b32 v199, v3, 2, v199
    v_lshlrev_b32 v199, 4, v199
    v_lshrrev_b32 v3, 5, v1
    v_lshl_add_u32 v199, v3, 9, v199
    v_bfe_u32 v2, v1, 4, 1
    v_lshl_add_u32 v2, v2, 1, v3
    v_and_b32 v3, 15, v1
    v_lshlrev_b32 v3, 4, v3
    v_lshl_add_u32 v200, v2, 9, v3
    s_lshl_b32 s32, s5, 1
    s_add_u32 s32, s32, s7
    s_lshl_b32 s33, s4, 2
    s_lshl_b32 s20, s6, 1
    s_add_u32 s33, s33, s20
    s_lshl_b32 s34, s33, 16
    s_lshl_b32 s20, s32, 10
    s_add_u32 s34, s34, s20
    s_add_u32 s20, s32, 0
    s_and_b32 s20, s20, 31
    s_lshl_b32 s20, s20, 6
    s_add_u32 s20, s20, s33
    s_lshl_b32 s56, s20, 12
    s_add_u32 s57, s56, 4096
    s_add_u32 s20, s32, 0
    s_and_b32 s20, s20, 31
    s_lshl_b32 s20, s20, 6
    s_add_u32 s20, s20, s33
    s_lshl_b32 s58, s20, 12
    s_add_u32 s59, s58, 4096
    s_add_u32 s38, s34, 65536
    s_mov_b32 s44, 0x3e8293ee
    s_mov_b32 s45, s44
    s_setprio 1
    s_mov_b32 s18, 0
    v_add_u32 v185, s18, v184
    v_add_u32 v192, s18, v186
    v_add_u32 v193, s18, v187
    v_add_u32 v194, s18, v188
    v_add_u32 v195, s18, v189
    v_add_u32 v196, s18, v190
    v_add_u32 v197, s18, v191
    s_barrier
    ds_read_b128 v[104:107], v185 offset:0
    ds_read_b128 v[108:111], v185 offset:2048
    ds_read_b128 v[112:115], v185 offset:4096
    ds_read_b128 v[116:119], v185 offset:6144
    ds_read_b64_tr_b16 v[120:121], v192 offset:0
    ds_read_b64_tr_b16 v[122:123], v192 offset:512
    ds_read_b64_tr_b16 v[124:125], v193 offset:0
    ds_read_b64_tr_b16 v[126:127], v193 offset:512
    ds_read_b64_tr_b16 v[128:129], v194 offset:0
    ds_read_b64_tr_b16 v[130:131], v194 offset:512
    ds_read_b64_tr_b16 v[132:133], v195 offset:0
    ds_read_b64_tr_b16 v[134:135], v195 offset:512
    ds_read_b64_tr_b16 v[136:137], v196 offset:0
    ds_read_b64_tr_b16 v[138:139], v196 offset:512
    ds_read_b64_tr_b16 v[140:141], v197 offset:0
    ds_read_b64_tr_b16 v[142:143], v197 offset:512
    s_mov_b32 s19, 16
    s_waitcnt lgkmcnt(0)
.p2align 6
adaLN_cond__mha_block__mixer_gmlp__prompt_kernel_q_c_loop:
    v_mfma_f32_16x16x32_bf16 v[8:11], v[120:123], v[104:107], v[8:11]
    ds_read_b128 v[144:147], v185 offset:1024
    v_mfma_f32_16x16x32_bf16 v[32:35], v[120:123], v[108:111], v[32:35]
    ds_read_b128 v[148:151], v185 offset:3072
    v_mfma_f32_16x16x32_bf16 v[56:59], v[120:123], v[112:115], v[56:59]
    ds_read_b128 v[152:155], v185 offset:5120
    v_mfma_f32_16x16x32_bf16 v[80:83], v[120:123], v[116:119], v[80:83]
    ds_read_b128 v[156:159], v185 offset:7168
    v_mfma_f32_16x16x32_bf16 v[12:15], v[124:127], v[104:107], v[12:15]
    ds_read_b64_tr_b16 v[160:161], v192 offset:4096
    v_mfma_f32_16x16x32_bf16 v[36:39], v[124:127], v[108:111], v[36:39]
    ds_read_b64_tr_b16 v[162:163], v192 offset:4608
    v_mfma_f32_16x16x32_bf16 v[60:63], v[124:127], v[112:115], v[60:63]
    ds_read_b64_tr_b16 v[164:165], v193 offset:4096
    v_mfma_f32_16x16x32_bf16 v[84:87], v[124:127], v[116:119], v[84:87]
    ds_read_b64_tr_b16 v[166:167], v193 offset:4608
    v_mfma_f32_16x16x32_bf16 v[16:19], v[128:131], v[104:107], v[16:19]
    ds_read_b64_tr_b16 v[168:169], v194 offset:4096
    v_mfma_f32_16x16x32_bf16 v[40:43], v[128:131], v[108:111], v[40:43]
    ds_read_b64_tr_b16 v[170:171], v194 offset:4608
    v_mfma_f32_16x16x32_bf16 v[64:67], v[128:131], v[112:115], v[64:67]
    ds_read_b64_tr_b16 v[172:173], v195 offset:4096
    v_mfma_f32_16x16x32_bf16 v[88:91], v[128:131], v[116:119], v[88:91]
    ds_read_b64_tr_b16 v[174:175], v195 offset:4608
    v_mfma_f32_16x16x32_bf16 v[20:23], v[132:135], v[104:107], v[20:23]
    ds_read_b64_tr_b16 v[176:177], v196 offset:4096
    v_mfma_f32_16x16x32_bf16 v[44:47], v[132:135], v[108:111], v[44:47]
    ds_read_b64_tr_b16 v[178:179], v196 offset:4608
    v_mfma_f32_16x16x32_bf16 v[68:71], v[132:135], v[112:115], v[68:71]
    ds_read_b64_tr_b16 v[180:181], v197 offset:4096
    v_mfma_f32_16x16x32_bf16 v[92:95], v[132:135], v[116:119], v[92:95]
    ds_read_b64_tr_b16 v[182:183], v197 offset:4608
    v_mfma_f32_16x16x32_bf16 v[24:27], v[104:107], v[136:139], v[24:27]
    s_add_u32 s18, s18, 40960
    v_mfma_f32_16x16x32_bf16 v[48:51], v[108:111], v[136:139], v[48:51]
    s_cmp_ge_u32 s18, 122880
    v_mfma_f32_16x16x32_bf16 v[72:75], v[112:115], v[136:139], v[72:75]
    s_cselect_b32 s18, 0, s18
    v_mfma_f32_16x16x32_bf16 v[96:99], v[116:119], v[136:139], v[96:99]
    v_add_u32 v185, s18, v184
    v_mfma_f32_16x16x32_bf16 v[28:31], v[104:107], v[140:143], v[28:31]
    v_add_u32 v192, s18, v186
    v_mfma_f32_16x16x32_bf16 v[52:55], v[108:111], v[140:143], v[52:55]
    v_add_u32 v193, s18, v187
    v_mfma_f32_16x16x32_bf16 v[76:79], v[112:115], v[140:143], v[76:79]
    v_add_u32 v194, s18, v188
    v_mfma_f32_16x16x32_bf16 v[100:103], v[116:119], v[140:143], v[100:103]
    v_add_u32 v195, s18, v189
    v_add_u32 v196, s18, v190
    v_add_u32 v197, s18, v191
    s_waitcnt lgkmcnt(0)
    s_barrier
    v_mfma_f32_16x16x32_bf16 v[8:11], v[160:163], v[144:147], v[8:11]
    ds_read_b128 v[104:107], v185 offset:0
    v_mfma_f32_16x16x32_bf16 v[32:35], v[160:163], v[148:151], v[32:35]
    ds_read_b128 v[108:111], v185 offset:2048
    v_mfma_f32_16x16x32_bf16 v[56:59], v[160:163], v[152:155], v[56:59]
    ds_read_b128 v[112:115], v185 offset:4096
    v_mfma_f32_16x16x32_bf16 v[80:83], v[160:163], v[156:159], v[80:83]
    ds_read_b128 v[116:119], v185 offset:6144
    v_mfma_f32_16x16x32_bf16 v[12:15], v[164:167], v[144:147], v[12:15]
    ds_read_b64_tr_b16 v[120:121], v192 offset:0
    v_mfma_f32_16x16x32_bf16 v[36:39], v[164:167], v[148:151], v[36:39]
    ds_read_b64_tr_b16 v[122:123], v192 offset:512
    v_mfma_f32_16x16x32_bf16 v[60:63], v[164:167], v[152:155], v[60:63]
    ds_read_b64_tr_b16 v[124:125], v193 offset:0
    v_mfma_f32_16x16x32_bf16 v[84:87], v[164:167], v[156:159], v[84:87]
    ds_read_b64_tr_b16 v[126:127], v193 offset:512
    v_mfma_f32_16x16x32_bf16 v[16:19], v[168:171], v[144:147], v[16:19]
    ds_read_b64_tr_b16 v[128:129], v194 offset:0
    v_mfma_f32_16x16x32_bf16 v[40:43], v[168:171], v[148:151], v[40:43]
    ds_read_b64_tr_b16 v[130:131], v194 offset:512
    v_mfma_f32_16x16x32_bf16 v[64:67], v[168:171], v[152:155], v[64:67]
    ds_read_b64_tr_b16 v[132:133], v195 offset:0
    v_mfma_f32_16x16x32_bf16 v[88:91], v[168:171], v[156:159], v[88:91]
    ds_read_b64_tr_b16 v[134:135], v195 offset:512
    v_mfma_f32_16x16x32_bf16 v[20:23], v[172:175], v[144:147], v[20:23]
    ds_read_b64_tr_b16 v[136:137], v196 offset:0
    v_mfma_f32_16x16x32_bf16 v[44:47], v[172:175], v[148:151], v[44:47]
    ds_read_b64_tr_b16 v[138:139], v196 offset:512
    v_mfma_f32_16x16x32_bf16 v[68:71], v[172:175], v[152:155], v[68:71]
    ds_read_b64_tr_b16 v[140:141], v197 offset:0
    v_mfma_f32_16x16x32_bf16 v[92:95], v[172:175], v[156:159], v[92:95]
    ds_read_b64_tr_b16 v[142:143], v197 offset:512
    v_mfma_f32_16x16x32_bf16 v[24:27], v[144:147], v[176:179], v[24:27]
    s_sub_u32 s19, s19, 1
    v_mfma_f32_16x16x32_bf16 v[48:51], v[148:151], v[176:179], v[48:51]
    s_cmp_lg_u32 s19, 0
    v_mfma_f32_16x16x32_bf16 v[72:75], v[152:155], v[176:179], v[72:75]
    v_mfma_f32_16x16x32_bf16 v[96:99], v[156:159], v[176:179], v[96:99]
    v_mfma_f32_16x16x32_bf16 v[28:31], v[144:147], v[180:183], v[28:31]
    v_mfma_f32_16x16x32_bf16 v[52:55], v[148:151], v[180:183], v[52:55]
    v_mfma_f32_16x16x32_bf16 v[76:79], v[152:155], v[180:183], v[76:79]
    v_mfma_f32_16x16x32_bf16 v[100:103], v[156:159], v[180:183], v[100:103]
    s_waitcnt lgkmcnt(0)
    s_cbranch_scc1 adaLN_cond__mha_block__mixer_gmlp__prompt_kernel_q_c_loop
    s_nop 7
    v_pk_mul_f32 v[8:9], v[8:9], s[44:45]
    v_pk_mul_f32 v[10:11], v[10:11], s[44:45]
    v_pk_mul_f32 v[12:13], v[12:13], s[44:45]
    v_pk_mul_f32 v[14:15], v[14:15], s[44:45]
    v_pk_mul_f32 v[32:33], v[32:33], s[44:45]
    v_pk_mul_f32 v[34:35], v[34:35], s[44:45]
    v_pk_mul_f32 v[36:37], v[36:37], s[44:45]
    v_pk_mul_f32 v[38:39], v[38:39], s[44:45]
    v_pk_mul_f32 v[56:57], v[56:57], s[44:45]
    v_pk_mul_f32 v[58:59], v[58:59], s[44:45]
    v_pk_mul_f32 v[60:61], v[60:61], s[44:45]
    v_pk_mul_f32 v[62:63], v[62:63], s[44:45]
    v_pk_mul_f32 v[80:81], v[80:81], s[44:45]
    v_pk_mul_f32 v[82:83], v[82:83], s[44:45]
    v_pk_mul_f32 v[84:85], v[84:85], s[44:45]
    v_pk_mul_f32 v[86:87], v[86:87], s[44:45]
    v_cvt_pk_bf16_f32 v104, v16, v17
    v_cvt_pk_bf16_f32 v105, v18, v19
    v_cvt_pk_bf16_f32 v106, v40, v41
    v_cvt_pk_bf16_f32 v107, v42, v43
    v_cvt_pk_bf16_f32 v108, v64, v65
    v_cvt_pk_bf16_f32 v109, v66, v67
    v_cvt_pk_bf16_f32 v110, v88, v89
    v_cvt_pk_bf16_f32 v111, v90, v91
    v_permlane16_swap_b32 v104, v106
    v_permlane16_swap_b32 v105, v107
    buffer_store_dwordx4 v[104:107], v199, s[40:43], s56 offen offset:0 sc1
    v_cvt_pk_bf16_f32 v112, v20, v21
    v_cvt_pk_bf16_f32 v113, v22, v23
    v_cvt_pk_bf16_f32 v114, v44, v45
    v_cvt_pk_bf16_f32 v115, v46, v47
    v_permlane16_swap_b32 v108, v110
    v_permlane16_swap_b32 v109, v111
    buffer_store_dwordx4 v[108:111], v199, s[40:43], s57 offen offset:0 sc1
    v_cvt_pk_bf16_f32 v116, v68, v69
    v_cvt_pk_bf16_f32 v117, v70, v71
    v_cvt_pk_bf16_f32 v118, v92, v93
    v_cvt_pk_bf16_f32 v119, v94, v95
    v_permlane16_swap_b32 v112, v114
    v_permlane16_swap_b32 v113, v115
    buffer_store_dwordx4 v[112:115], v199, s[40:43], s56 offen offset:1024 sc1
    v_cvt_pk_bf16_f32 v104, v24, v25
    v_cvt_pk_bf16_f32 v105, v26, v27
    v_cvt_pk_bf16_f32 v106, v48, v49
    v_cvt_pk_bf16_f32 v107, v50, v51
    v_permlane16_swap_b32 v116, v118
    v_permlane16_swap_b32 v117, v119
    buffer_store_dwordx4 v[116:119], v199, s[40:43], s57 offen offset:1024 sc1
    v_cvt_pk_bf16_f32 v108, v72, v73
    v_cvt_pk_bf16_f32 v109, v74, v75
    v_cvt_pk_bf16_f32 v110, v96, v97
    v_cvt_pk_bf16_f32 v111, v98, v99
    v_permlane16_swap_b32 v104, v106
    v_permlane16_swap_b32 v105, v107
    buffer_store_dwordx4 v[104:107], v200, s[40:43], s58 offen offset:2048 sc1
    v_cvt_pk_bf16_f32 v112, v28, v29
    v_cvt_pk_bf16_f32 v113, v30, v31
    v_cvt_pk_bf16_f32 v114, v52, v53
    v_cvt_pk_bf16_f32 v115, v54, v55
    v_permlane16_swap_b32 v108, v110
    v_permlane16_swap_b32 v109, v111
    buffer_store_dwordx4 v[108:111], v200, s[40:43], s59 offen offset:2048 sc1
    v_cvt_pk_bf16_f32 v116, v76, v77
    v_cvt_pk_bf16_f32 v117, v78, v79
    v_cvt_pk_bf16_f32 v118, v100, v101
    v_cvt_pk_bf16_f32 v119, v102, v103
    v_permlane16_swap_b32 v112, v114
    v_permlane16_swap_b32 v113, v115
    buffer_store_dwordx4 v[112:115], v200, s[40:43], s58 offen offset:2304 sc1
    v_cvt_pk_bf16_f32 v104, v8, v9
    v_cvt_pk_bf16_f32 v105, v10, v11
    v_cvt_pk_bf16_f32 v106, v32, v33
    v_cvt_pk_bf16_f32 v107, v34, v35
    v_permlane16_swap_b32 v116, v118
    v_permlane16_swap_b32 v117, v119
    buffer_store_dwordx4 v[116:119], v200, s[40:43], s59 offen offset:2304 sc1
    v_cvt_pk_bf16_f32 v108, v56, v57
    v_cvt_pk_bf16_f32 v109, v58, v59
    v_cvt_pk_bf16_f32 v110, v80, v81
    v_cvt_pk_bf16_f32 v111, v82, v83
    v_permlane16_swap_b32 v104, v106
    v_permlane16_swap_b32 v105, v107
    buffer_store_dwordx4 v[104:107], v198, s[24:27], s34 offen offset:0 sc1
    v_cvt_pk_bf16_f32 v112, v12, v13
    v_cvt_pk_bf16_f32 v113, v14, v15
    v_cvt_pk_bf16_f32 v114, v36, v37
    v_cvt_pk_bf16_f32 v115, v38, v39
    v_permlane16_swap_b32 v108, v110
    v_permlane16_swap_b32 v109, v111
    buffer_store_dwordx4 v[108:111], v198, s[24:27], s38 offen offset:0 sc1
    v_cvt_pk_bf16_f32 v116, v60, v61
    v_cvt_pk_bf16_f32 v117, v62, v63
    v_cvt_pk_bf16_f32 v118, v84, v85
    v_cvt_pk_bf16_f32 v119, v86, v87
    v_permlane16_swap_b32 v112, v114
    v_permlane16_swap_b32 v113, v115
    buffer_store_dwordx4 v[112:115], v198, s[24:27], s34 offen offset:512 sc1
    s_nop 1
    v_permlane16_swap_b32 v116, v118
    v_permlane16_swap_b32 v117, v119
    buffer_store_dwordx4 v[116:119], v198, s[24:27], s38 offen offset:512 sc1
    s_mov_b32 s21, s4
    s_add_u32 s20, s5, 16
    s_mul_i32 s20, s20, 4352
    s_lshl_b32 s21, s21, 7
    s_add_u32 s20, s20, s21
    v_mov_b32 v2, s101
    v_mov_b32 v3, 0
    s_cmp_eq_u32 s3, 0
    s_waitcnt vmcnt(0)
    s_barrier
    s_cbranch_scc0 sig_1
    s_mov_b64 exec, 1
    buffer_store_dword v2, v3, s[96:99], s20 offen sc1
    s_mov_b64 exec, -1
sig_1:
    s_and_b32 s4, s2, 7
    s_lshl_b32 s4, s4, 2
    s_lshr_b32 s20, s2, 6
    s_add_u32 s4, s4, s20
    s_bfe_u32 s5, s2, 0x30003
    v_and_b32 v1, 63, v0
    v_lshlrev_b32 v4, 4, v1
    s_mov_b32 s33, 0
    s_cmp_lt_u32 s3, 3
    s_cbranch_scc0 adaLN_cond__mha_block__mixer_gmlp__prompt_kernel_a_np
    s_cmp_eq_u32 s3, 1
    s_cselect_b32 s21, 16, 0
    s_cmp_eq_u32 s3, 2
    s_cselect_b32 s21, 16, s21
    s_lshr_b32 s20, s4, 1
    s_add_u32 s20, s20, s21
    s_and_b32 s20, s20, 15
    s_add_u32 s20, s20, 16
    s_mul_i32 s20, s20, 4352
    v_and_b32 v2, 63, v0
    v_lshlrev_b32 v2, 7, v2
    s_bfm_b64 exec, 16, 0
    s_mov_b32 s19, 0x80000
adaLN_cond__mha_block__mixer_gmlp__prompt_kernel_a_dp:
    buffer_load_dword v240, v2, s[96:99], s20 offen sc1
    s_waitcnt vmcnt(0)
    v_cmp_ne_u32 vcc, s101, v240
    s_sub_u32 s19, s19, 1
    s_cmp_eq_u32 s19, 0
    s_cbranch_scc1 adaLN_cond__mha_block__mixer_gmlp__prompt_kernel_a_dp_d
    s_cbranch_vccz adaLN_cond__mha_block__mixer_gmlp__prompt_kernel_a_dp_d
    s_sleep 4
    s_branch adaLN_cond__mha_block__mixer_gmlp__prompt_kernel_a_dp
adaLN_cond__mha_block__mixer_gmlp__prompt_kernel_a_dp_d:
    s_mov_b64 exec, -1
adaLN_cond__mha_block__mixer_gmlp__prompt_kernel_a_np:
    s_barrier
    v_bfe_u32 v5, v1, 4, 1
    v_lshlrev_b32 v5, 15, v5
    v_lshrrev_b32 v6, 5, v1
    v_lshl_add_u32 v5, v6, 8, v5
    v_and_b32 v6, 15, v1
    v_lshl_add_u32 v5, v6, 4, v5
    s_lshl_b32 s7, s5, 2
    s_add_u32 s7, s7, s3
    s_lshl_b32 s7, s7, 17
    s_lshl_b32 s20, s4, 10
    s_add_u32 s7, s7, s20
    s_add_u32 s32, s7, 65536
    s_add_u32 s12, s36, 6291456
    s_addc_u32 s13, s37, 0
    s_mov_b32 s14, 4194304
    s_mov_b32 s15, 0x20000
    s_add_u32 s24, s36, 6291456
    s_addc_u32 s25, s37, 0
    s_mov_b32 s26, 4194304
    s_mov_b32 s27, 0x20000
    buffer_load_dwordx4 v[8:11], v5, s[12:15], s7 offen offset:0 sc1
    buffer_load_dwordx4 v[12:15], v5, s[12:15], s7 offen offset:512 sc1
    buffer_load_dwordx4 v[16:19], v5, s[12:15], s32 offen offset:0 sc1
    buffer_load_dwordx4 v[20:23], v5, s[12:15], s32 offen offset:512 sc1
    v_bfe_u32 v6, v1, 2, 1
    v_bfe_u32 v7, v1, 4, 1
    v_cmp_eq_u32 vcc, v6, v7
    v_mov_b32 v6, 0x3f803f80
    s_setprio 2
    v_cndmask_b32 v136, 0, v6, vcc
    v_mov_b32 v137, v136
    v_mov_b32 v138, v136
    v_mov_b32 v139, v136
    v_mov_b32 v96, 0
    v_mov_b32 v97, 0
    v_mov_b32 v98, 0
    v_mov_b32 v99, 0
    v_mov_b32 v100, 0
    v_mov_b32 v101, 0
    v_mov_b32 v102, 0
    v_mov_b32 v103, 0
    v_mov_b32 v104, 0
    v_mov_b32 v105, 0
    v_mov_b32 v106, 0
    v_mov_b32 v107, 0
    v_mov_b32 v108, 0
    v_mov_b32 v109, 0
    v_mov_b32 v110, 0
    v_mov_b32 v111, 0
    v_mov_b32 v112, 0
    v_mov_b32 v113, 0
    v_mov_b32 v114, 0
    v_mov_b32 v115, 0
    v_mov_b32 v116, 0
    v_mov_b32 v117, 0
    v_mov_b32 v118, 0
    v_mov_b32 v119, 0
    v_mov_b32 v120, 0
    v_mov_b32 v121, 0
    v_mov_b32 v122, 0
    v_mov_b32 v123, 0
    v_mov_b32 v124, 0
    v_mov_b32 v125, 0
    v_mov_b32 v126, 0
    v_mov_b32 v127, 0
    v_mov_b32 v128, 0
    v_mov_b32 v129, 0
    v_mov_b32 v130, 0
    v_mov_b32 v131, 0
    v_mov_b32 v132, 0
    v_mov_b32 v133, 0
    v_mov_b32 v134, 0
    v_mov_b32 v135, 0
    v_mov_b32 v92, 0
    v_mov_b32 v93, 0
    v_mov_b32 v94, 0
    v_mov_b32 v95, 0
    v_mov_b32 v156, 0
    v_mov_b32 v157, 0
    v_mov_b32 v158, 0
    v_mov_b32 v159, 0
    v_mov_b32 v2, v4
    s_mov_b32 s18, 0
    s_barrier
    ds_read_b128 v[140:143], v2 offset:0
    ds_read_b128 v[144:147], v2 offset:1024
    ds_read_b128 v[148:151], v2 offset:2048
    s_waitcnt vmcnt(0) lgkmcnt(0)
    v_mfma_f32_32x32x16_bf16 v[72:87], v[140:143], v[16:19], 0
    v_mfma_f32_32x32x16_bf16 v[72:87], v[144:147], v[20:23], v[72:87]
    v_mfma_f32_32x32x16_bf16 v[56:71], v[140:143], v[8:11], 0
    v_mfma_f32_32x32x16_bf16 v[56:71], v[144:147], v[12:15], v[56:71]
    s_nop 7
    s_nop 1
    v_max3_f32 v6, v72, v73, v74
    v_max3_f32 v6, v6, v75, v76
    v_max3_f32 v6, v6, v77, v78
    v_max3_f32 v6, v6, v79, v80
    v_max3_f32 v6, v6, v81, v82
    v_max3_f32 v6, v6, v83, v84
    v_max3_f32 v6, v6, v85, v86
    v_max_f32 v6, v6, v87
    v_mov_b32 v7, v6
    s_nop 1
    v_permlane32_swap_b32 v6, v7
    s_nop 0
    v_max_f32 v6, v6, v7
    v_sub_f32 v40, 0xc2200000, v6
    v_mov_b32 v41, v40
    v_mov_b32 v42, v40
    v_mov_b32 v43, v40
    v_mov_b32 v44, v40
    v_mov_b32 v45, v40
    v_mov_b32 v46, v40
    v_mov_b32 v47, v40
    v_mov_b32 v48, v40
    v_mov_b32 v49, v40
    v_mov_b32 v50, v40
    v_mov_b32 v51, v40
    v_mov_b32 v52, v40
    v_mov_b32 v53, v40
    v_mov_b32 v54, v40
    v_mov_b32 v55, v40
    v_max3_f32 v6, v56, v57, v58
    v_max3_f32 v6, v6, v59, v60
    v_max3_f32 v6, v6, v61, v62
    v_max3_f32 v6, v6, v63, v64
    v_max3_f32 v6, v6, v65, v66
    v_max3_f32 v6, v6, v67, v68
    v_max3_f32 v6, v6, v69, v70
    v_max_f32 v6, v6, v71
    v_mov_b32 v7, v6
    s_nop 1
    v_permlane32_swap_b32 v6, v7
    s_nop 0
    v_max_f32 v6, v6, v7
    v_sub_f32 v24, 0xc2200000, v6
    v_mov_b32 v25, v24
    v_mov_b32 v26, v24
    v_mov_b32 v27, v24
    v_mov_b32 v28, v24
    v_mov_b32 v29, v24
    v_mov_b32 v30, v24
    v_mov_b32 v31, v24
    v_mov_b32 v32, v24
    v_mov_b32 v33, v24
    v_mov_b32 v34, v24
    v_mov_b32 v35, v24
    v_mov_b32 v36, v24
    v_mov_b32 v37, v24
    v_mov_b32 v38, v24
    v_mov_b32 v39, v24
    v_pk_add_f32 v[56:57], v[56:57], v[24:25]
    v_pk_add_f32 v[58:59], v[58:59], v[24:25]
    v_pk_add_f32 v[60:61], v[60:61], v[24:25]
    v_pk_add_f32 v[62:63], v[62:63], v[24:25]
    v_pk_add_f32 v[64:65], v[64:65], v[24:25]
    v_pk_add_f32 v[66:67], v[66:67], v[24:25]
    v_pk_add_f32 v[68:69], v[68:69], v[24:25]
    v_pk_add_f32 v[70:71], v[70:71], v[24:25]
    s_mov_b32 s19, 8
    s_branch adaLN_cond__mha_block__mixer_gmlp__prompt_kernel_a_loop
adaLN_cond__mha_block__mixer_gmlp__prompt_kernel_a_havem:
    s_nop 1
    v_mfma_f32_32x32x16_bf16 v[56:71], v[140:143], v[8:11], v[24:39]
    v_mfma_f32_32x32x16_bf16 v[56:71], v[144:147], v[12:15], v[56:71]
    s_mov_b32 s19, 8
    s_nop 7
    s_nop 3
.p2align 6
adaLN_cond__mha_block__mixer_gmlp__prompt_kernel_a_loop:
    v_mfma_f32_32x32x16_bf16 v[72:87], v[140:143], v[16:19], v[40:55]
    ds_read_b128 v[140:143], v2 offset:4096
    v_exp_f32 v56, v56
    v_exp_f32 v57, v57
    v_exp_f32 v58, v58
    v_mfma_f32_16x16x32_bf16 v[132:135], v[136:139], v[92:95], v[132:135]
    v_exp_f32 v59, v59
    v_exp_f32 v60, v60
    v_mfma_f32_32x32x16_bf16 v[112:127], v[156:159], v[92:95], v[112:127]
    ds_read_b128 v[156:159], v2 offset:3072
    v_exp_f32 v61, v61
    v_exp_f32 v62, v62
    v_exp_f32 v63, v63
    v_cvt_pk_bf16_f32 v88, v56, v57
    v_cvt_pk_bf16_f32 v89, v58, v59
    v_mfma_f32_32x32x16_bf16 v[72:87], v[144:147], v[20:23], v[72:87]
    ds_read_b128 v[144:147], v2 offset:5120
    v_cvt_pk_bf16_f32 v90, v60, v61
    v_cvt_pk_bf16_f32 v91, v62, v63
    v_exp_f32 v64, v64
    v_exp_f32 v65, v65
    v_exp_f32 v66, v66
    v_mfma_f32_16x16x32_bf16 v[128:131], v[136:139], v[88:91], v[128:131]
    ds_read_b128 v[152:155], v2 offset:6144
    v_exp_f32 v67, v67
    v_exp_f32 v68, v68
    v_mfma_f32_32x32x16_bf16 v[96:111], v[148:151], v[88:91], v[96:111]
    v_exp_f32 v69, v69
    v_exp_f32 v70, v70
    v_exp_f32 v71, v71
    v_cvt_pk_bf16_f32 v92, v64, v65
    v_cvt_pk_bf16_f32 v93, v66, v67
    v_cvt_pk_bf16_f32 v94, v68, v69
    v_cvt_pk_bf16_f32 v95, v70, v71
    s_waitcnt lgkmcnt(0)
    v_mfma_f32_32x32x16_bf16 v[56:71], v[140:143], v[8:11], v[24:39]
    v_exp_f32 v72, v72
    v_exp_f32 v73, v73
    v_exp_f32 v74, v74
    v_mfma_f32_16x16x32_bf16 v[128:131], v[136:139], v[92:95], v[128:131]
    v_exp_f32 v75, v75
    v_exp_f32 v76, v76
    v_mfma_f32_32x32x16_bf16 v[96:111], v[156:159], v[92:95], v[96:111]
    v_exp_f32 v77, v77
    v_exp_f32 v78, v78
    v_exp_f32 v79, v79
    v_cvt_pk_bf16_f32 v88, v72, v73
    v_cvt_pk_bf16_f32 v89, v74, v75
    v_mfma_f32_32x32x16_bf16 v[56:71], v[144:147], v[12:15], v[56:71]
    v_cvt_pk_bf16_f32 v90, v76, v77
    v_cvt_pk_bf16_f32 v91, v78, v79
    v_exp_f32 v80, v80
    v_exp_f32 v81, v81
    v_exp_f32 v82, v82
    v_mfma_f32_16x16x32_bf16 v[132:135], v[136:139], v[88:91], v[132:135]
    v_exp_f32 v83, v83
    v_exp_f32 v84, v84
    v_mfma_f32_32x32x16_bf16 v[112:127], v[148:151], v[88:91], v[112:127]
    v_exp_f32 v85, v85
    v_exp_f32 v86, v86
    v_exp_f32 v87, v87
    v_cvt_pk_bf16_f32 v92, v80, v81
    v_cvt_pk_bf16_f32 v93, v82, v83
    v_cvt_pk_bf16_f32 v94, v84, v85
    v_cvt_pk_bf16_f32 v95, v86, v87
    v_mfma_f32_32x32x16_bf16 v[72:87], v[140:143], v[16:19], v[40:55]
    ds_read_b128 v[140:143], v2 offset:8192
    v_exp_f32 v56, v56
    v_exp_f32 v57, v57
    v_exp_f32 v58, v58
    v_mfma_f32_16x16x32_bf16 v[132:135], v[136:139], v[92:95], v[132:135]
    v_exp_f32 v59, v59
    v_exp_f32 v60, v60
    v_mfma_f32_32x32x16_bf16 v[112:127], v[156:159], v[92:95], v[112:127]
    ds_read_b128 v[156:159], v2 offset:7168
    v_exp_f32 v61, v61
    v_exp_f32 v62, v62
    v_exp_f32 v63, v63
    v_cvt_pk_bf16_f32 v88, v56, v57
    v_cvt_pk_bf16_f32 v89, v58, v59
    v_mfma_f32_32x32x16_bf16 v[72:87], v[144:147], v[20:23], v[72:87]
    ds_read_b128 v[144:147], v2 offset:9216
    v_cvt_pk_bf16_f32 v90, v60, v61
    v_cvt_pk_bf16_f32 v91, v62, v63
    v_exp_f32 v64, v64
    v_exp_f32 v65, v65
    v_exp_f32 v66, v66
    v_mfma_f32_16x16x32_bf16 v[128:131], v[136:139], v[88:91], v[128:131]
    ds_read_b128 v[148:151], v2 offset:10240
    v_exp_f32 v67, v67
    v_exp_f32 v68, v68
    v_mfma_f32_32x32x16_bf16 v[96:111], v[152:155], v[88:91], v[96:111]
    v_exp_f32 v69, v69
    v_exp_f32 v70, v70
    v_exp_f32 v71, v71
    v_cvt_pk_bf16_f32 v92, v64, v65
    v_cvt_pk_bf16_f32 v93, v66, v67
    v_cvt_pk_bf16_f32 v94, v68, v69
    v_cvt_pk_bf16_f32 v95, v70, v71
    s_waitcnt lgkmcnt(0)
    v_mfma_f32_32x32x16_bf16 v[56:71], v[140:143], v[8:11], v[24:39]
    v_exp_f32 v72, v72
    v_exp_f32 v73, v73
    v_exp_f32 v74, v74
    v_mfma_f32_16x16x32_bf16 v[128:131], v[136:139], v[92:95], v[128:131]
    v_exp_f32 v75, v75
    v_exp_f32 v76, v76
    v_mfma_f32_32x32x16_bf16 v[96:111], v[156:159], v[92:95], v[96:111]
    v_exp_f32 v77, v77
    v_exp_f32 v78, v78
    v_exp_f32 v79, v79
    v_cvt_pk_bf16_f32 v88, v72, v73
    v_cvt_pk_bf16_f32 v89, v74, v75
    v_mfma_f32_32x32x16_bf16 v[56:71], v[144:147], v[12:15], v[56:71]
    v_cvt_pk_bf16_f32 v90, v76, v77
    v_cvt_pk_bf16_f32 v91, v78, v79
    v_exp_f32 v80, v80
    v_exp_f32 v81, v81
    v_exp_f32 v82, v82
    v_mfma_f32_16x16x32_bf16 v[132:135], v[136:139], v[88:91], v[132:135]
    v_exp_f32 v83, v83
    v_exp_f32 v84, v84
    v_mfma_f32_32x32x16_bf16 v[112:127], v[152:155], v[88:91], v[112:127]
    v_exp_f32 v85, v85
    v_exp_f32 v86, v86
    v_exp_f32 v87, v87
    v_cvt_pk_bf16_f32 v92, v80, v81
    v_cvt_pk_bf16_f32 v93, v82, v83
    v_cvt_pk_bf16_f32 v94, v84, v85
    v_cvt_pk_bf16_f32 v95, v86, v87
    v_mfma_f32_32x32x16_bf16 v[72:87], v[140:143], v[16:19], v[40:55]
    ds_read_b128 v[140:143], v2 offset:12288
    v_exp_f32 v56, v56
    v_exp_f32 v57, v57
    v_exp_f32 v58, v58
    v_mfma_f32_16x16x32_bf16 v[132:135], v[136:139], v[92:95], v[132:135]
    v_exp_f32 v59, v59
    v_exp_f32 v60, v60
    v_mfma_f32_32x32x16_bf16 v[112:127], v[156:159], v[92:95], v[112:127]
    ds_read_b128 v[156:159], v2 offset:11264
    v_exp_f32 v61, v61
    v_exp_f32 v62, v62
    v_exp_f32 v63, v63
    v_cvt_pk_bf16_f32 v88, v56, v57
    v_cvt_pk_bf16_f32 v89, v58, v59
    v_mfma_f32_32x32x16_bf16 v[72:87], v[144:147], v[20:23], v[72:87]
    ds_read_b128 v[144:147], v2 offset:13312
    v_cvt_pk_bf16_f32 v90, v60, v61
    v_cvt_pk_bf16_f32 v91, v62, v63
    v_exp_f32 v64, v64
    v_exp_f32 v65, v65
    v_exp_f32 v66, v66
    v_mfma_f32_16x16x32_bf16 v[128:131], v[136:139], v[88:91], v[128:131]
    ds_read_b128 v[152:155], v2 offset:14336
    v_exp_f32 v67, v67
    v_exp_f32 v68, v68
    v_mfma_f32_32x32x16_bf16 v[96:111], v[148:151], v[88:91], v[96:111]
    v_exp_f32 v69, v69
    v_exp_f32 v70, v70
    v_exp_f32 v71, v71
    v_cvt_pk_bf16_f32 v92, v64, v65
    v_cvt_pk_bf16_f32 v93, v66, v67
    v_cvt_pk_bf16_f32 v94, v68, v69
    v_cvt_pk_bf16_f32 v95, v70, v71
    s_waitcnt lgkmcnt(0)
    v_mfma_f32_32x32x16_bf16 v[56:71], v[140:143], v[8:11], v[24:39]
    v_exp_f32 v72, v72
    v_exp_f32 v73, v73
    v_exp_f32 v74, v74
    v_mfma_f32_16x16x32_bf16 v[128:131], v[136:139], v[92:95], v[128:131]
    v_exp_f32 v75, v75
    v_exp_f32 v76, v76
    v_mfma_f32_32x32x16_bf16 v[96:111], v[156:159], v[92:95], v[96:111]
    v_exp_f32 v77, v77
    v_exp_f32 v78, v78
    v_exp_f32 v79, v79
    v_cvt_pk_bf16_f32 v88, v72, v73
    v_cvt_pk_bf16_f32 v89, v74, v75
    v_mfma_f32_32x32x16_bf16 v[56:71], v[144:147], v[12:15], v[56:71]
    v_cvt_pk_bf16_f32 v90, v76, v77
    v_cvt_pk_bf16_f32 v91, v78, v79
    v_exp_f32 v80, v80
    v_exp_f32 v81, v81
    v_exp_f32 v82, v82
    v_mfma_f32_16x16x32_bf16 v[132:135], v[136:139], v[88:91], v[132:135]
    v_exp_f32 v83, v83
    v_exp_f32 v84, v84
    v_mfma_f32_32x32x16_bf16 v[112:127], v[148:151], v[88:91], v[112:127]
    v_exp_f32 v85, v85
    v_exp_f32 v86, v86
    v_exp_f32 v87, v87
    v_cvt_pk_bf16_f32 v92, v80, v81
    v_cvt_pk_bf16_f32 v93, v82, v83
    v_cvt_pk_bf16_f32 v94, v84, v85
    v_cvt_pk_bf16_f32 v95, v86, v87
    v_mfma_f32_32x32x16_bf16 v[72:87], v[140:143], v[16:19], v[40:55]
    ds_read_b128 v[140:143], v2 offset:16384
    v_exp_f32 v56, v56
    v_exp_f32 v57, v57
    v_exp_f32 v58, v58
    v_mfma_f32_16x16x32_bf16 v[132:135], v[136:139], v[92:95], v[132:135]
    v_exp_f32 v59, v59
    v_exp_f32 v60, v60
    v_mfma_f32_32x32x16_bf16 v[112:127], v[156:159], v[92:95], v[112:127]
    ds_read_b128 v[156:159], v2 offset:15360
    v_exp_f32 v61, v61
    v_exp_f32 v62, v62
    v_exp_f32 v63, v63
    v_cvt_pk_bf16_f32 v88, v56, v57
    v_cvt_pk_bf16_f32 v89, v58, v59
    v_mfma_f32_32x32x16_bf16 v[72:87], v[144:147], v[20:23], v[72:87]
    ds_read_b128 v[144:147], v2 offset:17408
    v_cvt_pk_bf16_f32 v90, v60, v61
    v_cvt_pk_bf16_f32 v91, v62, v63
    v_exp_f32 v64, v64
    v_exp_f32 v65, v65
    v_exp_f32 v66, v66
    v_mfma_f32_16x16x32_bf16 v[128:131], v[136:139], v[88:91], v[128:131]
    ds_read_b128 v[148:151], v2 offset:18432
    v_exp_f32 v67, v67
    v_exp_f32 v68, v68
    v_mfma_f32_32x32x16_bf16 v[96:111], v[152:155], v[88:91], v[96:111]
    v_exp_f32 v69, v69
    v_exp_f32 v70, v70
    v_exp_f32 v71, v71
    v_cvt_pk_bf16_f32 v92, v64, v65
    v_cvt_pk_bf16_f32 v93, v66, v67
    v_cvt_pk_bf16_f32 v94, v68, v69
    v_cvt_pk_bf16_f32 v95, v70, v71
    s_waitcnt lgkmcnt(0)
    v_mfma_f32_32x32x16_bf16 v[56:71], v[140:143], v[8:11], v[24:39]
    v_exp_f32 v72, v72
    v_exp_f32 v73, v73
    v_exp_f32 v74, v74
    v_mfma_f32_16x16x32_bf16 v[128:131], v[136:139], v[92:95], v[128:131]
    v_exp_f32 v75, v75
    v_exp_f32 v76, v76
    v_mfma_f32_32x32x16_bf16 v[96:111], v[156:159], v[92:95], v[96:111]
    v_exp_f32 v77, v77
    v_exp_f32 v78, v78
    v_exp_f32 v79, v79
    v_cvt_pk_bf16_f32 v88, v72, v73
    v_cvt_pk_bf16_f32 v89, v74, v75
    v_mfma_f32_32x32x16_bf16 v[56:71], v[144:147], v[12:15], v[56:71]
    v_cvt_pk_bf16_f32 v90, v76, v77
    v_cvt_pk_bf16_f32 v91, v78, v79
    v_exp_f32 v80, v80
    v_exp_f32 v81, v81
    v_exp_f32 v82, v82
    v_mfma_f32_16x16x32_bf16 v[132:135], v[136:139], v[88:91], v[132:135]
    v_exp_f32 v83, v83
    v_exp_f32 v84, v84
    v_mfma_f32_32x32x16_bf16 v[112:127], v[152:155], v[88:91], v[112:127]
    v_exp_f32 v85, v85
    v_exp_f32 v86, v86
    v_exp_f32 v87, v87
    v_cvt_pk_bf16_f32 v92, v80, v81
    v_cvt_pk_bf16_f32 v93, v82, v83
    v_cvt_pk_bf16_f32 v94, v84, v85
    v_cvt_pk_bf16_f32 v95, v86, v87
    v_mfma_f32_32x32x16_bf16 v[72:87], v[140:143], v[16:19], v[40:55]
    ds_read_b128 v[140:143], v2 offset:20480
    v_exp_f32 v56, v56
    v_exp_f32 v57, v57
    v_exp_f32 v58, v58
    v_mfma_f32_16x16x32_bf16 v[132:135], v[136:139], v[92:95], v[132:135]
    v_exp_f32 v59, v59
    v_exp_f32 v60, v60
    v_mfma_f32_32x32x16_bf16 v[112:127], v[156:159], v[92:95], v[112:127]
    ds_read_b128 v[156:159], v2 offset:19456
    v_exp_f32 v61, v61
    v_exp_f32 v62, v62
    v_exp_f32 v63, v63
    v_cvt_pk_bf16_f32 v88, v56, v57
    v_cvt_pk_bf16_f32 v89, v58, v59
    v_mfma_f32_32x32x16_bf16 v[72:87], v[144:147], v[20:23], v[72:87]
    ds_read_b128 v[144:147], v2 offset:21504
    v_cvt_pk_bf16_f32 v90, v60, v61
    v_cvt_pk_bf16_f32 v91, v62, v63
    v_exp_f32 v64, v64
    v_exp_f32 v65, v65
    v_exp_f32 v66, v66
    v_mfma_f32_16x16x32_bf16 v[128:131], v[136:139], v[88:91], v[128:131]
    ds_read_b128 v[152:155], v2 offset:22528
    v_exp_f32 v67, v67
    v_exp_f32 v68, v68
    v_mfma_f32_32x32x16_bf16 v[96:111], v[148:151], v[88:91], v[96:111]
    v_exp_f32 v69, v69
    v_exp_f32 v70, v70
    v_exp_f32 v71, v71
    v_cvt_pk_bf16_f32 v92, v64, v65
    v_cvt_pk_bf16_f32 v93, v66, v67
    v_cvt_pk_bf16_f32 v94, v68, v69
    v_cvt_pk_bf16_f32 v95, v70, v71
    s_waitcnt lgkmcnt(0)
    v_mfma_f32_32x32x16_bf16 v[56:71], v[140:143], v[8:11], v[24:39]
    v_exp_f32 v72, v72
    v_exp_f32 v73, v73
    v_exp_f32 v74, v74
    v_mfma_f32_16x16x32_bf16 v[128:131], v[136:139], v[92:95], v[128:131]
    v_exp_f32 v75, v75
    v_exp_f32 v76, v76
    v_mfma_f32_32x32x16_bf16 v[96:111], v[156:159], v[92:95], v[96:111]
    v_exp_f32 v77, v77
    v_exp_f32 v78, v78
    v_exp_f32 v79, v79
    v_cvt_pk_bf16_f32 v88, v72, v73
    v_cvt_pk_bf16_f32 v89, v74, v75
    v_mfma_f32_32x32x16_bf16 v[56:71], v[144:147], v[12:15], v[56:71]
    v_cvt_pk_bf16_f32 v90, v76, v77
    v_cvt_pk_bf16_f32 v91, v78, v79
    v_exp_f32 v80, v80
    v_exp_f32 v81, v81
    v_exp_f32 v82, v82
    v_mfma_f32_16x16x32_bf16 v[132:135], v[136:139], v[88:91], v[132:135]
    v_exp_f32 v83, v83
    v_exp_f32 v84, v84
    v_mfma_f32_32x32x16_bf16 v[112:127], v[148:151], v[88:91], v[112:127]
    v_exp_f32 v85, v85
    v_exp_f32 v86, v86
    v_exp_f32 v87, v87
    v_cvt_pk_bf16_f32 v92, v80, v81
    v_cvt_pk_bf16_f32 v93, v82, v83
    v_cvt_pk_bf16_f32 v94, v84, v85
    v_cvt_pk_bf16_f32 v95, v86, v87
    v_mfma_f32_32x32x16_bf16 v[72:87], v[140:143], v[16:19], v[40:55]
    ds_read_b128 v[140:143], v2 offset:24576
    v_exp_f32 v56, v56
    v_exp_f32 v57, v57
    v_exp_f32 v58, v58
    v_mfma_f32_16x16x32_bf16 v[132:135], v[136:139], v[92:95], v[132:135]
    v_exp_f32 v59, v59
    v_exp_f32 v60, v60
    v_mfma_f32_32x32x16_bf16 v[112:127], v[156:159], v[92:95], v[112:127]
    ds_read_b128 v[156:159], v2 offset:23552
    v_exp_f32 v61, v61
    v_exp_f32 v62, v62
    v_exp_f32 v63, v63
    v_cvt_pk_bf16_f32 v88, v56, v57
    v_cvt_pk_bf16_f32 v89, v58, v59
    v_mfma_f32_32x32x16_bf16 v[72:87], v[144:147], v[20:23], v[72:87]
    ds_read_b128 v[144:147], v2 offset:25600
    v_cvt_pk_bf16_f32 v90, v60, v61
    v_cvt_pk_bf16_f32 v91, v62, v63
    v_exp_f32 v64, v64
    v_exp_f32 v65, v65
    v_exp_f32 v66, v66
    v_mfma_f32_16x16x32_bf16 v[128:131], v[136:139], v[88:91], v[128:131]
    ds_read_b128 v[148:151], v2 offset:26624
    v_exp_f32 v67, v67
    v_exp_f32 v68, v68
    v_mfma_f32_32x32x16_bf16 v[96:111], v[152:155], v[88:91], v[96:111]
    v_exp_f32 v69, v69
    v_exp_f32 v70, v70
    v_exp_f32 v71, v71
    v_cvt_pk_bf16_f32 v92, v64, v65
    v_cvt_pk_bf16_f32 v93, v66, v67
    v_cvt_pk_bf16_f32 v94, v68, v69
    v_cvt_pk_bf16_f32 v95, v70, v71
    s_waitcnt lgkmcnt(0)
    v_mfma_f32_32x32x16_bf16 v[56:71], v[140:143], v[8:11], v[24:39]
    v_exp_f32 v72, v72
    v_exp_f32 v73, v73
    v_exp_f32 v74, v74
    v_mfma_f32_16x16x32_bf16 v[128:131], v[136:139], v[92:95], v[128:131]
    v_exp_f32 v75, v75
    v_exp_f32 v76, v76
    v_mfma_f32_32x32x16_bf16 v[96:111], v[156:159], v[92:95], v[96:111]
    v_exp_f32 v77, v77
    v_exp_f32 v78, v78
    v_exp_f32 v79, v79
    v_cvt_pk_bf16_f32 v88, v72, v73
    v_cvt_pk_bf16_f32 v89, v74, v75
    v_mfma_f32_32x32x16_bf16 v[56:71], v[144:147], v[12:15], v[56:71]
    v_cvt_pk_bf16_f32 v90, v76, v77
    v_cvt_pk_bf16_f32 v91, v78, v79
    v_exp_f32 v80, v80
    v_exp_f32 v81, v81
    v_exp_f32 v82, v82
    v_mfma_f32_16x16x32_bf16 v[132:135], v[136:139], v[88:91], v[132:135]
    v_exp_f32 v83, v83
    v_exp_f32 v84, v84
    v_mfma_f32_32x32x16_bf16 v[112:127], v[152:155], v[88:91], v[112:127]
    v_exp_f32 v85, v85
    v_exp_f32 v86, v86
    v_exp_f32 v87, v87
    v_cvt_pk_bf16_f32 v92, v80, v81
    v_cvt_pk_bf16_f32 v93, v82, v83
    v_cvt_pk_bf16_f32 v94, v84, v85
    v_cvt_pk_bf16_f32 v95, v86, v87
    v_mfma_f32_32x32x16_bf16 v[72:87], v[140:143], v[16:19], v[40:55]
    ds_read_b128 v[140:143], v2 offset:28672
    v_exp_f32 v56, v56
    v_exp_f32 v57, v57
    v_exp_f32 v58, v58
    v_mfma_f32_16x16x32_bf16 v[132:135], v[136:139], v[92:95], v[132:135]
    v_exp_f32 v59, v59
    v_exp_f32 v60, v60
    v_mfma_f32_32x32x16_bf16 v[112:127], v[156:159], v[92:95], v[112:127]
    ds_read_b128 v[156:159], v2 offset:27648
    v_exp_f32 v61, v61
    v_exp_f32 v62, v62
    v_exp_f32 v63, v63
    v_cvt_pk_bf16_f32 v88, v56, v57
    v_cvt_pk_bf16_f32 v89, v58, v59
    v_mfma_f32_32x32x16_bf16 v[72:87], v[144:147], v[20:23], v[72:87]
    ds_read_b128 v[144:147], v2 offset:29696
    v_cvt_pk_bf16_f32 v90, v60, v61
    v_cvt_pk_bf16_f32 v91, v62, v63
    v_exp_f32 v64, v64
    v_exp_f32 v65, v65
    v_exp_f32 v66, v66
    v_mfma_f32_16x16x32_bf16 v[128:131], v[136:139], v[88:91], v[128:131]
    ds_read_b128 v[152:155], v2 offset:30720
    v_exp_f32 v67, v67
    v_exp_f32 v68, v68
    v_mfma_f32_32x32x16_bf16 v[96:111], v[148:151], v[88:91], v[96:111]
    v_exp_f32 v69, v69
    v_exp_f32 v70, v70
    v_exp_f32 v71, v71
    v_cvt_pk_bf16_f32 v92, v64, v65
    v_cvt_pk_bf16_f32 v93, v66, v67
    v_cvt_pk_bf16_f32 v94, v68, v69
    v_cvt_pk_bf16_f32 v95, v70, v71
    s_waitcnt lgkmcnt(0)
    v_mfma_f32_32x32x16_bf16 v[56:71], v[140:143], v[8:11], v[24:39]
    s_add_u32 s18, s18, 32768
    s_and_b32 s18, s18, 131071
    v_exp_f32 v72, v72
    v_exp_f32 v73, v73
    v_exp_f32 v74, v74
    v_mfma_f32_16x16x32_bf16 v[128:131], v[136:139], v[92:95], v[128:131]
    v_exp_f32 v75, v75
    v_exp_f32 v76, v76
    v_mfma_f32_32x32x16_bf16 v[96:111], v[156:159], v[92:95], v[96:111]
    v_add_u32 v3, s18, v4
    v_exp_f32 v77, v77
    v_exp_f32 v78, v78
    v_exp_f32 v79, v79
    v_cvt_pk_bf16_f32 v88, v72, v73
    v_cvt_pk_bf16_f32 v89, v74, v75
    v_mfma_f32_32x32x16_bf16 v[56:71], v[144:147], v[12:15], v[56:71]
    v_cvt_pk_bf16_f32 v90, v76, v77
    v_cvt_pk_bf16_f32 v91, v78, v79
    v_exp_f32 v80, v80
    v_exp_f32 v81, v81
    v_exp_f32 v82, v82
    v_mfma_f32_16x16x32_bf16 v[132:135], v[136:139], v[88:91], v[132:135]
    v_exp_f32 v83, v83
    v_exp_f32 v84, v84
    v_mfma_f32_32x32x16_bf16 v[112:127], v[148:151], v[88:91], v[112:127]
    v_exp_f32 v85, v85
    v_exp_f32 v86, v86
    v_exp_f32 v87, v87
    v_cvt_pk_bf16_f32 v92, v80, v81
    v_cvt_pk_bf16_f32 v93, v82, v83
    v_cvt_pk_bf16_f32 v94, v84, v85
    v_cvt_pk_bf16_f32 v95, v86, v87
    v_mfma_f32_32x32x16_bf16 v[72:87], v[140:143], v[16:19], v[40:55]
    s_barrier
    ds_read_b128 v[140:143], v3 offset:0
    v_exp_f32 v56, v56
    v_exp_f32 v57, v57
    v_exp_f32 v58, v58
    v_mfma_f32_16x16x32_bf16 v[132:135], v[136:139], v[92:95], v[132:135]
    v_exp_f32 v59, v59
    v_exp_f32 v60, v60
    v_mfma_f32_32x32x16_bf16 v[112:127], v[156:159], v[92:95], v[112:127]
    ds_read_b128 v[156:159], v2 offset:31744
    v_exp_f32 v61, v61
    v_exp_f32 v62, v62
    v_exp_f32 v63, v63
    v_cvt_pk_bf16_f32 v88, v56, v57
    v_cvt_pk_bf16_f32 v89, v58, v59
    v_mfma_f32_32x32x16_bf16 v[72:87], v[144:147], v[20:23], v[72:87]
    ds_read_b128 v[144:147], v3 offset:1024
    v_cvt_pk_bf16_f32 v90, v60, v61
    v_cvt_pk_bf16_f32 v91, v62, v63
    v_exp_f32 v64, v64
    v_exp_f32 v65, v65
    v_exp_f32 v66, v66
    v_mfma_f32_16x16x32_bf16 v[128:131], v[136:139], v[88:91], v[128:131]
    ds_read_b128 v[148:151], v3 offset:2048
    v_exp_f32 v67, v67
    v_exp_f32 v68, v68
    v_mfma_f32_32x32x16_bf16 v[96:111], v[152:155], v[88:91], v[96:111]
    v_exp_f32 v69, v69
    v_exp_f32 v70, v70
    v_exp_f32 v71, v71
    v_cvt_pk_bf16_f32 v92, v64, v65
    v_cvt_pk_bf16_f32 v93, v66, v67
    v_cvt_pk_bf16_f32 v94, v68, v69
    v_cvt_pk_bf16_f32 v95, v70, v71
    s_waitcnt lgkmcnt(0)
    v_mfma_f32_32x32x16_bf16 v[56:71], v[140:143], v[8:11], v[24:39]
    v_exp_f32 v72, v72
    v_exp_f32 v73, v73
    v_exp_f32 v74, v74
    v_mfma_f32_16x16x32_bf16 v[128:131], v[136:139], v[92:95], v[128:131]
    v_exp_f32 v75, v75
    v_exp_f32 v76, v76
    v_mfma_f32_32x32x16_bf16 v[96:111], v[156:159], v[92:95], v[96:111]
    v_mov_b32 v2, v3
    v_exp_f32 v77, v77
    v_exp_f32 v78, v78
    v_exp_f32 v79, v79
    v_cvt_pk_bf16_f32 v88, v72, v73
    v_cvt_pk_bf16_f32 v89, v74, v75
    v_mfma_f32_32x32x16_bf16 v[56:71], v[144:147], v[12:15], v[56:71]
    s_sub_u32 s19, s19, 1
    s_cmp_lg_u32 s19, 0
    v_cvt_pk_bf16_f32 v90, v76, v77
    v_cvt_pk_bf16_f32 v91, v78, v79
    v_exp_f32 v80, v80
    v_exp_f32 v81, v81
    v_exp_f32 v82, v82
    v_mfma_f32_16x16x32_bf16 v[132:135], v[136:139], v[88:91], v[132:135]
    v_exp_f32 v83, v83
    v_exp_f32 v84, v84
    v_mfma_f32_32x32x16_bf16 v[112:127], v[152:155], v[88:91], v[112:127]
    v_exp_f32 v85, v85
    v_exp_f32 v86, v86
    v_exp_f32 v87, v87
    v_cvt_pk_bf16_f32 v92, v80, v81
    v_cvt_pk_bf16_f32 v93, v82, v83
    v_cvt_pk_bf16_f32 v94, v84, v85
    v_cvt_pk_bf16_f32 v95, v86, v87
    s_cbranch_scc1 adaLN_cond__mha_block__mixer_gmlp__prompt_kernel_a_loop
    s_nop 0
    v_mfma_f32_32x32x16_bf16 v[112:127], v[156:159], v[92:95], v[112:127]
    v_mfma_f32_16x16x32_bf16 v[132:135], v[136:139], v[92:95], v[132:135]
    v_rcp_f32 v6, v128
    v_pk_mul_f32 v[56:57], v[96:97], 0
    v_pk_fma_f32 v[56:57], v[98:99], 0, v[56:57]
    v_pk_fma_f32 v[56:57], v[100:101], 0, v[56:57]
    v_pk_fma_f32 v[56:57], v[102:103], 0, v[56:57]
    v_pk_fma_f32 v[56:57], v[104:105], 0, v[56:57]
    v_pk_fma_f32 v[56:57], v[106:107], 0, v[56:57]
    v_pk_fma_f32 v[56:57], v[108:109], 0, v[56:57]
    v_pk_fma_f32 v[56:57], v[110:111], 0, v[56:57]
    v_pk_mul_f32 v[96:97], v[96:97], v[6:7] op_sel_hi:[1,0]
    v_pk_mul_f32 v[98:99], v[98:99], v[6:7] op_sel_hi:[1,0]
    v_pk_mul_f32 v[100:101], v[100:101], v[6:7] op_sel_hi:[1,0]
    v_pk_mul_f32 v[102:103], v[102:103], v[6:7] op_sel_hi:[1,0]
    v_pk_mul_f32 v[104:105], v[104:105], v[6:7] op_sel_hi:[1,0]
    v_pk_mul_f32 v[106:107], v[106:107], v[6:7] op_sel_hi:[1,0]
    v_pk_mul_f32 v[108:109], v[108:109], v[6:7] op_sel_hi:[1,0]
    v_pk_mul_f32 v[110:111], v[110:111], v[6:7] op_sel_hi:[1,0]
    v_cvt_pk_bf16_f32 v64, v96, v97
    v_cvt_pk_bf16_f32 v65, v98, v99
    v_cvt_pk_bf16_f32 v66, v100, v101
    v_cvt_pk_bf16_f32 v67, v102, v103
    v_cvt_pk_bf16_f32 v68, v104, v105
    v_cvt_pk_bf16_f32 v69, v106, v107
    v_cvt_pk_bf16_f32 v70, v108, v109
    v_cvt_pk_bf16_f32 v71, v110, v111
    s_nop 1
    v_permlane32_swap_b32 v64, v66
    v_permlane32_swap_b32 v65, v67
    v_permlane32_swap_b32 v68, v70
    v_permlane32_swap_b32 v69, v71
    buffer_store_dwordx4 v[64:67], v5, s[24:27], s7 offen offset:0 sc1
    buffer_store_dwordx4 v[68:71], v5, s[24:27], s7 offen offset:512 sc1
    s_nop 1
    v_rcp_f32 v6, v132
    v_pk_mul_f32 v[58:59], v[112:113], 0
    v_pk_fma_f32 v[58:59], v[114:115], 0, v[58:59]
    v_pk_fma_f32 v[58:59], v[116:117], 0, v[58:59]
    v_pk_fma_f32 v[58:59], v[118:119], 0, v[58:59]
    v_pk_fma_f32 v[58:59], v[120:121], 0, v[58:59]
    v_pk_fma_f32 v[58:59], v[122:123], 0, v[58:59]
    v_pk_fma_f32 v[58:59], v[124:125], 0, v[58:59]
    v_pk_fma_f32 v[58:59], v[126:127], 0, v[58:59]
    v_pk_mul_f32 v[112:113], v[112:113], v[6:7] op_sel_hi:[1,0]
    v_pk_mul_f32 v[114:115], v[114:115], v[6:7] op_sel_hi:[1,0]
    v_pk_mul_f32 v[116:117], v[116:117], v[6:7] op_sel_hi:[1,0]
    v_pk_mul_f32 v[118:119], v[118:119], v[6:7] op_sel_hi:[1,0]
    v_pk_mul_f32 v[120:121], v[120:121], v[6:7] op_sel_hi:[1,0]
    v_pk_mul_f32 v[122:123], v[122:123], v[6:7] op_sel_hi:[1,0]
    v_pk_mul_f32 v[124:125], v[124:125], v[6:7] op_sel_hi:[1,0]
    v_pk_mul_f32 v[126:127], v[126:127], v[6:7] op_sel_hi:[1,0]
    v_cvt_pk_bf16_f32 v72, v112, v113
    v_cvt_pk_bf16_f32 v73, v114, v115
    v_cvt_pk_bf16_f32 v74, v116, v117
    v_cvt_pk_bf16_f32 v75, v118, v119
    v_cvt_pk_bf16_f32 v76, v120, v121
    v_cvt_pk_bf16_f32 v77, v122, v123
    v_cvt_pk_bf16_f32 v78, v124, v125
    v_cvt_pk_bf16_f32 v79, v126, v127
    s_nop 1
    v_permlane32_swap_b32 v72, v74
    v_permlane32_swap_b32 v73, v75
    v_permlane32_swap_b32 v76, v78
    v_permlane32_swap_b32 v77, v79
    buffer_store_dwordx4 v[72:75], v5, s[24:27], s32 offen offset:0 sc1
    buffer_store_dwordx4 v[76:79], v5, s[24:27], s32 offen offset:512 sc1
    v_mov_b32 v6, 0x71800000
    v_cmp_nle_f32 s[20:21], v128, v6
    v_cmp_nle_f32 vcc, v132, v6
    s_or_b64 s[20:21], s[20:21], vcc
    v_cmp_u_f32 vcc, v56, v57
    s_or_b64 s[20:21], s[20:21], vcc
    v_cmp_u_f32 vcc, v58, v59
    s_or_b64 s[20:21], s[20:21], vcc
    s_cmp_lg_u64 s[20:21], 0
    s_cselect_b32 s20, 1, 0
    s_cmp_eq_u32 s33, 0
    s_cselect_b32 s20, s20, 0
    v_mov_b32 v6, s20
    s_lshl_b32 s21, s3, 2
    v_mov_b32 v7, s21
    ds_write_b32 v7, v6
    s_waitcnt lgkmcnt(0)
    s_barrier
    v_mov_b32 v7, 0
    ds_read_b128 v[140:143], v7
    s_waitcnt lgkmcnt(0)
    v_or3_b32 v6, v140, v141, v142
    v_or_b32 v6, v6, v143
    s_nop 0
    v_readfirstlane_b32 s20, v6
    s_nop 3
    s_cmp_eq_u32 s20, 0
    s_cbranch_scc1 adaLN_cond__mha_block__mixer_gmlp__prompt_kernel_a_ok
adaLN_cond__mha_block__mixer_gmlp__prompt_kernel_a_fb:
    s_mov_b32 s33, 1
    s_waitcnt vmcnt(0)
    s_barrier
    v_mov_b32 v88, 0xff800000
    v_mov_b32 v89, 0xff800000
    s_mov_b32 s18, 0
    s_mov_b32 s19, 8
    s_barrier
adaLN_cond__mha_block__mixer_gmlp__prompt_kernel_a_mx:
    v_add_u32 v2, s18, v4
    ds_read_b128 v[140:143], v2 offset:0
    ds_read_b128 v[144:147], v2 offset:1024
    s_waitcnt lgkmcnt(0)
    v_mfma_f32_32x32x16_bf16 v[56:71], v[140:143], v[8:11], 0
    v_mfma_f32_32x32x16_bf16 v[56:71], v[144:147], v[12:15], v[56:71]
    v_mfma_f32_32x32x16_bf16 v[72:87], v[140:143], v[16:19], 0
    v_mfma_f32_32x32x16_bf16 v[72:87], v[144:147], v[20:23], v[72:87]
    s_nop 7
    s_nop 7
    v_max3_f32 v88, v88, v56, v57
    v_max3_f32 v88, v88, v58, v59
    v_max3_f32 v88, v88, v60, v61
    v_max3_f32 v88, v88, v62, v63
    v_max3_f32 v88, v88, v64, v65
    v_max3_f32 v88, v88, v66, v67
    v_max3_f32 v88, v88, v68, v69
    v_max3_f32 v88, v88, v70, v71
    v_max3_f32 v89, v89, v72, v73
    v_max3_f32 v89, v89, v74, v75
    v_max3_f32 v89, v89, v76, v77
    v_max3_f32 v89, v89, v78, v79
    v_max3_f32 v89, v89, v80, v81
    v_max3_f32 v89, v89, v82, v83
    v_max3_f32 v89, v89, v84, v85
    v_max3_f32 v89, v89, v86, v87
    ds_read_b128 v[140:143], v2 offset:4096
    ds_read_b128 v[144:147], v2 offset:5120
    s_waitcnt lgkmcnt(0)
    v_mfma_f32_32x32x16_bf16 v[56:71], v[140:143], v[8:11], 0
    v_mfma_f32_32x32x16_bf16 v[56:71], v[144:147], v[12:15], v[56:71]
    v_mfma_f32_32x32x16_bf16 v[72:87], v[140:143], v[16:19], 0
    v_mfma_f32_32x32x16_bf16 v[72:87], v[144:147], v[20:23], v[72:87]
    s_nop 7
    s_nop 7
    v_max3_f32 v88, v88, v56, v57
    v_max3_f32 v88, v88, v58, v59
    v_max3_f32 v88, v88, v60, v61
    v_max3_f32 v88, v88, v62, v63
    v_max3_f32 v88, v88, v64, v65
    v_max3_f32 v88, v88, v66, v67
    v_max3_f32 v88, v88, v68, v69
    v_max3_f32 v88, v88, v70, v71
    v_max3_f32 v89, v89, v72, v73
    v_max3_f32 v89, v89, v74, v75
    v_max3_f32 v89, v89, v76, v77
    v_max3_f32 v89, v89, v78, v79
    v_max3_f32 v89, v89, v80, v81
    v_max3_f32 v89, v89, v82, v83
    v_max3_f32 v89, v89, v84, v85
    v_max3_f32 v89, v89, v86, v87
    ds_read_b128 v[140:143], v2 offset:8192
    ds_read_b128 v[144:147], v2 offset:9216
    s_waitcnt lgkmcnt(0)
    v_mfma_f32_32x32x16_bf16 v[56:71], v[140:143], v[8:11], 0
    v_mfma_f32_32x32x16_bf16 v[56:71], v[144:147], v[12:15], v[56:71]
    v_mfma_f32_32x32x16_bf16 v[72:87], v[140:143], v[16:19], 0
    v_mfma_f32_32x32x16_bf16 v[72:87], v[144:147], v[20:23], v[72:87]
    s_nop 7
    s_nop 7
    v_max3_f32 v88, v88, v56, v57
    v_max3_f32 v88, v88, v58, v59
    v_max3_f32 v88, v88, v60, v61
    v_max3_f32 v88, v88, v62, v63
    v_max3_f32 v88, v88, v64, v65
    v_max3_f32 v88, v88, v66, v67
    v_max3_f32 v88, v88, v68, v69
    v_max3_f32 v88, v88, v70, v71
    v_max3_f32 v89, v89, v72, v73
    v_max3_f32 v89, v89, v74, v75
    v_max3_f32 v89, v89, v76, v77
    v_max3_f32 v89, v89, v78, v79
    v_max3_f32 v89, v89, v80, v81
    v_max3_f32 v89, v89, v82, v83
    v_max3_f32 v89, v89, v84, v85
    v_max3_f32 v89, v89, v86, v87
    ds_read_b128 v[140:143], v2 offset:12288
    ds_read_b128 v[144:147], v2 offset:13312
    s_waitcnt lgkmcnt(0)
    v_mfma_f32_32x32x16_bf16 v[56:71], v[140:143], v[8:11], 0
    v_mfma_f32_32x32x16_bf16 v[56:71], v[144:147], v[12:15], v[56:71]
    v_mfma_f32_32x32x16_bf16 v[72:87], v[140:143], v[16:19], 0
    v_mfma_f32_32x32x16_bf16 v[72:87], v[144:147], v[20:23], v[72:87]
    s_nop 7
    s_nop 7
    v_max3_f32 v88, v88, v56, v57
    v_max3_f32 v88, v88, v58, v59
    v_max3_f32 v88, v88, v60, v61
    v_max3_f32 v88, v88, v62, v63
    v_max3_f32 v88, v88, v64, v65
    v_max3_f32 v88, v88, v66, v67
    v_max3_f32 v88, v88, v68, v69
    v_max3_f32 v88, v88, v70, v71
    v_max3_f32 v89, v89, v72, v73
    v_max3_f32 v89, v89, v74, v75
    v_max3_f32 v89, v89, v76, v77
    v_max3_f32 v89, v89, v78, v79
    v_max3_f32 v89, v89, v80, v81
    v_max3_f32 v89, v89, v82, v83
    v_max3_f32 v89, v89, v84, v85
    v_max3_f32 v89, v89, v86, v87
    ds_read_b128 v[140:143], v2 offset:16384
    ds_read_b128 v[144:147], v2 offset:17408
    s_waitcnt lgkmcnt(0)
    v_mfma_f32_32x32x16_bf16 v[56:71], v[140:143], v[8:11], 0
    v_mfma_f32_32x32x16_bf16 v[56:71], v[144:147], v[12:15], v[56:71]
    v_mfma_f32_32x32x16_bf16 v[72:87], v[140:143], v[16:19], 0
    v_mfma_f32_32x32x16_bf16 v[72:87], v[144:147], v[20:23], v[72:87]
    s_nop 7
    s_nop 7
    v_max3_f32 v88, v88, v56, v57
    v_max3_f32 v88, v88, v58, v59
    v_max3_f32 v88, v88, v60, v61
    v_max3_f32 v88, v88, v62, v63
    v_max3_f32 v88, v88, v64, v65
    v_max3_f32 v88, v88, v66, v67
    v_max3_f32 v88, v88, v68, v69
    v_max3_f32 v88, v88, v70, v71
    v_max3_f32 v89, v89, v72, v73
    v_max3_f32 v89, v89, v74, v75
    v_max3_f32 v89, v89, v76, v77
    v_max3_f32 v89, v89, v78, v79
    v_max3_f32 v89, v89, v80, v81
    v_max3_f32 v89, v89, v82, v83
    v_max3_f32 v89, v89, v84, v85
    v_max3_f32 v89, v89, v86, v87
    ds_read_b128 v[140:143], v2 offset:20480
    ds_read_b128 v[144:147], v2 offset:21504
    s_waitcnt lgkmcnt(0)
    v_mfma_f32_32x32x16_bf16 v[56:71], v[140:143], v[8:11], 0
    v_mfma_f32_32x32x16_bf16 v[56:71], v[144:147], v[12:15], v[56:71]
    v_mfma_f32_32x32x16_bf16 v[72:87], v[140:143], v[16:19], 0
    v_mfma_f32_32x32x16_bf16 v[72:87], v[144:147], v[20:23], v[72:87]
    s_nop 7
    s_nop 7
    v_max3_f32 v88, v88, v56, v57
    v_max3_f32 v88, v88, v58, v59
    v_max3_f32 v88, v88, v60, v61
    v_max3_f32 v88, v88, v62, v63
    v_max3_f32 v88, v88, v64, v65
    v_max3_f32 v88, v88, v66, v67
    v_max3_f32 v88, v88, v68, v69
    v_max3_f32 v88, v88, v70, v71
    v_max3_f32 v89, v89, v72, v73
    v_max3_f32 v89, v89, v74, v75
    v_max3_f32 v89, v89, v76, v77
    v_max3_f32 v89, v89, v78, v79
    v_max3_f32 v89, v89, v80, v81
    v_max3_f32 v89, v89, v82, v83
    v_max3_f32 v89, v89, v84, v85
    v_max3_f32 v89, v89, v86, v87
    ds_read_b128 v[140:143], v2 offset:24576
    ds_read_b128 v[144:147], v2 offset:25600
    s_waitcnt lgkmcnt(0)
    v_mfma_f32_32x32x16_bf16 v[56:71], v[140:143], v[8:11], 0
    v_mfma_f32_32x32x16_bf16 v[56:71], v[144:147], v[12:15], v[56:71]
    v_mfma_f32_32x32x16_bf16 v[72:87], v[140:143], v[16:19], 0
    v_mfma_f32_32x32x16_bf16 v[72:87], v[144:147], v[20:23], v[72:87]
    s_nop 7
    s_nop 7
    v_max3_f32 v88, v88, v56, v57
    v_max3_f32 v88, v88, v58, v59
    v_max3_f32 v88, v88, v60, v61
    v_max3_f32 v88, v88, v62, v63
    v_max3_f32 v88, v88, v64, v65
    v_max3_f32 v88, v88, v66, v67
    v_max3_f32 v88, v88, v68, v69
    v_max3_f32 v88, v88, v70, v71
    v_max3_f32 v89, v89, v72, v73
    v_max3_f32 v89, v89, v74, v75
    v_max3_f32 v89, v89, v76, v77
    v_max3_f32 v89, v89, v78, v79
    v_max3_f32 v89, v89, v80, v81
    v_max3_f32 v89, v89, v82, v83
    v_max3_f32 v89, v89, v84, v85
    v_max3_f32 v89, v89, v86, v87
    ds_read_b128 v[140:143], v2 offset:28672
    ds_read_b128 v[144:147], v2 offset:29696
    s_waitcnt lgkmcnt(0)
    v_mfma_f32_32x32x16_bf16 v[56:71], v[140:143], v[8:11], 0
    v_mfma_f32_32x32x16_bf16 v[56:71], v[144:147], v[12:15], v[56:71]
    v_mfma_f32_32x32x16_bf16 v[72:87], v[140:143], v[16:19], 0
    v_mfma_f32_32x32x16_bf16 v[72:87], v[144:147], v[20:23], v[72:87]
    s_nop 7
    s_nop 7
    v_max3_f32 v88, v88, v56, v57
    v_max3_f32 v88, v88, v58, v59
    v_max3_f32 v88, v88, v60, v61
    v_max3_f32 v88, v88, v62, v63
    v_max3_f32 v88, v88, v64, v65
    v_max3_f32 v88, v88, v66, v67
    v_max3_f32 v88, v88, v68, v69
    v_max3_f32 v88, v88, v70, v71
    v_max3_f32 v89, v89, v72, v73
    v_max3_f32 v89, v89, v74, v75
    v_max3_f32 v89, v89, v76, v77
    v_max3_f32 v89, v89, v78, v79
    v_max3_f32 v89, v89, v80, v81
    v_max3_f32 v89, v89, v82, v83
    v_max3_f32 v89, v89, v84, v85
    v_max3_f32 v89, v89, v86, v87
    s_barrier
    s_add_u32 s18, s18, 32768
    s_and_b32 s18, s18, 131071
    s_sub_u32 s19, s19, 1
    s_cmp_lg_u32 s19, 0
    s_cbranch_scc1 adaLN_cond__mha_block__mixer_gmlp__prompt_kernel_a_mx
    v_mov_b32 v7, v88
    s_nop 1
    v_permlane32_swap_b32 v88, v7
    s_nop 0
    v_max_f32 v6, v88, v7
    v_sub_f32 v24, 0, v6
    v_mov_b32 v25, v24
    v_mov_b32 v26, v24
    v_mov_b32 v27, v24
    v_mov_b32 v28, v24
    v_mov_b32 v29, v24
    v_mov_b32 v30, v24
    v_mov_b32 v31, v24
    v_mov_b32 v32, v24
    v_mov_b32 v33, v24
    v_mov_b32 v34, v24
    v_mov_b32 v35, v24
    v_mov_b32 v36, v24
    v_mov_b32 v37, v24
    v_mov_b32 v38, v24
    v_mov_b32 v39, v24
    v_mov_b32 v7, v89
    s_nop 1
    v_permlane32_swap_b32 v89, v7
    s_nop 0
    v_max_f32 v6, v89, v7
    v_sub_f32 v40, 0, v6
    v_mov_b32 v41, v40
    v_mov_b32 v42, v40
    v_mov_b32 v43, v40
    v_mov_b32 v44, v40
    v_mov_b32 v45, v40
    v_mov_b32 v46, v40
    v_mov_b32 v47, v40
    v_mov_b32 v48, v40
    v_mov_b32 v49, v40
    v_mov_b32 v50, v40
    v_mov_b32 v51, v40
    v_mov_b32 v52, v40
    v_mov_b32 v53, v40
    v_mov_b32 v54, v40
    v_mov_b32 v55, v40
    v_mov_b32 v96, 0
    v_mov_b32 v97, 0
    v_mov_b32 v98, 0
    v_mov_b32 v99, 0
    v_mov_b32 v100, 0
    v_mov_b32 v101, 0
    v_mov_b32 v102, 0
    v_mov_b32 v103, 0
    v_mov_b32 v104, 0
    v_mov_b32 v105, 0
    v_mov_b32 v106, 0
    v_mov_b32 v107, 0
    v_mov_b32 v108, 0
    v_mov_b32 v109, 0
    v_mov_b32 v110, 0
    v_mov_b32 v111, 0
    v_mov_b32 v112, 0
    v_mov_b32 v113, 0
    v_mov_b32 v114, 0
    v_mov_b32 v115, 0
    v_mov_b32 v116, 0
    v_mov_b32 v117, 0
    v_mov_b32 v118, 0
    v_mov_b32 v119, 0
    v_mov_b32 v120, 0
    v_mov_b32 v121, 0
    v_mov_b32 v122, 0
    v_mov_b32 v123, 0
    v_mov_b32 v124, 0
    v_mov_b32 v125, 0
    v_mov_b32 v126, 0
    v_mov_b32 v127, 0
    v_mov_b32 v128, 0
    v_mov_b32 v129, 0
    v_mov_b32 v130, 0
    v_mov_b32 v131, 0
    v_mov_b32 v132, 0
    v_mov_b32 v133, 0
    v_mov_b32 v134, 0
    v_mov_b32 v135, 0
    v_mov_b32 v92, 0
    v_mov_b32 v93, 0
    v_mov_b32 v94, 0
    v_mov_b32 v95, 0
    v_mov_b32 v156, 0
    v_mov_b32 v157, 0
    v_mov_b32 v158, 0
    v_mov_b32 v159, 0
    v_mov_b32 v2, v4
    s_mov_b32 s18, 0
    s_barrier
    s_barrier
    ds_read_b128 v[140:143], v2 offset:0
    ds_read_b128 v[144:147], v2 offset:1024
    ds_read_b128 v[148:151], v2 offset:2048
    s_waitcnt lgkmcnt(0)
    s_branch adaLN_cond__mha_block__mixer_gmlp__prompt_kernel_a_havem
adaLN_cond__mha_block__mixer_gmlp__prompt_kernel_a_ok:
    s_mov_b32 s21, s4
    s_add_u32 s20, s5, 32
    s_mul_i32 s20, s20, 4352
    s_lshl_b32 s21, s21, 7
    s_add_u32 s20, s20, s21
    v_mov_b32 v2, s101
    v_mov_b32 v3, 0
    s_cmp_eq_u32 s3, 0
    s_waitcnt vmcnt(0)
    s_barrier
    s_cbranch_scc0 adaLN_cond__mha_block__mixer_gmlp__prompt_kernel_a_sig
    s_mov_b64 exec, 1
    buffer_store_dword v2, v3, s[96:99], s20 offen sc1
    s_mov_b64 exec, -1
adaLN_cond__mha_block__mixer_gmlp__prompt_kernel_a_sig:
    s_and_b32 s20, s2, 7
    s_lshr_b32 s21, s2, 3
    s_and_b32 s4, s20, 3
    s_lshl_b32 s4, s4, 3
    s_and_b32 s22, s21, 7
    s_add_u32 s4, s4, s22
    s_lshr_b32 s5, s20, 2
    s_mul_i32 s5, s5, 4
    s_lshr_b32 s22, s21, 3
    s_add_u32 s5, s5, s22
    s_cmp_eq_u32 s3, 1
    s_cbranch_scc0 adaLN_cond__mha_block__mixer_gmlp__prompt_kernel_p_ns1
    v_and_b32 v2, 31, v0
    v_lshlrev_b32 v2, 7, v2
    v_bfe_u32 v3, v0, 5, 1
    v_mul_u32_u24 v3, 4352, v3
    v_add_u32 v2, v2, v3
    s_mov_b32 s19, 0x80000
adaLN_cond__mha_block__mixer_gmlp__prompt_kernel_p_sp1:
    s_mov_b32 s20, 417792
    buffer_load_dword v240, v2, s[96:99], s20 offen sc1
    s_mov_b32 s20, 426496
    buffer_load_dword v241, v2, s[96:99], s20 offen sc1
    s_mov_b32 s20, 435200
    buffer_load_dword v242, v2, s[96:99], s20 offen sc1
    s_mov_b32 s20, 443904
    buffer_load_dword v243, v2, s[96:99], s20 offen sc1
    s_waitcnt vmcnt(0)
    v_xor_b32 v240, s101, v240
    v_xor_b32 v241, s101, v241
    v_xor_b32 v242, s101, v242
    v_xor_b32 v243, s101, v243
    v_or3_b32 v240, v240, v241, v242
    v_or_b32 v240, v240, v243
    v_cmp_ne_u32 vcc, 0, v240
    s_sub_u32 s19, s19, 1
    s_cmp_eq_u32 s19, 0
    s_cbranch_scc1 adaLN_cond__mha_block__mixer_gmlp__prompt_kernel_p_sp1_d
    s_cbranch_vccz adaLN_cond__mha_block__mixer_gmlp__prompt_kernel_p_sp1_d
    s_sleep 4
    s_branch adaLN_cond__mha_block__mixer_gmlp__prompt_kernel_p_sp1
adaLN_cond__mha_block__mixer_gmlp__prompt_kernel_p_sp1_d:
adaLN_cond__mha_block__mixer_gmlp__prompt_kernel_p_ns1:
    s_cmp_eq_u32 s3, 2
    s_cbranch_scc0 adaLN_cond__mha_block__mixer_gmlp__prompt_kernel_p_ns2
    v_and_b32 v2, 31, v0
    v_lshlrev_b32 v2, 7, v2
    v_bfe_u32 v3, v0, 5, 1
    v_mul_u32_u24 v3, 4352, v3
    v_add_u32 v2, v2, v3
    s_mov_b32 s19, 0x80000
adaLN_cond__mha_block__mixer_gmlp__prompt_kernel_p_sp2:
    s_mov_b32 s20, 452608
    buffer_load_dword v240, v2, s[96:99], s20 offen sc1
    s_mov_b32 s20, 461312
    buffer_load_dword v241, v2, s[96:99], s20 offen sc1
    s_mov_b32 s20, 470016
    buffer_load_dword v242, v2, s[96:99], s20 offen sc1
    s_mov_b32 s20, 478720
    buffer_load_dword v243, v2, s[96:99], s20 offen sc1
    s_waitcnt vmcnt(0)
    v_xor_b32 v240, s101, v240
    v_xor_b32 v241, s101, v241
    v_xor_b32 v242, s101, v242
    v_xor_b32 v243, s101, v243
    v_or3_b32 v240, v240, v241, v242
    v_or_b32 v240, v240, v243
    v_cmp_ne_u32 vcc, 0, v240
    s_sub_u32 s19, s19, 1
    s_cmp_eq_u32 s19, 0
    s_cbranch_scc1 adaLN_cond__mha_block__mixer_gmlp__prompt_kernel_p_sp2_d
    s_cbranch_vccz adaLN_cond__mha_block__mixer_gmlp__prompt_kernel_p_sp2_d
    s_sleep 4
    s_branch adaLN_cond__mha_block__mixer_gmlp__prompt_kernel_p_sp2
adaLN_cond__mha_block__mixer_gmlp__prompt_kernel_p_sp2_d:
adaLN_cond__mha_block__mixer_gmlp__prompt_kernel_p_ns2:
    s_cmp_eq_u32 s3, 0
    s_cbranch_scc0 adaLN_cond__mha_block__mixer_gmlp__prompt_kernel_p_np
    s_lshr_b32 s20, s4, 2
    s_add_u32 s20, s20, 32
    s_mul_i32 s20, s20, 4352
    v_and_b32 v2, 63, v0
    v_lshlrev_b32 v2, 7, v2
    s_bfm_b64 exec, 32, 0
    s_mov_b32 s19, 0x80000
adaLN_cond__mha_block__mixer_gmlp__prompt_kernel_p_dp:
    buffer_load_dword v240, v2, s[96:99], s20 offen sc1
    s_waitcnt vmcnt(0)
    v_cmp_ne_u32 vcc, s101, v240
    s_sub_u32 s19, s19, 1
    s_cmp_eq_u32 s19, 0
    s_cbranch_scc1 adaLN_cond__mha_block__mixer_gmlp__prompt_kernel_p_dp_d
    s_cbranch_vccz adaLN_cond__mha_block__mixer_gmlp__prompt_kernel_p_dp_d
    s_sleep 4
    s_branch adaLN_cond__mha_block__mixer_gmlp__prompt_kernel_p_dp
adaLN_cond__mha_block__mixer_gmlp__prompt_kernel_p_dp_d:
    s_mov_b64 exec, -1
adaLN_cond__mha_block__mixer_gmlp__prompt_kernel_p_np:
    s_barrier
    v_and_b32 v1, 63, v0
    s_and_b32 s6, s3, 1
    s_lshr_b32 s7, s3, 1
    v_lshlrev_b32 v88, 4, v1
    s_lshl_b32 s20, s7, 12
    v_add_u32 v88, s20, v88
    v_lshlrev_b32 v90, 4, v1
    s_mov_b32 s20, 8192
    s_mul_i32 s22, s6, 8192
    s_add_u32 s20, s20, s22
    v_add_u32 v90, s20, v90
    v_mov_b32 v8, 0
    v_mov_b32 v9, 0
    v_mov_b32 v10, 0
    v_mov_b32 v11, 0
    v_mov_b32 v12, 0
    v_mov_b32 v13, 0
    v_mov_b32 v14, 0
    v_mov_b32 v15, 0
    v_mov_b32 v16, 0
    v_mov_b32 v17, 0
    v_mov_b32 v18, 0
    v_mov_b32 v19, 0
    v_mov_b32 v20, 0
    v_mov_b32 v21, 0
    v_mov_b32 v22, 0
    v_mov_b32 v23, 0
    v_mov_b32 v24, 0
    v_mov_b32 v25, 0
    v_mov_b32 v26, 0
    v_mov_b32 v27, 0
    v_mov_b32 v28, 0
    v_mov_b32 v29, 0
    v_mov_b32 v30, 0
    v_mov_b32 v31, 0
    v_mov_b32 v32, 0
    v_mov_b32 v33, 0
    v_mov_b32 v34, 0
    v_mov_b32 v35, 0
    v_mov_b32 v36, 0
    v_mov_b32 v37, 0
    v_mov_b32 v38, 0
    v_mov_b32 v39, 0
    s_mov_b32 s40, s36
    s_mov_b32 s41, s37
    s_mov_b32 s42, 131072
    s_mov_b32 s43, 0x20000
    s_add_u32 s48, s36, 27262976
    s_addc_u32 s49, s37, 0
    s_mov_b32 s50, 4194304
    s_mov_b32 s51, 0x20000
    s_add_u32 s52, s36, 2097152
    s_addc_u32 s53, s37, 0
    s_mov_b32 s54, 4194304
    s_mov_b32 s55, 0x20000
    s_lshl_b32 s56, s4, 6
    s_lshl_b32 s20, s7, 5
    s_add_u32 s56, s56, s20
    s_lshl_b32 s57, s5, 7
    s_lshl_b32 s20, s6, 6
    s_add_u32 s57, s57, s20
    v_and_b32 v2, 15, v1
    v_lshrrev_b32 v3, 4, v1
    v_lshrrev_b32 v4, 1, v3
    s_lshl_b32 s20, s6, 3
    v_or_b32 v4, s20, v4
    v_xor_b32 v4, v4, v2
    v_and_b32 v5, 1, v3
    v_lshlrev_b32 v5, 3, v5
    v_lshl_add_u32 v5, v2, 8, v5
    s_lshl_b32 s20, s7, 13
    s_add_u32 s20, s20, 98304
    v_add_u32 v5, s20, v5
    v_xor_b32 v6, 0, v4
    v_lshl_add_u32 v152, v6, 4, v5
    v_xor_b32 v6, 2, v4
    v_lshl_add_u32 v153, v6, 4, v5
    v_xor_b32 v6, 4, v4
    v_lshl_add_u32 v154, v6, 4, v5
    v_xor_b32 v6, 6, v4
    v_lshl_add_u32 v155, v6, 4, v5
    s_lshl_b32 s20, s6, 8
    s_add_u32 s20, s20, 114688
    v_lshl_add_u32 v142, v3, 4, s20
    v_and_b32 v141, 15, v1
    v_lshrrev_b32 v3, 5, v1
    v_lshl_add_u32 v141, v3, 4, v141
    v_lshlrev_b32 v141, 3, v141
    v_bfe_u32 v3, v1, 4, 1
    v_lshl_add_u32 v141, v3, 2, v141
    v_bfe_u32 v140, v1, 4, 1
    v_mul_u32_u24 v140, 32768, v140
    v_lshrrev_b32 v3, 5, v1
    v_lshl_add_u32 v140, v3, 8, v140
    v_and_b32 v3, 15, v1
    v_lshl_add_u32 v140, v3, 4, v140
    s_lshl_b32 s60, s56, 3
    s_add_u32 s60, s60, 65536
    s_lshl_b32 s62, s56, 11
    s_lshl_b32 s20, s57, 5
    s_add_u32 s62, s62, s20
    s_setprio 1
    s_mov_b32 s18, 0
    v_add_u32 v89, s18, v88
    v_add_u32 v91, s18, v90
    s_barrier
    ds_read_b128 v[40:43], v89 offset:0
    ds_read_b128 v[44:47], v89 offset:2048
    ds_read_b128 v[48:51], v91 offset:0
    ds_read_b128 v[52:55], v91 offset:2048
    ds_read_b128 v[56:59], v91 offset:4096
    ds_read_b128 v[60:63], v91 offset:6144
    s_mov_b32 s19, 16
    s_waitcnt lgkmcnt(0)
.p2align 6
adaLN_cond__mha_block__mixer_gmlp__prompt_kernel_p_c_loop:
    v_mfma_f32_16x16x32_bf16 v[8:11], v[48:51], v[40:43], v[8:11]
    ds_read_b128 v[64:67], v89 offset:1024
    ds_read_b128 v[68:71], v89 offset:3072
    v_mfma_f32_16x16x32_bf16 v[24:27], v[48:51], v[44:47], v[24:27]
    ds_read_b128 v[72:75], v91 offset:1024
    ds_read_b128 v[76:79], v91 offset:3072
    v_mfma_f32_16x16x32_bf16 v[12:15], v[52:55], v[40:43], v[12:15]
    ds_read_b128 v[80:83], v91 offset:5120
    ds_read_b128 v[84:87], v91 offset:7168
    v_mfma_f32_16x16x32_bf16 v[28:31], v[52:55], v[44:47], v[28:31]
    s_add_u32 s18, s18, 24576
    s_cmp_ge_u32 s18, 147456
    v_mfma_f32_16x16x32_bf16 v[16:19], v[56:59], v[40:43], v[16:19]
    s_cselect_b32 s18, 0, s18
    v_add_u32 v89, s18, v88
    v_mfma_f32_16x16x32_bf16 v[32:35], v[56:59], v[44:47], v[32:35]
    v_add_u32 v91, s18, v90
    v_mfma_f32_16x16x32_bf16 v[20:23], v[60:63], v[40:43], v[20:23]
    v_mfma_f32_16x16x32_bf16 v[36:39], v[60:63], v[44:47], v[36:39]
    s_waitcnt lgkmcnt(0)
    s_barrier
    v_mfma_f32_16x16x32_bf16 v[8:11], v[72:75], v[64:67], v[8:11]
    ds_read_b128 v[40:43], v89 offset:0
    ds_read_b128 v[44:47], v89 offset:2048
    v_mfma_f32_16x16x32_bf16 v[24:27], v[72:75], v[68:71], v[24:27]
    ds_read_b128 v[48:51], v91 offset:0
    ds_read_b128 v[52:55], v91 offset:2048
    v_mfma_f32_16x16x32_bf16 v[12:15], v[76:79], v[64:67], v[12:15]
    ds_read_b128 v[56:59], v91 offset:4096
    ds_read_b128 v[60:63], v91 offset:6144
    v_mfma_f32_16x16x32_bf16 v[28:31], v[76:79], v[68:71], v[28:31]
    s_sub_u32 s19, s19, 1
    s_cmp_lg_u32 s19, 0
    v_mfma_f32_16x16x32_bf16 v[16:19], v[80:83], v[64:67], v[16:19]
    v_mfma_f32_16x16x32_bf16 v[32:35], v[80:83], v[68:71], v[32:35]
    v_mfma_f32_16x16x32_bf16 v[20:23], v[84:87], v[64:67], v[20:23]
    v_mfma_f32_16x16x32_bf16 v[36:39], v[84:87], v[68:71], v[36:39]
    s_waitcnt lgkmcnt(0)
    s_cbranch_scc1 adaLN_cond__mha_block__mixer_gmlp__prompt_kernel_p_c_loop
    s_nop 7
    ds_read_b64 v[92:93], v152 offset:0
    ds_read_b64 v[94:95], v153 offset:0
    ds_read_b64 v[96:97], v154 offset:0
    ds_read_b64 v[98:99], v155 offset:0
    ds_read_b64 v[100:101], v152 offset:4096
    ds_read_b64 v[102:103], v153 offset:4096
    ds_read_b64 v[104:105], v154 offset:4096
    ds_read_b64 v[106:107], v155 offset:4096
    ds_read_b128 v[108:111], v142 offset:0
    ds_read_b128 v[124:127], v142 offset:512
    ds_read_b128 v[112:115], v142 offset:64
    ds_read_b128 v[128:131], v142 offset:576
    ds_read_b128 v[116:119], v142 offset:128
    ds_read_b128 v[132:135], v142 offset:640
    ds_read_b128 v[120:123], v142 offset:192
    ds_read_b128 v[136:139], v142 offset:704
    s_waitcnt lgkmcnt(0)
    s_barrier
    v_lshlrev_b32 v2, 16, v92
    v_and_b32 v3, 0xffff0000, v92
    v_pk_fma_f32 v[8:9], v[8:9], v[108:109], v[2:3]
    v_lshlrev_b32 v2, 16, v93
    v_and_b32 v3, 0xffff0000, v93
    v_pk_fma_f32 v[10:11], v[10:11], v[110:111], v[2:3]
    v_lshlrev_b32 v2, 16, v94
    v_and_b32 v3, 0xffff0000, v94
    v_pk_fma_f32 v[12:13], v[12:13], v[112:113], v[2:3]
    v_lshlrev_b32 v2, 16, v95
    v_and_b32 v3, 0xffff0000, v95
    v_pk_fma_f32 v[14:15], v[14:15], v[114:115], v[2:3]
    v_lshlrev_b32 v2, 16, v96
    v_and_b32 v3, 0xffff0000, v96
    v_pk_fma_f32 v[16:17], v[16:17], v[116:117], v[2:3]
    v_lshlrev_b32 v2, 16, v97
    v_and_b32 v3, 0xffff0000, v97
    v_pk_fma_f32 v[18:19], v[18:19], v[118:119], v[2:3]
    v_lshlrev_b32 v2, 16, v98
    v_and_b32 v3, 0xffff0000, v98
    v_pk_fma_f32 v[20:21], v[20:21], v[120:121], v[2:3]
    v_lshlrev_b32 v2, 16, v99
    v_and_b32 v3, 0xffff0000, v99
    v_pk_fma_f32 v[22:23], v[22:23], v[122:123], v[2:3]
    v_lshlrev_b32 v2, 16, v100
    v_and_b32 v3, 0xffff0000, v100
    v_pk_fma_f32 v[24:25], v[24:25], v[108:109], v[2:3]
    v_lshlrev_b32 v2, 16, v101
    v_and_b32 v3, 0xffff0000, v101
    v_pk_fma_f32 v[26:27], v[26:27], v[110:111], v[2:3]
    v_lshlrev_b32 v2, 16, v102
    v_and_b32 v3, 0xffff0000, v102
    v_pk_fma_f32 v[28:29], v[28:29], v[112:113], v[2:3]
    v_lshlrev_b32 v2, 16, v103
    v_and_b32 v3, 0xffff0000, v103
    v_pk_fma_f32 v[30:31], v[30:31], v[114:115], v[2:3]
    v_lshlrev_b32 v2, 16, v104
    v_and_b32 v3, 0xffff0000, v104
    v_pk_fma_f32 v[32:33], v[32:33], v[116:117], v[2:3]
    v_lshlrev_b32 v2, 16, v105
    v_and_b32 v3, 0xffff0000, v105
    v_pk_fma_f32 v[34:35], v[34:35], v[118:119], v[2:3]
    v_lshlrev_b32 v2, 16, v106
    v_and_b32 v3, 0xffff0000, v106
    v_pk_fma_f32 v[36:37], v[36:37], v[120:121], v[2:3]
    v_lshlrev_b32 v2, 16, v107
    v_and_b32 v3, 0xffff0000, v107
    v_pk_fma_f32 v[38:39], v[38:39], v[122:123], v[2:3]
    v_pk_mul_f32 v[146:147], v[8:9], v[8:9]
    v_pk_add_f32 v[144:145], v[8:9], v[10:11]
    v_pk_fma_f32 v[146:147], v[10:11], v[10:11], v[146:147]
    v_pk_add_f32 v[144:145], v[144:145], v[12:13]
    v_pk_fma_f32 v[146:147], v[12:13], v[12:13], v[146:147]
    v_pk_add_f32 v[144:145], v[144:145], v[14:15]
    v_pk_fma_f32 v[146:147], v[14:15], v[14:15], v[146:147]
    v_pk_add_f32 v[144:145], v[144:145], v[16:17]
    v_pk_fma_f32 v[146:147], v[16:17], v[16:17], v[146:147]
    v_pk_add_f32 v[144:145], v[144:145], v[18:19]
    v_pk_fma_f32 v[146:147], v[18:19], v[18:19], v[146:147]
    v_pk_add_f32 v[144:145], v[144:145], v[20:21]
    v_pk_fma_f32 v[146:147], v[20:21], v[20:21], v[146:147]
    v_pk_add_f32 v[144:145], v[144:145], v[22:23]
    v_pk_fma_f32 v[146:147], v[22:23], v[22:23], v[146:147]
    v_pk_mul_f32 v[150:151], v[24:25], v[24:25]
    v_pk_add_f32 v[148:149], v[24:25], v[26:27]
    v_pk_fma_f32 v[150:151], v[26:27], v[26:27], v[150:151]
    v_pk_add_f32 v[148:149], v[148:149], v[28:29]
    v_pk_fma_f32 v[150:151], v[28:29], v[28:29], v[150:151]
    v_pk_add_f32 v[148:149], v[148:149], v[30:31]
    v_pk_fma_f32 v[150:151], v[30:31], v[30:31], v[150:151]
    v_pk_add_f32 v[148:149], v[148:149], v[32:33]
    v_pk_fma_f32 v[150:151], v[32:33], v[32:33], v[150:151]
    v_pk_add_f32 v[148:149], v[148:149], v[34:35]
    v_pk_fma_f32 v[150:151], v[34:35], v[34:35], v[150:151]
    v_pk_add_f32 v[148:149], v[148:149], v[36:37]
    v_pk_fma_f32 v[150:151], v[36:37], v[36:37], v[150:151]
    v_pk_add_f32 v[148:149], v[148:149], v[38:39]
    v_pk_fma_f32 v[150:151], v[38:39], v[38:39], v[150:151]
    v_add_f32 v144, v144, v145
    v_add_f32 v146, v146, v147
    v_add_f32 v148, v148, v149
    v_add_f32 v150, v150, v151
    s_nop 1
    v_permlane16_swap_b32 v144, v146
    v_permlane16_swap_b32 v148, v150
    s_nop 0
    v_add_f32 v144, v144, v146
    v_add_f32 v148, v148, v150
    s_nop 1
    v_permlane32_swap_b32 v144, v148
    s_nop 0
    v_add_f32 v144, v144, v148
    buffer_atomic_add_f32 v144, v141, s[40:43], s60 offen offset:0
    v_pk_mul_f32 v[156:157], v[8:9], v[124:125]
    v_pk_mul_f32 v[158:159], v[10:11], v[126:127]
    v_pk_mul_f32 v[160:161], v[12:13], v[128:129]
    v_pk_mul_f32 v[162:163], v[14:15], v[130:131]
    v_pk_mul_f32 v[164:165], v[16:17], v[132:133]
    v_pk_mul_f32 v[166:167], v[18:19], v[134:135]
    v_pk_mul_f32 v[168:169], v[20:21], v[136:137]
    v_pk_mul_f32 v[170:171], v[22:23], v[138:139]
    v_pk_mul_f32 v[172:173], v[24:25], v[124:125]
    v_pk_mul_f32 v[174:175], v[26:27], v[126:127]
    v_pk_mul_f32 v[176:177], v[28:29], v[128:129]
    v_pk_mul_f32 v[178:179], v[30:31], v[130:131]
    v_pk_mul_f32 v[180:181], v[32:33], v[132:133]
    v_pk_mul_f32 v[182:183], v[34:35], v[134:135]
    v_pk_mul_f32 v[184:185], v[36:37], v[136:137]
    v_pk_mul_f32 v[186:187], v[38:39], v[138:139]
    v_cvt_pk_bf16_f32 v188, v156, v157
    v_cvt_pk_bf16_f32 v189, v158, v159
    v_cvt_pk_bf16_f32 v190, v172, v173
    v_cvt_pk_bf16_f32 v191, v174, v175
    v_cvt_pk_bf16_f32 v192, v160, v161
    v_cvt_pk_bf16_f32 v193, v162, v163
    v_cvt_pk_bf16_f32 v194, v176, v177
    v_cvt_pk_bf16_f32 v195, v178, v179
    v_permlane16_swap_b32 v188, v190
    v_permlane16_swap_b32 v189, v191
    buffer_store_dwordx4 v[188:191], v140, s[52:55], s62 offen offset:0 sc1
    v_cvt_pk_bf16_f32 v196, v164, v165
    v_cvt_pk_bf16_f32 v197, v166, v167
    v_cvt_pk_bf16_f32 v198, v180, v181
    v_cvt_pk_bf16_f32 v199, v182, v183
    v_permlane16_swap_b32 v192, v194
    v_permlane16_swap_b32 v193, v195
    buffer_store_dwordx4 v[192:195], v140, s[52:55], s62 offen offset:512 sc1
    v_cvt_pk_bf16_f32 v200, v168, v169
    v_cvt_pk_bf16_f32 v201, v170, v171
    v_cvt_pk_bf16_f32 v202, v184, v185
    v_cvt_pk_bf16_f32 v203, v186, v187
    v_permlane16_swap_b32 v196, v198
    v_permlane16_swap_b32 v197, v199
    buffer_store_dwordx4 v[196:199], v140, s[52:55], s62 offen offset:1024 sc1
    v_cvt_pk_bf16_f32 v204, v8, v9
    v_cvt_pk_bf16_f32 v205, v10, v11
    v_cvt_pk_bf16_f32 v206, v24, v25
    v_cvt_pk_bf16_f32 v207, v26, v27
    v_permlane16_swap_b32 v200, v202
    v_permlane16_swap_b32 v201, v203
    buffer_store_dwordx4 v[200:203], v140, s[52:55], s62 offen offset:1536 sc1
    v_cvt_pk_bf16_f32 v208, v12, v13
    v_cvt_pk_bf16_f32 v209, v14, v15
    v_cvt_pk_bf16_f32 v210, v28, v29
    v_cvt_pk_bf16_f32 v211, v30, v31
    v_permlane16_swap_b32 v204, v206
    v_permlane16_swap_b32 v205, v207
    buffer_store_dwordx4 v[204:207], v140, s[48:51], s62 offen offset:0 sc1
    v_cvt_pk_bf16_f32 v212, v16, v17
    v_cvt_pk_bf16_f32 v213, v18, v19
    v_cvt_pk_bf16_f32 v214, v32, v33
    v_cvt_pk_bf16_f32 v215, v34, v35
    v_permlane16_swap_b32 v208, v210
    v_permlane16_swap_b32 v209, v211
    buffer_store_dwordx4 v[208:211], v140, s[48:51], s62 offen offset:512 sc1
    v_cvt_pk_bf16_f32 v216, v20, v21
    v_cvt_pk_bf16_f32 v217, v22, v23
    v_cvt_pk_bf16_f32 v218, v36, v37
    v_cvt_pk_bf16_f32 v219, v38, v39
    v_permlane16_swap_b32 v212, v214
    v_permlane16_swap_b32 v213, v215
    buffer_store_dwordx4 v[212:215], v140, s[48:51], s62 offen offset:1024 sc1
    s_nop 1
    v_permlane16_swap_b32 v216, v218
    v_permlane16_swap_b32 v217, v219
    buffer_store_dwordx4 v[216:219], v140, s[48:51], s62 offen offset:1536 sc1
    s_and_b32 s21, s4, 1
    s_lshl_b32 s21, s21, 3
    s_add_u32 s21, s21, s5
    s_lshr_b32 s22, s4, 1
    s_add_u32 s20, s22, 48
    s_mul_i32 s20, s20, 4352
    s_lshl_b32 s21, s21, 7
    s_add_u32 s20, s20, s21
    v_mov_b32 v2, s101
    v_mov_b32 v3, 0
    s_cmp_eq_u32 s3, 0
    s_waitcnt vmcnt(0)
    s_barrier
    s_cbranch_scc0 sig_3
    s_mov_b64 exec, 1
    buffer_store_dword v2, v3, s[96:99], s20 offen sc1
    s_mov_b64 exec, -1
sig_3:
    s_and_b32 s20, s2, 7
    s_lshr_b32 s21, s2, 3
    s_and_b32 s4, s20, 1
    s_lshl_b32 s4, s4, 3
    s_and_b32 s22, s21, 7
    s_add_u32 s4, s4, s22
    s_lshr_b32 s5, s20, 1
    s_mul_i32 s5, s5, 4
    s_lshr_b32 s22, s21, 3
    s_add_u32 s5, s5, s22
    s_cmp_eq_u32 s3, 0
    s_cbranch_scc0 adaLN_cond__mha_block__mixer_gmlp__prompt_kernel_w_np
    s_add_u32 s20, s4, 48
    s_mul_i32 s20, s20, 4352
    v_and_b32 v2, 63, v0
    v_lshlrev_b32 v2, 7, v2
    s_bfm_b64 exec, 16, 0
    s_mov_b32 s19, 0x80000
adaLN_cond__mha_block__mixer_gmlp__prompt_kernel_w_dp:
    buffer_load_dword v240, v2, s[96:99], s20 offen sc1
    s_waitcnt vmcnt(0)
    v_cmp_ne_u32 vcc, s101, v240
    s_sub_u32 s19, s19, 1
    s_cmp_eq_u32 s19, 0
    s_cbranch_scc1 adaLN_cond__mha_block__mixer_gmlp__prompt_kernel_w_dp_d
    s_cbranch_vccz adaLN_cond__mha_block__mixer_gmlp__prompt_kernel_w_dp_d
    s_sleep 4
    s_branch adaLN_cond__mha_block__mixer_gmlp__prompt_kernel_w_dp
adaLN_cond__mha_block__mixer_gmlp__prompt_kernel_w_dp_d:
    s_mov_b64 exec, -1
adaLN_cond__mha_block__mixer_gmlp__prompt_kernel_w_np:
    s_barrier
    v_and_b32 v1, 63, v0
    s_and_b32 s6, s3, 1
    s_lshr_b32 s7, s3, 1
    v_lshlrev_b32 v208, 4, v1
    s_lshl_b32 s20, s6, 13
    v_add_u32 v208, s20, v208
    v_lshlrev_b32 v210, 4, v1
    s_mov_b32 s20, 16384
    s_mul_i32 s22, s7, 14336
    s_add_u32 s20, s20, s22
    v_add_u32 v210, s20, v210
    v_mov_b32 v8, 0
    v_mov_b32 v9, 0
    v_mov_b32 v10, 0
    v_mov_b32 v11, 0
    v_mov_b32 v12, 0
    v_mov_b32 v13, 0
    v_mov_b32 v14, 0
    v_mov_b32 v15, 0
    v_mov_b32 v16, 0
    v_mov_b32 v17, 0
    v_mov_b32 v18, 0
    v_mov_b32 v19, 0
    v_mov_b32 v20, 0
    v_mov_b32 v21, 0
    v_mov_b32 v22, 0
    v_mov_b32 v23, 0
    v_mov_b32 v24, 0
    v_mov_b32 v25, 0
    v_mov_b32 v26, 0
    v_mov_b32 v27, 0
    v_mov_b32 v28, 0
    v_mov_b32 v29, 0
    v_mov_b32 v30, 0
    v_mov_b32 v31, 0
    v_mov_b32 v32, 0
    v_mov_b32 v33, 0
    v_mov_b32 v34, 0
    v_mov_b32 v35, 0
    v_mov_b32 v36, 0
    v_mov_b32 v37, 0
    v_mov_b32 v38, 0
    v_mov_b32 v39, 0
    v_mov_b32 v40, 0
    v_mov_b32 v41, 0
    v_mov_b32 v42, 0
    v_mov_b32 v43, 0
    v_mov_b32 v44, 0
    v_mov_b32 v45, 0
    v_mov_b32 v46, 0
    v_mov_b32 v47, 0
    v_mov_b32 v48, 0
    v_mov_b32 v49, 0
    v_mov_b32 v50, 0
    v_mov_b32 v51, 0
    v_mov_b32 v52, 0
    v_mov_b32 v53, 0
    v_mov_b32 v54, 0
    v_mov_b32 v55, 0
    v_mov_b32 v56, 0
    v_mov_b32 v57, 0
    v_mov_b32 v58, 0
    v_mov_b32 v59, 0
    v_mov_b32 v60, 0
    v_mov_b32 v61, 0
    v_mov_b32 v62, 0
    v_mov_b32 v63, 0
    v_mov_b32 v64, 0
    v_mov_b32 v65, 0
    v_mov_b32 v66, 0
    v_mov_b32 v67, 0
    v_mov_b32 v68, 0
    v_mov_b32 v69, 0
    v_mov_b32 v70, 0
    v_mov_b32 v71, 0
    v_mov_b32 v72, 0
    v_mov_b32 v73, 0
    v_mov_b32 v74, 0
    v_mov_b32 v75, 0
    v_mov_b32 v76, 0
    v_mov_b32 v77, 0
    v_mov_b32 v78, 0
    v_mov_b32 v79, 0
    v_mov_b32 v80, 0
    v_mov_b32 v81, 0
    v_mov_b32 v82, 0
    v_mov_b32 v83, 0
    v_mov_b32 v84, 0
    v_mov_b32 v85, 0
    v_mov_b32 v86, 0
    v_mov_b32 v87, 0
    v_mov_b32 v88, 0
    v_mov_b32 v89, 0
    v_mov_b32 v90, 0
    v_mov_b32 v91, 0
    v_mov_b32 v92, 0
    v_mov_b32 v93, 0
    v_mov_b32 v94, 0
    v_mov_b32 v95, 0
    v_mov_b32 v96, 0
    v_mov_b32 v97, 0
    v_mov_b32 v98, 0
    v_mov_b32 v99, 0
    v_mov_b32 v100, 0
    v_mov_b32 v101, 0
    v_mov_b32 v102, 0
    v_mov_b32 v103, 0
    v_mov_b32 v104, 0
    v_mov_b32 v105, 0
    v_mov_b32 v106, 0
    v_mov_b32 v107, 0
    v_mov_b32 v108, 0
    v_mov_b32 v109, 0
    v_mov_b32 v110, 0
    v_mov_b32 v111, 0
    v_mov_b32 v112, 0
    v_mov_b32 v113, 0
    v_mov_b32 v114, 0
    v_mov_b32 v115, 0
    v_mov_b32 v116, 0
    v_mov_b32 v117, 0
    v_mov_b32 v118, 0
    v_mov_b32 v119, 0
    s_add_u32 s24, s36, 46137344
    s_addc_u32 s25, s37, 0
    s_mov_b32 s26, 7340032
    s_mov_b32 s27, 0x20000
    s_add_u32 s40, s36, 10485760
    s_addc_u32 s41, s37, 0
    s_mov_b32 s42, 7340032
    s_mov_b32 s43, 0x20000
    s_add_u32 s44, s36, 114688
    s_addc_u32 s45, s37, 0
    s_mov_b32 s46, 32768
    s_mov_b32 s47, 0x20000
    v_bfe_u32 v212, v1, 4, 1
    v_mul_u32_u24 v212, 57344, v212
    v_lshrrev_b32 v3, 5, v1
    v_lshl_add_u32 v212, v3, 8, v212
    v_and_b32 v3, 15, v1
    v_lshl_add_u32 v212, v3, 4, v212
    v_and_b32 v213, 19, v1
    v_bfe_u32 v3, v1, 2, 1
    v_lshl_or_b32 v213, v3, 3, v213
    v_bfe_u32 v3, v1, 3, 1
    v_lshl_or_b32 v213, v3, 2, v213
    v_lshlrev_b32 v213, 5, v213
    v_lshrrev_b32 v3, 5, v1
    v_lshl_add_u32 v213, v3, 4, v213
    v_and_b32 v2, 15, v1
    v_lshrrev_b32 v3, 4, v1
    v_lshlrev_b32 v218, 4, v2
    v_lshl_add_u32 v214, v3, 2, v218
    v_xor_b32 v215, 8, v214
    v_and_b32 v4, 1, v3
    v_xor_b32 v4, 1, v4
    v_cvt_f32_u32 v219, v4
    s_mul_i32 s20, s7, 448
    s_add_u32 s20, s20, 135168
    v_lshl_add_u32 v216, v3, 4, s20
    s_lshl_b32 s20, s6, 9
    s_add_u32 s20, s20, 137216
    v_lshl_add_u32 v217, v2, 3, s20
    s_lshl_b32 s56, s4, 7
    s_lshl_b32 s20, s6, 6
    s_add_u32 s56, s56, s20
    s_lshl_b32 s60, s56, 4
    s_lshr_b32 s21, s56, 4
    s_mul_i32 s21, s21, 224
    s_mul_i32 s20, s5, 14
    s_add_u32 s21, s21, s20
    s_lshl_b32 s68, s21, 8
    s_add_u32 s69, s68, 114688
    s_mul_i32 s20, s5, 458752
    s_lshl_b32 s22, s56, 5
    s_add_u32 s70, s20, s22
    s_mov_b32 s64, 0xbdd2d3e8
    s_mov_b32 s65, s64
    s_setprio 1
    s_mov_b32 s18, 0
    v_add_u32 v209, s18, v208
    v_add_u32 v211, s18, v210
    s_barrier
    ds_read_b128 v[120:123], v209 offset:0
    ds_read_b128 v[124:127], v209 offset:2048
    ds_read_b128 v[128:131], v209 offset:4096
    ds_read_b128 v[132:135], v209 offset:6144
    ds_read_b128 v[136:139], v211 offset:0
    ds_read_b128 v[140:143], v211 offset:2048
    ds_read_b128 v[144:147], v211 offset:4096
    ds_read_b128 v[148:151], v211 offset:6144
    ds_read_b128 v[152:155], v211 offset:8192
    ds_read_b128 v[156:159], v211 offset:10240
    ds_read_b128 v[160:163], v211 offset:12288
    s_mov_b32 s19, 16
    s_waitcnt lgkmcnt(0)
.p2align 6
adaLN_cond__mha_block__mixer_gmlp__prompt_kernel_w_c_loop:
    v_mfma_f32_16x16x32_bf16 v[8:11], v[136:139], v[120:123], v[8:11]
    ds_read_b128 v[164:167], v209 offset:1024
    v_mfma_f32_16x16x32_bf16 v[36:39], v[136:139], v[124:127], v[36:39]
    ds_read_b128 v[168:171], v209 offset:3072
    v_mfma_f32_16x16x32_bf16 v[64:67], v[136:139], v[128:131], v[64:67]
    ds_read_b128 v[172:175], v209 offset:5120
    v_mfma_f32_16x16x32_bf16 v[92:95], v[136:139], v[132:135], v[92:95]
    ds_read_b128 v[176:179], v209 offset:7168
    v_mfma_f32_16x16x32_bf16 v[12:15], v[140:143], v[120:123], v[12:15]
    ds_read_b128 v[180:183], v211 offset:1024
    v_mfma_f32_16x16x32_bf16 v[40:43], v[140:143], v[124:127], v[40:43]
    ds_read_b128 v[184:187], v211 offset:3072
    v_mfma_f32_16x16x32_bf16 v[68:71], v[140:143], v[128:131], v[68:71]
    ds_read_b128 v[188:191], v211 offset:5120
    v_mfma_f32_16x16x32_bf16 v[96:99], v[140:143], v[132:135], v[96:99]
    ds_read_b128 v[192:195], v211 offset:7168
    v_mfma_f32_16x16x32_bf16 v[16:19], v[144:147], v[120:123], v[16:19]
    ds_read_b128 v[196:199], v211 offset:9216
    v_mfma_f32_16x16x32_bf16 v[44:47], v[144:147], v[124:127], v[44:47]
    ds_read_b128 v[200:203], v211 offset:11264
    v_mfma_f32_16x16x32_bf16 v[72:75], v[144:147], v[128:131], v[72:75]
    ds_read_b128 v[204:207], v211 offset:13312
    v_mfma_f32_16x16x32_bf16 v[100:103], v[144:147], v[132:135], v[100:103]
    s_add_u32 s18, s18, 45056
    v_mfma_f32_16x16x32_bf16 v[20:23], v[148:151], v[120:123], v[20:23]
    s_cmp_ge_u32 s18, 135168
    v_mfma_f32_16x16x32_bf16 v[48:51], v[148:151], v[124:127], v[48:51]
    s_cselect_b32 s18, 0, s18
    v_mfma_f32_16x16x32_bf16 v[76:79], v[148:151], v[128:131], v[76:79]
    v_add_u32 v209, s18, v208
    v_mfma_f32_16x16x32_bf16 v[104:107], v[148:151], v[132:135], v[104:107]
    v_add_u32 v211, s18, v210
    v_mfma_f32_16x16x32_bf16 v[24:27], v[152:155], v[120:123], v[24:27]
    v_mfma_f32_16x16x32_bf16 v[52:55], v[152:155], v[124:127], v[52:55]
    v_mfma_f32_16x16x32_bf16 v[80:83], v[152:155], v[128:131], v[80:83]
    v_mfma_f32_16x16x32_bf16 v[108:111], v[152:155], v[132:135], v[108:111]
    v_mfma_f32_16x16x32_bf16 v[28:31], v[156:159], v[120:123], v[28:31]
    v_mfma_f32_16x16x32_bf16 v[56:59], v[156:159], v[124:127], v[56:59]
    v_mfma_f32_16x16x32_bf16 v[84:87], v[156:159], v[128:131], v[84:87]
    v_mfma_f32_16x16x32_bf16 v[112:115], v[156:159], v[132:135], v[112:115]
    v_mfma_f32_16x16x32_bf16 v[32:35], v[160:163], v[120:123], v[32:35]
    v_mfma_f32_16x16x32_bf16 v[60:63], v[160:163], v[124:127], v[60:63]
    v_mfma_f32_16x16x32_bf16 v[88:91], v[160:163], v[128:131], v[88:91]
    v_mfma_f32_16x16x32_bf16 v[116:119], v[160:163], v[132:135], v[116:119]
    s_waitcnt lgkmcnt(0)
    s_barrier
    v_mfma_f32_16x16x32_bf16 v[8:11], v[180:183], v[164:167], v[8:11]
    ds_read_b128 v[120:123], v209 offset:0
    v_mfma_f32_16x16x32_bf16 v[36:39], v[180:183], v[168:171], v[36:39]
    ds_read_b128 v[124:127], v209 offset:2048
    v_mfma_f32_16x16x32_bf16 v[64:67], v[180:183], v[172:175], v[64:67]
    ds_read_b128 v[128:131], v209 offset:4096
    v_mfma_f32_16x16x32_bf16 v[92:95], v[180:183], v[176:179], v[92:95]
    ds_read_b128 v[132:135], v209 offset:6144
    v_mfma_f32_16x16x32_bf16 v[12:15], v[184:187], v[164:167], v[12:15]
    ds_read_b128 v[136:139], v211 offset:0
    v_mfma_f32_16x16x32_bf16 v[40:43], v[184:187], v[168:171], v[40:43]
    ds_read_b128 v[140:143], v211 offset:2048
    v_mfma_f32_16x16x32_bf16 v[68:71], v[184:187], v[172:175], v[68:71]
    ds_read_b128 v[144:147], v211 offset:4096
    v_mfma_f32_16x16x32_bf16 v[96:99], v[184:187], v[176:179], v[96:99]
    ds_read_b128 v[148:151], v211 offset:6144
    v_mfma_f32_16x16x32_bf16 v[16:19], v[188:191], v[164:167], v[16:19]
    ds_read_b128 v[152:155], v211 offset:8192
    v_mfma_f32_16x16x32_bf16 v[44:47], v[188:191], v[168:171], v[44:47]
    ds_read_b128 v[156:159], v211 offset:10240
    v_mfma_f32_16x16x32_bf16 v[72:75], v[188:191], v[172:175], v[72:75]
    ds_read_b128 v[160:163], v211 offset:12288
    v_mfma_f32_16x16x32_bf16 v[100:103], v[188:191], v[176:179], v[100:103]
    s_sub_u32 s19, s19, 1
    v_mfma_f32_16x16x32_bf16 v[20:23], v[192:195], v[164:167], v[20:23]
    s_cmp_lg_u32 s19, 0
    v_mfma_f32_16x16x32_bf16 v[48:51], v[192:195], v[168:171], v[48:51]
    v_mfma_f32_16x16x32_bf16 v[76:79], v[192:195], v[172:175], v[76:79]
    v_mfma_f32_16x16x32_bf16 v[104:107], v[192:195], v[176:179], v[104:107]
    v_mfma_f32_16x16x32_bf16 v[24:27], v[196:199], v[164:167], v[24:27]
    v_mfma_f32_16x16x32_bf16 v[52:55], v[196:199], v[168:171], v[52:55]
    v_mfma_f32_16x16x32_bf16 v[80:83], v[196:199], v[172:175], v[80:83]
    v_mfma_f32_16x16x32_bf16 v[108:111], v[196:199], v[176:179], v[108:111]
    v_mfma_f32_16x16x32_bf16 v[28:31], v[200:203], v[164:167], v[28:31]
    v_mfma_f32_16x16x32_bf16 v[56:59], v[200:203], v[168:171], v[56:59]
    v_mfma_f32_16x16x32_bf16 v[84:87], v[200:203], v[172:175], v[84:87]
    v_mfma_f32_16x16x32_bf16 v[112:115], v[200:203], v[176:179], v[112:115]
    v_mfma_f32_16x16x32_bf16 v[32:35], v[204:207], v[164:167], v[32:35]
    v_mfma_f32_16x16x32_bf16 v[60:63], v[204:207], v[168:171], v[60:63]
    v_mfma_f32_16x16x32_bf16 v[88:91], v[204:207], v[172:175], v[88:91]
    v_mfma_f32_16x16x32_bf16 v[116:119], v[204:207], v[176:179], v[116:119]
    s_waitcnt lgkmcnt(0)
    s_cbranch_scc1 adaLN_cond__mha_block__mixer_gmlp__prompt_kernel_w_c_loop
    s_nop 7
    ds_read_b64 v[192:193], v217 offset:0
    ds_read_b64 v[194:195], v217 offset:128
    ds_read_b64 v[196:197], v217 offset:256
    ds_read_b64 v[198:199], v217 offset:384
    ds_read_b128 v[136:139], v216 offset:0
    ds_read_b128 v[164:167], v216 offset:896
    ds_read_b128 v[140:143], v216 offset:64
    ds_read_b128 v[168:171], v216 offset:960
    ds_read_b128 v[144:147], v216 offset:128
    ds_read_b128 v[172:175], v216 offset:1024
    ds_read_b128 v[148:151], v216 offset:192
    ds_read_b128 v[176:179], v216 offset:1088
    ds_read_b128 v[152:155], v216 offset:256
    ds_read_b128 v[180:183], v216 offset:1152
    ds_read_b128 v[156:159], v216 offset:320
    ds_read_b128 v[184:187], v216 offset:1216
    ds_read_b128 v[160:163], v216 offset:384
    ds_read_b128 v[188:191], v216 offset:1280
    v_mov_b32 v128, 0xc0135761
    v_mov_b32 v129, 0xc0135761
    s_waitcnt lgkmcnt(0)
    s_cmp_eq_u32 s7, 0
    s_cbranch_scc0 adaLN_cond__mha_block__mixer_gmlp__prompt_kernel_w_e1
    v_pk_fma_f32 v[130:131], v[136:137], v[192:193], v[164:165] op_sel:[0,1,0] op_sel_hi:[1,1,1]
    v_pk_fma_f32 v[132:133], v[138:139], v[192:193], v[166:167] op_sel:[0,1,0] op_sel_hi:[1,1,1]
    v_pk_fma_f32 v[8:9], v[8:9], v[192:193], v[130:131] op_sel:[0,0,0] op_sel_hi:[1,0,1]
    v_pk_fma_f32 v[10:11], v[10:11], v[192:193], v[132:133] op_sel:[0,0,0] op_sel_hi:[1,0,1]
    v_pk_fma_f32 v[130:131], v[136:137], v[194:195], v[164:165] op_sel:[0,1,0] op_sel_hi:[1,1,1]
    v_pk_fma_f32 v[132:133], v[138:139], v[194:195], v[166:167] op_sel:[0,1,0] op_sel_hi:[1,1,1]
    v_pk_fma_f32 v[36:37], v[36:37], v[194:195], v[130:131] op_sel:[0,0,0] op_sel_hi:[1,0,1]
    v_pk_fma_f32 v[38:39], v[38:39], v[194:195], v[132:133] op_sel:[0,0,0] op_sel_hi:[1,0,1]
    v_pk_fma_f32 v[130:131], v[136:137], v[196:197], v[164:165] op_sel:[0,1,0] op_sel_hi:[1,1,1]
    v_pk_fma_f32 v[132:133], v[138:139], v[196:197], v[166:167] op_sel:[0,1,0] op_sel_hi:[1,1,1]
    v_pk_fma_f32 v[64:65], v[64:65], v[196:197], v[130:131] op_sel:[0,0,0] op_sel_hi:[1,0,1]
    v_pk_fma_f32 v[66:67], v[66:67], v[196:197], v[132:133] op_sel:[0,0,0] op_sel_hi:[1,0,1]
    v_pk_fma_f32 v[130:131], v[136:137], v[198:199], v[164:165] op_sel:[0,1,0] op_sel_hi:[1,1,1]
    v_pk_fma_f32 v[132:133], v[138:139], v[198:199], v[166:167] op_sel:[0,1,0] op_sel_hi:[1,1,1]
    v_pk_fma_f32 v[92:93], v[92:93], v[198:199], v[130:131] op_sel:[0,0,0] op_sel_hi:[1,0,1]
    v_pk_fma_f32 v[94:95], v[94:95], v[198:199], v[132:133] op_sel:[0,0,0] op_sel_hi:[1,0,1]
    v_pk_mul_f32 v[120:121], v[8:9], v[8:9]
    v_pk_mul_f32 v[122:123], v[10:11], v[10:11]
    v_pk_mul_f32 v[124:125], v[36:37], v[36:37]
    v_pk_mul_f32 v[126:127], v[38:39], v[38:39]
    v_pk_fma_f32 v[120:121], v[120:121], s[64:65], v[128:129]
    v_pk_fma_f32 v[122:123], v[122:123], s[64:65], v[128:129]
    v_pk_fma_f32 v[124:125], v[124:125], s[64:65], v[128:129]
    v_pk_fma_f32 v[126:127], v[126:127], s[64:65], v[128:129]
    v_pk_mul_f32 v[120:121], v[120:121], v[8:9]
    v_pk_mul_f32 v[122:123], v[122:123], v[10:11]
    v_pk_mul_f32 v[124:125], v[124:125], v[36:37]
    v_pk_mul_f32 v[126:127], v[126:127], v[38:39]
    v_exp_f32 v120, v120
    v_exp_f32 v121, v121
    v_exp_f32 v122, v122
    v_exp_f32 v123, v123
    v_exp_f32 v124, v124
    v_exp_f32 v125, v125
    v_exp_f32 v126, v126
    v_exp_f32 v127, v127
    v_pk_add_f32 v[120:121], v[120:121], 1.0 op_sel_hi:[1,0]
    v_pk_add_f32 v[122:123], v[122:123], 1.0 op_sel_hi:[1,0]
    v_pk_add_f32 v[124:125], v[124:125], 1.0 op_sel_hi:[1,0]
    v_pk_add_f32 v[126:127], v[126:127], 1.0 op_sel_hi:[1,0]
    v_rcp_f32 v120, v120
    v_rcp_f32 v121, v121
    v_rcp_f32 v122, v122
    v_rcp_f32 v123, v123
    v_rcp_f32 v124, v124
    v_rcp_f32 v125, v125
    v_rcp_f32 v126, v126
    v_rcp_f32 v127, v127
    v_pk_mul_f32 v[8:9], v[8:9], v[120:121]
    v_pk_mul_f32 v[10:11], v[10:11], v[122:123]
    v_pk_mul_f32 v[36:37], v[36:37], v[124:125]
    v_pk_mul_f32 v[38:39], v[38:39], v[126:127]
    v_pk_mul_f32 v[120:121], v[64:65], v[64:65]
    v_pk_mul_f32 v[122:123], v[66:67], v[66:67]
    v_pk_mul_f32 v[124:125], v[92:93], v[92:93]
    v_pk_mul_f32 v[126:127], v[94:95], v[94:95]
    v_pk_fma_f32 v[120:121], v[120:121], s[64:65], v[128:129]
    v_pk_fma_f32 v[122:123], v[122:123], s[64:65], v[128:129]
    v_pk_fma_f32 v[124:125], v[124:125], s[64:65], v[128:129]
    v_pk_fma_f32 v[126:127], v[126:127], s[64:65], v[128:129]
    v_pk_mul_f32 v[120:121], v[120:121], v[64:65]
    v_pk_mul_f32 v[122:123], v[122:123], v[66:67]
    v_pk_mul_f32 v[124:125], v[124:125], v[92:93]
    v_pk_mul_f32 v[126:127], v[126:127], v[94:95]
    v_exp_f32 v120, v120
    v_exp_f32 v121, v121
    v_exp_f32 v122, v122
    v_exp_f32 v123, v123
    v_exp_f32 v124, v124
    v_exp_f32 v125, v125
    v_exp_f32 v126, v126
    v_exp_f32 v127, v127
    v_pk_add_f32 v[120:121], v[120:121], 1.0 op_sel_hi:[1,0]
    v_pk_add_f32 v[122:123], v[122:123], 1.0 op_sel_hi:[1,0]
    v_pk_add_f32 v[124:125], v[124:125], 1.0 op_sel_hi:[1,0]
    v_pk_add_f32 v[126:127], v[126:127], 1.0 op_sel_hi:[1,0]
    v_rcp_f32 v120, v120
    v_rcp_f32 v121, v121
    v_rcp_f32 v122, v122
    v_rcp_f32 v123, v123
    v_rcp_f32 v124, v124
    v_rcp_f32 v125, v125
    v_rcp_f32 v126, v126
    v_rcp_f32 v127, v127
    v_pk_mul_f32 v[64:65], v[64:65], v[120:121]
    v_pk_mul_f32 v[66:67], v[66:67], v[122:123]
    v_pk_mul_f32 v[92:93], v[92:93], v[124:125]
    v_pk_mul_f32 v[94:95], v[94:95], v[126:127]
    v_pk_add_f32 v[220:221], v[8:9], v[10:11]
    v_pk_mul_f32 v[222:223], v[8:9], v[8:9]
    v_pk_fma_f32 v[222:223], v[10:11], v[10:11], v[222:223]
    v_pk_add_f32 v[224:225], v[36:37], v[38:39]
    v_pk_mul_f32 v[226:227], v[36:37], v[36:37]
    v_pk_fma_f32 v[226:227], v[38:39], v[38:39], v[226:227]
    v_pk_add_f32 v[228:229], v[64:65], v[66:67]
    v_pk_mul_f32 v[230:231], v[64:65], v[64:65]
    v_pk_fma_f32 v[230:231], v[66:67], v[66:67], v[230:231]
    v_pk_add_f32 v[232:233], v[92:93], v[94:95]
    v_pk_mul_f32 v[234:235], v[92:93], v[92:93]
    v_pk_fma_f32 v[234:235], v[94:95], v[94:95], v[234:235]
    v_pk_fma_f32 v[130:131], v[140:141], v[192:193], v[168:169] op_sel:[0,1,0] op_sel_hi:[1,1,1]
    v_pk_fma_f32 v[132:133], v[142:143], v[192:193], v[170:171] op_sel:[0,1,0] op_sel_hi:[1,1,1]
    v_pk_fma_f32 v[12:13], v[12:13], v[192:193], v[130:131] op_sel:[0,0,0] op_sel_hi:[1,0,1]
    v_pk_fma_f32 v[14:15], v[14:15], v[192:193], v[132:133] op_sel:[0,0,0] op_sel_hi:[1,0,1]
    v_pk_fma_f32 v[130:131], v[140:141], v[194:195], v[168:169] op_sel:[0,1,0] op_sel_hi:[1,1,1]
    v_pk_fma_f32 v[132:133], v[142:143], v[194:195], v[170:171] op_sel:[0,1,0] op_sel_hi:[1,1,1]
    v_pk_fma_f32 v[40:41], v[40:41], v[194:195], v[130:131] op_sel:[0,0,0] op_sel_hi:[1,0,1]
    v_pk_fma_f32 v[42:43], v[42:43], v[194:195], v[132:133] op_sel:[0,0,0] op_sel_hi:[1,0,1]
    v_pk_fma_f32 v[130:131], v[140:141], v[196:197], v[168:169] op_sel:[0,1,0] op_sel_hi:[1,1,1]
    v_pk_fma_f32 v[132:133], v[142:143], v[196:197], v[170:171] op_sel:[0,1,0] op_sel_hi:[1,1,1]
    v_pk_fma_f32 v[68:69], v[68:69], v[196:197], v[130:131] op_sel:[0,0,0] op_sel_hi:[1,0,1]
    v_pk_fma_f32 v[70:71], v[70:71], v[196:197], v[132:133] op_sel:[0,0,0] op_sel_hi:[1,0,1]
    v_pk_fma_f32 v[130:131], v[140:141], v[198:199], v[168:169] op_sel:[0,1,0] op_sel_hi:[1,1,1]
    v_pk_fma_f32 v[132:133], v[142:143], v[198:199], v[170:171] op_sel:[0,1,0] op_sel_hi:[1,1,1]
    v_pk_fma_f32 v[96:97], v[96:97], v[198:199], v[130:131] op_sel:[0,0,0] op_sel_hi:[1,0,1]
    v_pk_fma_f32 v[98:99], v[98:99], v[198:199], v[132:133] op_sel:[0,0,0] op_sel_hi:[1,0,1]
    v_pk_mul_f32 v[120:121], v[12:13], v[12:13]
    v_pk_mul_f32 v[122:123], v[14:15], v[14:15]
    v_pk_mul_f32 v[124:125], v[40:41], v[40:41]
    v_pk_mul_f32 v[126:127], v[42:43], v[42:43]
    v_pk_fma_f32 v[120:121], v[120:121], s[64:65], v[128:129]
    v_pk_fma_f32 v[122:123], v[122:123], s[64:65], v[128:129]
    v_pk_fma_f32 v[124:125], v[124:125], s[64:65], v[128:129]
    v_pk_fma_f32 v[126:127], v[126:127], s[64:65], v[128:129]
    v_pk_mul_f32 v[120:121], v[120:121], v[12:13]
    v_pk_mul_f32 v[122:123], v[122:123], v[14:15]
    v_pk_mul_f32 v[124:125], v[124:125], v[40:41]
    v_pk_mul_f32 v[126:127], v[126:127], v[42:43]
    v_exp_f32 v120, v120
    v_exp_f32 v121, v121
    v_exp_f32 v122, v122
    v_exp_f32 v123, v123
    v_exp_f32 v124, v124
    v_exp_f32 v125, v125
    v_exp_f32 v126, v126
    v_exp_f32 v127, v127
    v_pk_add_f32 v[120:121], v[120:121], 1.0 op_sel_hi:[1,0]
    v_pk_add_f32 v[122:123], v[122:123], 1.0 op_sel_hi:[1,0]
    v_pk_add_f32 v[124:125], v[124:125], 1.0 op_sel_hi:[1,0]
    v_pk_add_f32 v[126:127], v[126:127], 1.0 op_sel_hi:[1,0]
    v_rcp_f32 v120, v120
    v_rcp_f32 v121, v121
    v_rcp_f32 v122, v122
    v_rcp_f32 v123, v123
    v_rcp_f32 v124, v124
    v_rcp_f32 v125, v125
    v_rcp_f32 v126, v126
    v_rcp_f32 v127, v127
    v_pk_mul_f32 v[12:13], v[12:13], v[120:121]
    v_pk_mul_f32 v[14:15], v[14:15], v[122:123]
    v_pk_mul_f32 v[40:41], v[40:41], v[124:125]
    v_pk_mul_f32 v[42:43], v[42:43], v[126:127]
    v_pk_mul_f32 v[120:121], v[68:69], v[68:69]
    v_pk_mul_f32 v[122:123], v[70:71], v[70:71]
    v_pk_mul_f32 v[124:125], v[96:97], v[96:97]
    v_pk_mul_f32 v[126:127], v[98:99], v[98:99]
    v_pk_fma_f32 v[120:121], v[120:121], s[64:65], v[128:129]
    v_pk_fma_f32 v[122:123], v[122:123], s[64:65], v[128:129]
    v_pk_fma_f32 v[124:125], v[124:125], s[64:65], v[128:129]
    v_pk_fma_f32 v[126:127], v[126:127], s[64:65], v[128:129]
    v_pk_mul_f32 v[120:121], v[120:121], v[68:69]
    v_pk_mul_f32 v[122:123], v[122:123], v[70:71]
    v_pk_mul_f32 v[124:125], v[124:125], v[96:97]
    v_pk_mul_f32 v[126:127], v[126:127], v[98:99]
    v_exp_f32 v120, v120
    v_exp_f32 v121, v121
    v_exp_f32 v122, v122
    v_exp_f32 v123, v123
    v_exp_f32 v124, v124
    v_exp_f32 v125, v125
    v_exp_f32 v126, v126
    v_exp_f32 v127, v127
    v_pk_add_f32 v[120:121], v[120:121], 1.0 op_sel_hi:[1,0]
    v_pk_add_f32 v[122:123], v[122:123], 1.0 op_sel_hi:[1,0]
    v_pk_add_f32 v[124:125], v[124:125], 1.0 op_sel_hi:[1,0]
    v_pk_add_f32 v[126:127], v[126:127], 1.0 op_sel_hi:[1,0]
    v_rcp_f32 v120, v120
    v_rcp_f32 v121, v121
    v_rcp_f32 v122, v122
    v_rcp_f32 v123, v123
    v_rcp_f32 v124, v124
    v_rcp_f32 v125, v125
    v_rcp_f32 v126, v126
    v_rcp_f32 v127, v127
    v_pk_mul_f32 v[68:69], v[68:69], v[120:121]
    v_pk_mul_f32 v[70:71], v[70:71], v[122:123]
    v_pk_mul_f32 v[96:97], v[96:97], v[124:125]
    v_pk_mul_f32 v[98:99], v[98:99], v[126:127]
    v_pk_add_f32 v[220:221], v[220:221], v[12:13]
    v_pk_fma_f32 v[222:223], v[12:13], v[12:13], v[222:223]
    v_pk_add_f32 v[220:221], v[220:221], v[14:15]
    v_pk_fma_f32 v[222:223], v[14:15], v[14:15], v[222:223]
    v_pk_add_f32 v[224:225], v[224:225], v[40:41]
    v_pk_fma_f32 v[226:227], v[40:41], v[40:41], v[226:227]
    v_pk_add_f32 v[224:225], v[224:225], v[42:43]
    v_pk_fma_f32 v[226:227], v[42:43], v[42:43], v[226:227]
    v_pk_add_f32 v[228:229], v[228:229], v[68:69]
    v_pk_fma_f32 v[230:231], v[68:69], v[68:69], v[230:231]
    v_pk_add_f32 v[228:229], v[228:229], v[70:71]
    v_pk_fma_f32 v[230:231], v[70:71], v[70:71], v[230:231]
    v_pk_add_f32 v[232:233], v[232:233], v[96:97]
    v_pk_fma_f32 v[234:235], v[96:97], v[96:97], v[234:235]
    v_pk_add_f32 v[232:233], v[232:233], v[98:99]
    v_pk_fma_f32 v[234:235], v[98:99], v[98:99], v[234:235]
    v_pk_fma_f32 v[130:131], v[144:145], v[192:193], v[172:173] op_sel:[0,1,0] op_sel_hi:[1,1,1]
    v_pk_fma_f32 v[132:133], v[146:147], v[192:193], v[174:175] op_sel:[0,1,0] op_sel_hi:[1,1,1]
    v_pk_fma_f32 v[16:17], v[16:17], v[192:193], v[130:131] op_sel:[0,0,0] op_sel_hi:[1,0,1]
    v_pk_fma_f32 v[18:19], v[18:19], v[192:193], v[132:133] op_sel:[0,0,0] op_sel_hi:[1,0,1]
    v_pk_fma_f32 v[130:131], v[144:145], v[194:195], v[172:173] op_sel:[0,1,0] op_sel_hi:[1,1,1]
    v_pk_fma_f32 v[132:133], v[146:147], v[194:195], v[174:175] op_sel:[0,1,0] op_sel_hi:[1,1,1]
    v_pk_fma_f32 v[44:45], v[44:45], v[194:195], v[130:131] op_sel:[0,0,0] op_sel_hi:[1,0,1]
    v_pk_fma_f32 v[46:47], v[46:47], v[194:195], v[132:133] op_sel:[0,0,0] op_sel_hi:[1,0,1]
    v_pk_fma_f32 v[130:131], v[144:145], v[196:197], v[172:173] op_sel:[0,1,0] op_sel_hi:[1,1,1]
    v_pk_fma_f32 v[132:133], v[146:147], v[196:197], v[174:175] op_sel:[0,1,0] op_sel_hi:[1,1,1]
    v_pk_fma_f32 v[72:73], v[72:73], v[196:197], v[130:131] op_sel:[0,0,0] op_sel_hi:[1,0,1]
    v_pk_fma_f32 v[74:75], v[74:75], v[196:197], v[132:133] op_sel:[0,0,0] op_sel_hi:[1,0,1]
    v_pk_fma_f32 v[130:131], v[144:145], v[198:199], v[172:173] op_sel:[0,1,0] op_sel_hi:[1,1,1]
    v_pk_fma_f32 v[132:133], v[146:147], v[198:199], v[174:175] op_sel:[0,1,0] op_sel_hi:[1,1,1]
    v_pk_fma_f32 v[100:101], v[100:101], v[198:199], v[130:131] op_sel:[0,0,0] op_sel_hi:[1,0,1]
    v_pk_fma_f32 v[102:103], v[102:103], v[198:199], v[132:133] op_sel:[0,0,0] op_sel_hi:[1,0,1]
    v_pk_mul_f32 v[120:121], v[16:17], v[16:17]
    v_pk_mul_f32 v[122:123], v[18:19], v[18:19]
    v_pk_mul_f32 v[124:125], v[44:45], v[44:45]
    v_pk_mul_f32 v[126:127], v[46:47], v[46:47]
    v_pk_fma_f32 v[120:121], v[120:121], s[64:65], v[128:129]
    v_pk_fma_f32 v[122:123], v[122:123], s[64:65], v[128:129]
    v_pk_fma_f32 v[124:125], v[124:125], s[64:65], v[128:129]
    v_pk_fma_f32 v[126:127], v[126:127], s[64:65], v[128:129]
    v_pk_mul_f32 v[120:121], v[120:121], v[16:17]
    v_pk_mul_f32 v[122:123], v[122:123], v[18:19]
    v_pk_mul_f32 v[124:125], v[124:125], v[44:45]
    v_pk_mul_f32 v[126:127], v[126:127], v[46:47]
    v_exp_f32 v120, v120
    v_exp_f32 v121, v121
    v_exp_f32 v122, v122
    v_exp_f32 v123, v123
    v_exp_f32 v124, v124
    v_exp_f32 v125, v125
    v_exp_f32 v126, v126
    v_exp_f32 v127, v127
    v_pk_add_f32 v[120:121], v[120:121], 1.0 op_sel_hi:[1,0]
    v_pk_add_f32 v[122:123], v[122:123], 1.0 op_sel_hi:[1,0]
    v_pk_add_f32 v[124:125], v[124:125], 1.0 op_sel_hi:[1,0]
    v_pk_add_f32 v[126:127], v[126:127], 1.0 op_sel_hi:[1,0]
    v_rcp_f32 v120, v120
    v_rcp_f32 v121, v121
    v_rcp_f32 v122, v122
    v_rcp_f32 v123, v123
    v_rcp_f32 v124, v124
    v_rcp_f32 v125, v125
    v_rcp_f32 v126, v126
    v_rcp_f32 v127, v127
    v_pk_mul_f32 v[16:17], v[16:17], v[120:121]
    v_pk_mul_f32 v[18:19], v[18:19], v[122:123]
    v_pk_mul_f32 v[44:45], v[44:45], v[124:125]
    v_pk_mul_f32 v[46:47], v[46:47], v[126:127]
    v_pk_mul_f32 v[120:121], v[72:73], v[72:73]
    v_pk_mul_f32 v[122:123], v[74:75], v[74:75]
    v_pk_mul_f32 v[124:125], v[100:101], v[100:101]
    v_pk_mul_f32 v[126:127], v[102:103], v[102:103]
    v_pk_fma_f32 v[120:121], v[120:121], s[64:65], v[128:129]
    v_pk_fma_f32 v[122:123], v[122:123], s[64:65], v[128:129]
    v_pk_fma_f32 v[124:125], v[124:125], s[64:65], v[128:129]
    v_pk_fma_f32 v[126:127], v[126:127], s[64:65], v[128:129]
    v_pk_mul_f32 v[120:121], v[120:121], v[72:73]
    v_pk_mul_f32 v[122:123], v[122:123], v[74:75]
    v_pk_mul_f32 v[124:125], v[124:125], v[100:101]
    v_pk_mul_f32 v[126:127], v[126:127], v[102:103]
    v_exp_f32 v120, v120
    v_exp_f32 v121, v121
    v_exp_f32 v122, v122
    v_exp_f32 v123, v123
    v_exp_f32 v124, v124
    v_exp_f32 v125, v125
    v_exp_f32 v126, v126
    v_exp_f32 v127, v127
    v_pk_add_f32 v[120:121], v[120:121], 1.0 op_sel_hi:[1,0]
    v_pk_add_f32 v[122:123], v[122:123], 1.0 op_sel_hi:[1,0]
    v_pk_add_f32 v[124:125], v[124:125], 1.0 op_sel_hi:[1,0]
    v_pk_add_f32 v[126:127], v[126:127], 1.0 op_sel_hi:[1,0]
    v_rcp_f32 v120, v120
    v_rcp_f32 v121, v121
    v_rcp_f32 v122, v122
    v_rcp_f32 v123, v123
    v_rcp_f32 v124, v124
    v_rcp_f32 v125, v125
    v_rcp_f32 v126, v126
    v_rcp_f32 v127, v127
    v_pk_mul_f32 v[72:73], v[72:73], v[120:121]
    v_pk_mul_f32 v[74:75], v[74:75], v[122:123]
    v_pk_mul_f32 v[100:101], v[100:101], v[124:125]
    v_pk_mul_f32 v[102:103], v[102:103], v[126:127]
    v_pk_add_f32 v[220:221], v[220:221], v[16:17]
    v_pk_fma_f32 v[222:223], v[16:17], v[16:17], v[222:223]
    v_pk_add_f32 v[220:221], v[220:221], v[18:19]
    v_pk_fma_f32 v[222:223], v[18:19], v[18:19], v[222:223]
    v_pk_add_f32 v[224:225], v[224:225], v[44:45]
    v_pk_fma_f32 v[226:227], v[44:45], v[44:45], v[226:227]
    v_pk_add_f32 v[224:225], v[224:225], v[46:47]
    v_pk_fma_f32 v[226:227], v[46:47], v[46:47], v[226:227]
    v_pk_add_f32 v[228:229], v[228:229], v[72:73]
    v_pk_fma_f32 v[230:231], v[72:73], v[72:73], v[230:231]
    v_pk_add_f32 v[228:229], v[228:229], v[74:75]
    v_pk_fma_f32 v[230:231], v[74:75], v[74:75], v[230:231]
    v_pk_add_f32 v[232:233], v[232:233], v[100:101]
    v_pk_fma_f32 v[234:235], v[100:101], v[100:101], v[234:235]
    v_pk_add_f32 v[232:233], v[232:233], v[102:103]
    v_pk_fma_f32 v[234:235], v[102:103], v[102:103], v[234:235]
    v_pk_fma_f32 v[130:131], v[148:149], v[192:193], v[176:177] op_sel:[0,1,0] op_sel_hi:[1,1,1]
    v_pk_fma_f32 v[132:133], v[150:151], v[192:193], v[178:179] op_sel:[0,1,0] op_sel_hi:[1,1,1]
    v_pk_fma_f32 v[20:21], v[20:21], v[192:193], v[130:131] op_sel:[0,0,0] op_sel_hi:[1,0,1]
    v_pk_fma_f32 v[22:23], v[22:23], v[192:193], v[132:133] op_sel:[0,0,0] op_sel_hi:[1,0,1]
    v_pk_fma_f32 v[130:131], v[148:149], v[194:195], v[176:177] op_sel:[0,1,0] op_sel_hi:[1,1,1]
    v_pk_fma_f32 v[132:133], v[150:151], v[194:195], v[178:179] op_sel:[0,1,0] op_sel_hi:[1,1,1]
    v_pk_fma_f32 v[48:49], v[48:49], v[194:195], v[130:131] op_sel:[0,0,0] op_sel_hi:[1,0,1]
    v_pk_fma_f32 v[50:51], v[50:51], v[194:195], v[132:133] op_sel:[0,0,0] op_sel_hi:[1,0,1]
    v_pk_fma_f32 v[130:131], v[148:149], v[196:197], v[176:177] op_sel:[0,1,0] op_sel_hi:[1,1,1]
    v_pk_fma_f32 v[132:133], v[150:151], v[196:197], v[178:179] op_sel:[0,1,0] op_sel_hi:[1,1,1]
    v_pk_fma_f32 v[76:77], v[76:77], v[196:197], v[130:131] op_sel:[0,0,0] op_sel_hi:[1,0,1]
    v_pk_fma_f32 v[78:79], v[78:79], v[196:197], v[132:133] op_sel:[0,0,0] op_sel_hi:[1,0,1]
    v_pk_fma_f32 v[130:131], v[148:149], v[198:199], v[176:177] op_sel:[0,1,0] op_sel_hi:[1,1,1]
    v_pk_fma_f32 v[132:133], v[150:151], v[198:199], v[178:179] op_sel:[0,1,0] op_sel_hi:[1,1,1]
    v_pk_fma_f32 v[104:105], v[104:105], v[198:199], v[130:131] op_sel:[0,0,0] op_sel_hi:[1,0,1]
    v_pk_fma_f32 v[106:107], v[106:107], v[198:199], v[132:133] op_sel:[0,0,0] op_sel_hi:[1,0,1]
    v_pk_mul_f32 v[120:121], v[20:21], v[20:21]
    v_pk_mul_f32 v[122:123], v[22:23], v[22:23]
    v_pk_mul_f32 v[124:125], v[48:49], v[48:49]
    v_pk_mul_f32 v[126:127], v[50:51], v[50:51]
    v_pk_fma_f32 v[120:121], v[120:121], s[64:65], v[128:129]
    v_pk_fma_f32 v[122:123], v[122:123], s[64:65], v[128:129]
    v_pk_fma_f32 v[124:125], v[124:125], s[64:65], v[128:129]
    v_pk_fma_f32 v[126:127], v[126:127], s[64:65], v[128:129]
    v_pk_mul_f32 v[120:121], v[120:121], v[20:21]
    v_pk_mul_f32 v[122:123], v[122:123], v[22:23]
    v_pk_mul_f32 v[124:125], v[124:125], v[48:49]
    v_pk_mul_f32 v[126:127], v[126:127], v[50:51]
    v_exp_f32 v120, v120
    v_exp_f32 v121, v121
    v_exp_f32 v122, v122
    v_exp_f32 v123, v123
    v_exp_f32 v124, v124
    v_exp_f32 v125, v125
    v_exp_f32 v126, v126
    v_exp_f32 v127, v127
    v_pk_add_f32 v[120:121], v[120:121], 1.0 op_sel_hi:[1,0]
    v_pk_add_f32 v[122:123], v[122:123], 1.0 op_sel_hi:[1,0]
    v_pk_add_f32 v[124:125], v[124:125], 1.0 op_sel_hi:[1,0]
    v_pk_add_f32 v[126:127], v[126:127], 1.0 op_sel_hi:[1,0]
    v_rcp_f32 v120, v120
    v_rcp_f32 v121, v121
    v_rcp_f32 v122, v122
    v_rcp_f32 v123, v123
    v_rcp_f32 v124, v124
    v_rcp_f32 v125, v125
    v_rcp_f32 v126, v126
    v_rcp_f32 v127, v127
    v_pk_mul_f32 v[20:21], v[20:21], v[120:121]
    v_pk_mul_f32 v[22:23], v[22:23], v[122:123]
    v_pk_mul_f32 v[48:49], v[48:49], v[124:125]
    v_pk_mul_f32 v[50:51], v[50:51], v[126:127]
    v_pk_mul_f32 v[120:121], v[76:77], v[76:77]
    v_pk_mul_f32 v[122:123], v[78:79], v[78:79]
    v_pk_mul_f32 v[124:125], v[104:105], v[104:105]
    v_pk_mul_f32 v[126:127], v[106:107], v[106:107]
    v_pk_fma_f32 v[120:121], v[120:121], s[64:65], v[128:129]
    v_pk_fma_f32 v[122:123], v[122:123], s[64:65], v[128:129]
    v_pk_fma_f32 v[124:125], v[124:125], s[64:65], v[128:129]
    v_pk_fma_f32 v[126:127], v[126:127], s[64:65], v[128:129]
    v_pk_mul_f32 v[120:121], v[120:121], v[76:77]
    v_pk_mul_f32 v[122:123], v[122:123], v[78:79]
    v_pk_mul_f32 v[124:125], v[124:125], v[104:105]
    v_pk_mul_f32 v[126:127], v[126:127], v[106:107]
    v_exp_f32 v120, v120
    v_exp_f32 v121, v121
    v_exp_f32 v122, v122
    v_exp_f32 v123, v123
    v_exp_f32 v124, v124
    v_exp_f32 v125, v125
    v_exp_f32 v126, v126
    v_exp_f32 v127, v127
    v_pk_add_f32 v[120:121], v[120:121], 1.0 op_sel_hi:[1,0]
    v_pk_add_f32 v[122:123], v[122:123], 1.0 op_sel_hi:[1,0]
    v_pk_add_f32 v[124:125], v[124:125], 1.0 op_sel_hi:[1,0]
    v_pk_add_f32 v[126:127], v[126:127], 1.0 op_sel_hi:[1,0]
    v_rcp_f32 v120, v120
    v_rcp_f32 v121, v121
    v_rcp_f32 v122, v122
    v_rcp_f32 v123, v123
    v_rcp_f32 v124, v124
    v_rcp_f32 v125, v125
    v_rcp_f32 v126, v126
    v_rcp_f32 v127, v127
    v_pk_mul_f32 v[76:77], v[76:77], v[120:121]
    v_pk_mul_f32 v[78:79], v[78:79], v[122:123]
    v_pk_mul_f32 v[104:105], v[104:105], v[124:125]
    v_pk_mul_f32 v[106:107], v[106:107], v[126:127]
    v_pk_add_f32 v[220:221], v[220:221], v[20:21]
    v_pk_fma_f32 v[222:223], v[20:21], v[20:21], v[222:223]
    v_pk_add_f32 v[220:221], v[220:221], v[22:23]
    v_pk_fma_f32 v[222:223], v[22:23], v[22:23], v[222:223]
    v_pk_add_f32 v[224:225], v[224:225], v[48:49]
    v_pk_fma_f32 v[226:227], v[48:49], v[48:49], v[226:227]
    v_pk_add_f32 v[224:225], v[224:225], v[50:51]
    v_pk_fma_f32 v[226:227], v[50:51], v[50:51], v[226:227]
    v_pk_add_f32 v[228:229], v[228:229], v[76:77]
    v_pk_fma_f32 v[230:231], v[76:77], v[76:77], v[230:231]
    v_pk_add_f32 v[228:229], v[228:229], v[78:79]
    v_pk_fma_f32 v[230:231], v[78:79], v[78:79], v[230:231]
    v_pk_add_f32 v[232:233], v[232:233], v[104:105]
    v_pk_fma_f32 v[234:235], v[104:105], v[104:105], v[234:235]
    v_pk_add_f32 v[232:233], v[232:233], v[106:107]
    v_pk_fma_f32 v[234:235], v[106:107], v[106:107], v[234:235]
    v_add_f32 v220, v220, v221
    v_add_f32 v222, v222, v223
    v_add_f32 v224, v224, v225
    v_add_f32 v226, v226, v227
    v_add_f32 v228, v228, v229
    v_add_f32 v230, v230, v231
    v_add_f32 v232, v232, v233
    v_add_f32 v234, v234, v235
    s_nop 0
    v_permlane16_swap_b32 v220, v222
    v_permlane16_swap_b32 v224, v226
    v_permlane16_swap_b32 v228, v230
    v_permlane16_swap_b32 v232, v234
    v_add_f32 v220, v220, v222
    v_add_f32 v224, v224, v226
    v_add_f32 v228, v228, v230
    v_add_f32 v232, v232, v234
    s_nop 1
    v_permlane32_swap_b32 v220, v224
    v_permlane32_swap_b32 v228, v232
    s_bfm_b64 vcc, 32, 32
    v_add_f32 v220, v220, v224
    v_add_f32 v228, v228, v232
    v_cndmask_b32 v221, v220, v219, vcc
    v_cndmask_b32 v222, v219, v220, vcc
    v_cndmask_b32 v229, v228, v219, vcc
    v_cndmask_b32 v230, v219, v228, vcc
    buffer_atomic_add_f32 v221, v214, s[44:47], s60 offen offset:0
    buffer_atomic_add_f32 v222, v215, s[44:47], s60 offen offset:256
    buffer_atomic_add_f32 v229, v214, s[44:47], s60 offen offset:512
    buffer_atomic_add_f32 v230, v215, s[44:47], s60 offen offset:768
    v_pk_fma_f32 v[130:131], v[152:153], v[192:193], v[180:181] op_sel:[0,1,0] op_sel_hi:[1,1,1]
    v_pk_fma_f32 v[132:133], v[154:155], v[192:193], v[182:183] op_sel:[0,1,0] op_sel_hi:[1,1,1]
    v_pk_fma_f32 v[24:25], v[24:25], v[192:193], v[130:131] op_sel:[0,0,0] op_sel_hi:[1,0,1]
    v_pk_fma_f32 v[26:27], v[26:27], v[192:193], v[132:133] op_sel:[0,0,0] op_sel_hi:[1,0,1]
    v_pk_fma_f32 v[130:131], v[152:153], v[194:195], v[180:181] op_sel:[0,1,0] op_sel_hi:[1,1,1]
    v_pk_fma_f32 v[132:133], v[154:155], v[194:195], v[182:183] op_sel:[0,1,0] op_sel_hi:[1,1,1]
    v_pk_fma_f32 v[52:53], v[52:53], v[194:195], v[130:131] op_sel:[0,0,0] op_sel_hi:[1,0,1]
    v_pk_fma_f32 v[54:55], v[54:55], v[194:195], v[132:133] op_sel:[0,0,0] op_sel_hi:[1,0,1]
    v_pk_fma_f32 v[130:131], v[152:153], v[196:197], v[180:181] op_sel:[0,1,0] op_sel_hi:[1,1,1]
    v_pk_fma_f32 v[132:133], v[154:155], v[196:197], v[182:183] op_sel:[0,1,0] op_sel_hi:[1,1,1]
    v_pk_fma_f32 v[80:81], v[80:81], v[196:197], v[130:131] op_sel:[0,0,0] op_sel_hi:[1,0,1]
    v_pk_fma_f32 v[82:83], v[82:83], v[196:197], v[132:133] op_sel:[0,0,0] op_sel_hi:[1,0,1]
    v_pk_fma_f32 v[130:131], v[152:153], v[198:199], v[180:181] op_sel:[0,1,0] op_sel_hi:[1,1,1]
    v_pk_fma_f32 v[132:133], v[154:155], v[198:199], v[182:183] op_sel:[0,1,0] op_sel_hi:[1,1,1]
    v_pk_fma_f32 v[108:109], v[108:109], v[198:199], v[130:131] op_sel:[0,0,0] op_sel_hi:[1,0,1]
    v_pk_fma_f32 v[110:111], v[110:111], v[198:199], v[132:133] op_sel:[0,0,0] op_sel_hi:[1,0,1]
    v_pk_mul_f32 v[120:121], v[24:25], v[24:25]
    v_pk_mul_f32 v[122:123], v[26:27], v[26:27]
    v_pk_mul_f32 v[124:125], v[52:53], v[52:53]
    v_pk_mul_f32 v[126:127], v[54:55], v[54:55]
    v_pk_fma_f32 v[120:121], v[120:121], s[64:65], v[128:129]
    v_pk_fma_f32 v[122:123], v[122:123], s[64:65], v[128:129]
    v_pk_fma_f32 v[124:125], v[124:125], s[64:65], v[128:129]
    v_pk_fma_f32 v[126:127], v[126:127], s[64:65], v[128:129]
    v_pk_mul_f32 v[120:121], v[120:121], v[24:25]
    v_pk_mul_f32 v[122:123], v[122:123], v[26:27]
    v_pk_mul_f32 v[124:125], v[124:125], v[52:53]
    v_pk_mul_f32 v[126:127], v[126:127], v[54:55]
    v_exp_f32 v120, v120
    v_exp_f32 v121, v121
    v_exp_f32 v122, v122
    v_exp_f32 v123, v123
    v_exp_f32 v124, v124
    v_exp_f32 v125, v125
    v_exp_f32 v126, v126
    v_exp_f32 v127, v127
    v_pk_add_f32 v[120:121], v[120:121], 1.0 op_sel_hi:[1,0]
    v_pk_add_f32 v[122:123], v[122:123], 1.0 op_sel_hi:[1,0]
    v_pk_add_f32 v[124:125], v[124:125], 1.0 op_sel_hi:[1,0]
    v_pk_add_f32 v[126:127], v[126:127], 1.0 op_sel_hi:[1,0]
    v_rcp_f32 v120, v120
    v_rcp_f32 v121, v121
    v_rcp_f32 v122, v122
    v_rcp_f32 v123, v123
    v_rcp_f32 v124, v124
    v_rcp_f32 v125, v125
    v_rcp_f32 v126, v126
    v_rcp_f32 v127, v127
    v_pk_mul_f32 v[24:25], v[24:25], v[120:121]
    v_pk_mul_f32 v[26:27], v[26:27], v[122:123]
    v_pk_mul_f32 v[52:53], v[52:53], v[124:125]
    v_pk_mul_f32 v[54:55], v[54:55], v[126:127]
    v_pk_mul_f32 v[120:121], v[80:81], v[80:81]
    v_pk_mul_f32 v[122:123], v[82:83], v[82:83]
    v_pk_mul_f32 v[124:125], v[108:109], v[108:109]
    v_pk_mul_f32 v[126:127], v[110:111], v[110:111]
    v_pk_fma_f32 v[120:121], v[120:121], s[64:65], v[128:129]
    v_pk_fma_f32 v[122:123], v[122:123], s[64:65], v[128:129]
    v_pk_fma_f32 v[124:125], v[124:125], s[64:65], v[128:129]
    v_pk_fma_f32 v[126:127], v[126:127], s[64:65], v[128:129]
    v_pk_mul_f32 v[120:121], v[120:121], v[80:81]
    v_pk_mul_f32 v[122:123], v[122:123], v[82:83]
    v_pk_mul_f32 v[124:125], v[124:125], v[108:109]
    v_pk_mul_f32 v[126:127], v[126:127], v[110:111]
    v_exp_f32 v120, v120
    v_exp_f32 v121, v121
    v_exp_f32 v122, v122
    v_exp_f32 v123, v123
    v_exp_f32 v124, v124
    v_exp_f32 v125, v125
    v_exp_f32 v126, v126
    v_exp_f32 v127, v127
    v_pk_add_f32 v[120:121], v[120:121], 1.0 op_sel_hi:[1,0]
    v_pk_add_f32 v[122:123], v[122:123], 1.0 op_sel_hi:[1,0]
    v_pk_add_f32 v[124:125], v[124:125], 1.0 op_sel_hi:[1,0]
    v_pk_add_f32 v[126:127], v[126:127], 1.0 op_sel_hi:[1,0]
    v_rcp_f32 v120, v120
    v_rcp_f32 v121, v121
    v_rcp_f32 v122, v122
    v_rcp_f32 v123, v123
    v_rcp_f32 v124, v124
    v_rcp_f32 v125, v125
    v_rcp_f32 v126, v126
    v_rcp_f32 v127, v127
    v_pk_mul_f32 v[80:81], v[80:81], v[120:121]
    v_pk_mul_f32 v[82:83], v[82:83], v[122:123]
    v_pk_mul_f32 v[108:109], v[108:109], v[124:125]
    v_pk_mul_f32 v[110:111], v[110:111], v[126:127]
    v_cvt_pk_bf16_f32 v236, v24, v25
    v_cvt_pk_bf16_f32 v237, v26, v27
    v_cvt_pk_bf16_f32 v238, v52, v53
    v_cvt_pk_bf16_f32 v239, v54, v55
    v_cvt_pk_bf16_f32 v240, v80, v81
    v_cvt_pk_bf16_f32 v241, v82, v83
    v_cvt_pk_bf16_f32 v242, v108, v109
    v_cvt_pk_bf16_f32 v243, v110, v111
    v_permlane16_swap_b32 v236, v238
    v_permlane16_swap_b32 v237, v239
    buffer_store_dwordx4 v[236:239], v212, s[24:27], s68 offen offset:0 sc1
    s_nop 1
    v_permlane16_swap_b32 v240, v242
    v_permlane16_swap_b32 v241, v243
    buffer_store_dwordx4 v[240:243], v212, s[24:27], s69 offen offset:0 sc1
    v_pk_fma_f32 v[130:131], v[156:157], v[192:193], v[184:185] op_sel:[0,1,0] op_sel_hi:[1,1,1]
    v_pk_fma_f32 v[132:133], v[158:159], v[192:193], v[186:187] op_sel:[0,1,0] op_sel_hi:[1,1,1]
    v_pk_fma_f32 v[28:29], v[28:29], v[192:193], v[130:131] op_sel:[0,0,0] op_sel_hi:[1,0,1]
    v_pk_fma_f32 v[30:31], v[30:31], v[192:193], v[132:133] op_sel:[0,0,0] op_sel_hi:[1,0,1]
    v_pk_fma_f32 v[130:131], v[156:157], v[194:195], v[184:185] op_sel:[0,1,0] op_sel_hi:[1,1,1]
    v_pk_fma_f32 v[132:133], v[158:159], v[194:195], v[186:187] op_sel:[0,1,0] op_sel_hi:[1,1,1]
    v_pk_fma_f32 v[56:57], v[56:57], v[194:195], v[130:131] op_sel:[0,0,0] op_sel_hi:[1,0,1]
    v_pk_fma_f32 v[58:59], v[58:59], v[194:195], v[132:133] op_sel:[0,0,0] op_sel_hi:[1,0,1]
    v_pk_fma_f32 v[130:131], v[156:157], v[196:197], v[184:185] op_sel:[0,1,0] op_sel_hi:[1,1,1]
    v_pk_fma_f32 v[132:133], v[158:159], v[196:197], v[186:187] op_sel:[0,1,0] op_sel_hi:[1,1,1]
    v_pk_fma_f32 v[84:85], v[84:85], v[196:197], v[130:131] op_sel:[0,0,0] op_sel_hi:[1,0,1]
    v_pk_fma_f32 v[86:87], v[86:87], v[196:197], v[132:133] op_sel:[0,0,0] op_sel_hi:[1,0,1]
    v_pk_fma_f32 v[130:131], v[156:157], v[198:199], v[184:185] op_sel:[0,1,0] op_sel_hi:[1,1,1]
    v_pk_fma_f32 v[132:133], v[158:159], v[198:199], v[186:187] op_sel:[0,1,0] op_sel_hi:[1,1,1]
    v_pk_fma_f32 v[112:113], v[112:113], v[198:199], v[130:131] op_sel:[0,0,0] op_sel_hi:[1,0,1]
    v_pk_fma_f32 v[114:115], v[114:115], v[198:199], v[132:133] op_sel:[0,0,0] op_sel_hi:[1,0,1]
    v_pk_mul_f32 v[120:121], v[28:29], v[28:29]
    v_pk_mul_f32 v[122:123], v[30:31], v[30:31]
    v_pk_mul_f32 v[124:125], v[56:57], v[56:57]
    v_pk_mul_f32 v[126:127], v[58:59], v[58:59]
    v_pk_fma_f32 v[120:121], v[120:121], s[64:65], v[128:129]
    v_pk_fma_f32 v[122:123], v[122:123], s[64:65], v[128:129]
    v_pk_fma_f32 v[124:125], v[124:125], s[64:65], v[128:129]
    v_pk_fma_f32 v[126:127], v[126:127], s[64:65], v[128:129]
    v_pk_mul_f32 v[120:121], v[120:121], v[28:29]
    v_pk_mul_f32 v[122:123], v[122:123], v[30:31]
    v_pk_mul_f32 v[124:125], v[124:125], v[56:57]
    v_pk_mul_f32 v[126:127], v[126:127], v[58:59]
    v_exp_f32 v120, v120
    v_exp_f32 v121, v121
    v_exp_f32 v122, v122
    v_exp_f32 v123, v123
    v_exp_f32 v124, v124
    v_exp_f32 v125, v125
    v_exp_f32 v126, v126
    v_exp_f32 v127, v127
    v_pk_add_f32 v[120:121], v[120:121], 1.0 op_sel_hi:[1,0]
    v_pk_add_f32 v[122:123], v[122:123], 1.0 op_sel_hi:[1,0]
    v_pk_add_f32 v[124:125], v[124:125], 1.0 op_sel_hi:[1,0]
    v_pk_add_f32 v[126:127], v[126:127], 1.0 op_sel_hi:[1,0]
    v_rcp_f32 v120, v120
    v_rcp_f32 v121, v121
    v_rcp_f32 v122, v122
    v_rcp_f32 v123, v123
    v_rcp_f32 v124, v124
    v_rcp_f32 v125, v125
    v_rcp_f32 v126, v126
    v_rcp_f32 v127, v127
    v_pk_mul_f32 v[28:29], v[28:29], v[120:121]
    v_pk_mul_f32 v[30:31], v[30:31], v[122:123]
    v_pk_mul_f32 v[56:57], v[56:57], v[124:125]
    v_pk_mul_f32 v[58:59], v[58:59], v[126:127]
    v_pk_mul_f32 v[120:121], v[84:85], v[84:85]
    v_pk_mul_f32 v[122:123], v[86:87], v[86:87]
    v_pk_mul_f32 v[124:125], v[112:113], v[112:113]
    v_pk_mul_f32 v[126:127], v[114:115], v[114:115]
    v_pk_fma_f32 v[120:121], v[120:121], s[64:65], v[128:129]
    v_pk_fma_f32 v[122:123], v[122:123], s[64:65], v[128:129]
    v_pk_fma_f32 v[124:125], v[124:125], s[64:65], v[128:129]
    v_pk_fma_f32 v[126:127], v[126:127], s[64:65], v[128:129]
    v_pk_mul_f32 v[120:121], v[120:121], v[84:85]
    v_pk_mul_f32 v[122:123], v[122:123], v[86:87]
    v_pk_mul_f32 v[124:125], v[124:125], v[112:113]
    v_pk_mul_f32 v[126:127], v[126:127], v[114:115]
    v_exp_f32 v120, v120
    v_exp_f32 v121, v121
    v_exp_f32 v122, v122
    v_exp_f32 v123, v123
    v_exp_f32 v124, v124
    v_exp_f32 v125, v125
    v_exp_f32 v126, v126
    v_exp_f32 v127, v127
    v_pk_add_f32 v[120:121], v[120:121], 1.0 op_sel_hi:[1,0]
    v_pk_add_f32 v[122:123], v[122:123], 1.0 op_sel_hi:[1,0]
    v_pk_add_f32 v[124:125], v[124:125], 1.0 op_sel_hi:[1,0]
    v_pk_add_f32 v[126:127], v[126:127], 1.0 op_sel_hi:[1,0]
    v_rcp_f32 v120, v120
    v_rcp_f32 v121, v121
    v_rcp_f32 v122, v122
    v_rcp_f32 v123, v123
    v_rcp_f32 v124, v124
    v_rcp_f32 v125, v125
    v_rcp_f32 v126, v126
    v_rcp_f32 v127, v127
    v_pk_mul_f32 v[84:85], v[84:85], v[120:121]
    v_pk_mul_f32 v[86:87], v[86:87], v[122:123]
    v_pk_mul_f32 v[112:113], v[112:113], v[124:125]
    v_pk_mul_f32 v[114:115], v[114:115], v[126:127]
    v_cvt_pk_bf16_f32 v244, v28, v29
    v_cvt_pk_bf16_f32 v245, v30, v31
    v_cvt_pk_bf16_f32 v246, v56, v57
    v_cvt_pk_bf16_f32 v247, v58, v59
    v_cvt_pk_bf16_f32 v248, v84, v85
    v_cvt_pk_bf16_f32 v249, v86, v87
    v_cvt_pk_bf16_f32 v250, v112, v113
    v_cvt_pk_bf16_f32 v251, v114, v115
    v_permlane16_swap_b32 v244, v246
    v_permlane16_swap_b32 v245, v247
    buffer_store_dwordx4 v[244:247], v212, s[24:27], s68 offen offset:512 sc1
    s_nop 1
    v_permlane16_swap_b32 v248, v250
    v_permlane16_swap_b32 v249, v251
    buffer_store_dwordx4 v[248:251], v212, s[24:27], s69 offen offset:512 sc1
    s_barrier
    v_pk_fma_f32 v[130:131], v[160:161], v[192:193], v[188:189] op_sel:[0,1,0] op_sel_hi:[1,1,1]
    v_pk_fma_f32 v[132:133], v[162:163], v[192:193], v[190:191] op_sel:[0,1,0] op_sel_hi:[1,1,1]
    v_pk_fma_f32 v[32:33], v[32:33], v[192:193], v[130:131] op_sel:[0,0,0] op_sel_hi:[1,0,1]
    v_pk_fma_f32 v[34:35], v[34:35], v[192:193], v[132:133] op_sel:[0,0,0] op_sel_hi:[1,0,1]
    v_pk_fma_f32 v[130:131], v[160:161], v[194:195], v[188:189] op_sel:[0,1,0] op_sel_hi:[1,1,1]
    v_pk_fma_f32 v[132:133], v[162:163], v[194:195], v[190:191] op_sel:[0,1,0] op_sel_hi:[1,1,1]
    v_pk_fma_f32 v[60:61], v[60:61], v[194:195], v[130:131] op_sel:[0,0,0] op_sel_hi:[1,0,1]
    v_pk_fma_f32 v[62:63], v[62:63], v[194:195], v[132:133] op_sel:[0,0,0] op_sel_hi:[1,0,1]
    v_pk_fma_f32 v[130:131], v[160:161], v[196:197], v[188:189] op_sel:[0,1,0] op_sel_hi:[1,1,1]
    v_pk_fma_f32 v[132:133], v[162:163], v[196:197], v[190:191] op_sel:[0,1,0] op_sel_hi:[1,1,1]
    v_pk_fma_f32 v[88:89], v[88:89], v[196:197], v[130:131] op_sel:[0,0,0] op_sel_hi:[1,0,1]
    v_pk_fma_f32 v[90:91], v[90:91], v[196:197], v[132:133] op_sel:[0,0,0] op_sel_hi:[1,0,1]
    v_pk_fma_f32 v[130:131], v[160:161], v[198:199], v[188:189] op_sel:[0,1,0] op_sel_hi:[1,1,1]
    v_pk_fma_f32 v[132:133], v[162:163], v[198:199], v[190:191] op_sel:[0,1,0] op_sel_hi:[1,1,1]
    v_pk_fma_f32 v[116:117], v[116:117], v[198:199], v[130:131] op_sel:[0,0,0] op_sel_hi:[1,0,1]
    v_pk_fma_f32 v[118:119], v[118:119], v[198:199], v[132:133] op_sel:[0,0,0] op_sel_hi:[1,0,1]
    v_pk_mul_f32 v[120:121], v[32:33], v[32:33]
    v_pk_mul_f32 v[122:123], v[34:35], v[34:35]
    v_pk_mul_f32 v[124:125], v[60:61], v[60:61]
    v_pk_mul_f32 v[126:127], v[62:63], v[62:63]
    v_pk_fma_f32 v[120:121], v[120:121], s[64:65], v[128:129]
    v_pk_fma_f32 v[122:123], v[122:123], s[64:65], v[128:129]
    v_pk_fma_f32 v[124:125], v[124:125], s[64:65], v[128:129]
    v_pk_fma_f32 v[126:127], v[126:127], s[64:65], v[128:129]
    v_pk_mul_f32 v[120:121], v[120:121], v[32:33]
    v_pk_mul_f32 v[122:123], v[122:123], v[34:35]
    v_pk_mul_f32 v[124:125], v[124:125], v[60:61]
    v_pk_mul_f32 v[126:127], v[126:127], v[62:63]
    v_exp_f32 v120, v120
    v_exp_f32 v121, v121
    v_exp_f32 v122, v122
    v_exp_f32 v123, v123
    v_exp_f32 v124, v124
    v_exp_f32 v125, v125
    v_exp_f32 v126, v126
    v_exp_f32 v127, v127
    v_pk_add_f32 v[120:121], v[120:121], 1.0 op_sel_hi:[1,0]
    v_pk_add_f32 v[122:123], v[122:123], 1.0 op_sel_hi:[1,0]
    v_pk_add_f32 v[124:125], v[124:125], 1.0 op_sel_hi:[1,0]
    v_pk_add_f32 v[126:127], v[126:127], 1.0 op_sel_hi:[1,0]
    v_rcp_f32 v120, v120
    v_rcp_f32 v121, v121
    v_rcp_f32 v122, v122
    v_rcp_f32 v123, v123
    v_rcp_f32 v124, v124
    v_rcp_f32 v125, v125
    v_rcp_f32 v126, v126
    v_rcp_f32 v127, v127
    v_pk_mul_f32 v[32:33], v[32:33], v[120:121]
    v_pk_mul_f32 v[34:35], v[34:35], v[122:123]
    v_pk_mul_f32 v[60:61], v[60:61], v[124:125]
    v_pk_mul_f32 v[62:63], v[62:63], v[126:127]
    v_pk_mul_f32 v[120:121], v[88:89], v[88:89]
    v_pk_mul_f32 v[122:123], v[90:91], v[90:91]
    v_pk_mul_f32 v[124:125], v[116:117], v[116:117]
    v_pk_mul_f32 v[126:127], v[118:119], v[118:119]
    v_pk_fma_f32 v[120:121], v[120:121], s[64:65], v[128:129]
    v_pk_fma_f32 v[122:123], v[122:123], s[64:65], v[128:129]
    v_pk_fma_f32 v[124:125], v[124:125], s[64:65], v[128:129]
    v_pk_fma_f32 v[126:127], v[126:127], s[64:65], v[128:129]
    v_pk_mul_f32 v[120:121], v[120:121], v[88:89]
    v_pk_mul_f32 v[122:123], v[122:123], v[90:91]
    v_pk_mul_f32 v[124:125], v[124:125], v[116:117]
    v_pk_mul_f32 v[126:127], v[126:127], v[118:119]
    v_exp_f32 v120, v120
    v_exp_f32 v121, v121
    v_exp_f32 v122, v122
    v_exp_f32 v123, v123
    v_exp_f32 v124, v124
    v_exp_f32 v125, v125
    v_exp_f32 v126, v126
    v_exp_f32 v127, v127
    v_pk_add_f32 v[120:121], v[120:121], 1.0 op_sel_hi:[1,0]
    v_pk_add_f32 v[122:123], v[122:123], 1.0 op_sel_hi:[1,0]
    v_pk_add_f32 v[124:125], v[124:125], 1.0 op_sel_hi:[1,0]
    v_pk_add_f32 v[126:127], v[126:127], 1.0 op_sel_hi:[1,0]
    v_rcp_f32 v120, v120
    v_rcp_f32 v121, v121
    v_rcp_f32 v122, v122
    v_rcp_f32 v123, v123
    v_rcp_f32 v124, v124
    v_rcp_f32 v125, v125
    v_rcp_f32 v126, v126
    v_rcp_f32 v127, v127
    v_pk_mul_f32 v[88:89], v[88:89], v[120:121]
    v_pk_mul_f32 v[90:91], v[90:91], v[122:123]
    v_pk_mul_f32 v[116:117], v[116:117], v[124:125]
    v_pk_mul_f32 v[118:119], v[118:119], v[126:127]
    v_cvt_pk_bf16_f32 v236, v32, v33
    v_cvt_pk_bf16_f32 v237, v34, v35
    v_cvt_pk_bf16_f32 v238, v60, v61
    v_cvt_pk_bf16_f32 v239, v62, v63
    v_cvt_pk_bf16_f32 v240, v88, v89
    v_cvt_pk_bf16_f32 v241, v90, v91
    v_cvt_pk_bf16_f32 v242, v116, v117
    v_cvt_pk_bf16_f32 v243, v118, v119
    v_permlane16_swap_b32 v236, v238
    v_permlane16_swap_b32 v237, v239
    buffer_store_dwordx4 v[236:239], v212, s[24:27], s68 offen offset:1024 sc1
    s_nop 1
    v_permlane16_swap_b32 v240, v242
    v_permlane16_swap_b32 v241, v243
    buffer_store_dwordx4 v[240:243], v212, s[24:27], s69 offen offset:1024 sc1
    s_barrier
    ds_read_b64 v[136:137], v217 offset:1024
    ds_read_b64 v[140:141], v217 offset:1152
    ds_read_b64 v[144:145], v217 offset:1280
    ds_read_b64 v[148:149], v217 offset:1408
    s_waitcnt lgkmcnt(0)
    s_barrier
    v_pk_fma_f32 v[8:9], v[8:9], v[136:137], v[136:137] op_sel:[0,0,1] op_sel_hi:[1,0,1]
    v_pk_fma_f32 v[10:11], v[10:11], v[136:137], v[136:137] op_sel:[0,0,1] op_sel_hi:[1,0,1]
    v_pk_fma_f32 v[36:37], v[36:37], v[140:141], v[140:141] op_sel:[0,0,1] op_sel_hi:[1,0,1]
    v_pk_fma_f32 v[38:39], v[38:39], v[140:141], v[140:141] op_sel:[0,0,1] op_sel_hi:[1,0,1]
    v_pk_fma_f32 v[64:65], v[64:65], v[144:145], v[144:145] op_sel:[0,0,1] op_sel_hi:[1,0,1]
    v_pk_fma_f32 v[66:67], v[66:67], v[144:145], v[144:145] op_sel:[0,0,1] op_sel_hi:[1,0,1]
    v_pk_fma_f32 v[92:93], v[92:93], v[148:149], v[148:149] op_sel:[0,0,1] op_sel_hi:[1,0,1]
    v_pk_fma_f32 v[94:95], v[94:95], v[148:149], v[148:149] op_sel:[0,0,1] op_sel_hi:[1,0,1]
    v_pk_fma_f32 v[12:13], v[12:13], v[136:137], v[136:137] op_sel:[0,0,1] op_sel_hi:[1,0,1]
    v_pk_fma_f32 v[14:15], v[14:15], v[136:137], v[136:137] op_sel:[0,0,1] op_sel_hi:[1,0,1]
    v_pk_fma_f32 v[40:41], v[40:41], v[140:141], v[140:141] op_sel:[0,0,1] op_sel_hi:[1,0,1]
    v_pk_fma_f32 v[42:43], v[42:43], v[140:141], v[140:141] op_sel:[0,0,1] op_sel_hi:[1,0,1]
    v_pk_fma_f32 v[68:69], v[68:69], v[144:145], v[144:145] op_sel:[0,0,1] op_sel_hi:[1,0,1]
    v_pk_fma_f32 v[70:71], v[70:71], v[144:145], v[144:145] op_sel:[0,0,1] op_sel_hi:[1,0,1]
    v_pk_fma_f32 v[96:97], v[96:97], v[148:149], v[148:149] op_sel:[0,0,1] op_sel_hi:[1,0,1]
    v_pk_fma_f32 v[98:99], v[98:99], v[148:149], v[148:149] op_sel:[0,0,1] op_sel_hi:[1,0,1]
    v_pk_fma_f32 v[16:17], v[16:17], v[136:137], v[136:137] op_sel:[0,0,1] op_sel_hi:[1,0,1]
    v_pk_fma_f32 v[18:19], v[18:19], v[136:137], v[136:137] op_sel:[0,0,1] op_sel_hi:[1,0,1]
    v_pk_fma_f32 v[44:45], v[44:45], v[140:141], v[140:141] op_sel:[0,0,1] op_sel_hi:[1,0,1]
    v_pk_fma_f32 v[46:47], v[46:47], v[140:141], v[140:141] op_sel:[0,0,1] op_sel_hi:[1,0,1]
    v_pk_fma_f32 v[72:73], v[72:73], v[144:145], v[144:145] op_sel:[0,0,1] op_sel_hi:[1,0,1]
    v_pk_fma_f32 v[74:75], v[74:75], v[144:145], v[144:145] op_sel:[0,0,1] op_sel_hi:[1,0,1]
    v_pk_fma_f32 v[100:101], v[100:101], v[148:149], v[148:149] op_sel:[0,0,1] op_sel_hi:[1,0,1]
    v_pk_fma_f32 v[102:103], v[102:103], v[148:149], v[148:149] op_sel:[0,0,1] op_sel_hi:[1,0,1]
    v_pk_fma_f32 v[20:21], v[20:21], v[136:137], v[136:137] op_sel:[0,0,1] op_sel_hi:[1,0,1]
    v_pk_fma_f32 v[22:23], v[22:23], v[136:137], v[136:137] op_sel:[0,0,1] op_sel_hi:[1,0,1]
    v_pk_fma_f32 v[48:49], v[48:49], v[140:141], v[140:141] op_sel:[0,0,1] op_sel_hi:[1,0,1]
    v_pk_fma_f32 v[50:51], v[50:51], v[140:141], v[140:141] op_sel:[0,0,1] op_sel_hi:[1,0,1]
    v_pk_fma_f32 v[76:77], v[76:77], v[144:145], v[144:145] op_sel:[0,0,1] op_sel_hi:[1,0,1]
    v_pk_fma_f32 v[78:79], v[78:79], v[144:145], v[144:145] op_sel:[0,0,1] op_sel_hi:[1,0,1]
    v_pk_fma_f32 v[104:105], v[104:105], v[148:149], v[148:149] op_sel:[0,0,1] op_sel_hi:[1,0,1]
    v_pk_fma_f32 v[106:107], v[106:107], v[148:149], v[148:149] op_sel:[0,0,1] op_sel_hi:[1,0,1]
    v_cvt_pk_bf16_f32 v152, v8, v9
    v_cvt_pk_bf16_f32 v153, v10, v11
    v_cvt_pk_bf16_f32 v154, v36, v37
    v_cvt_pk_bf16_f32 v155, v38, v39
    v_cvt_pk_bf16_f32 v156, v64, v65
    v_cvt_pk_bf16_f32 v157, v66, v67
    v_cvt_pk_bf16_f32 v158, v92, v93
    v_cvt_pk_bf16_f32 v159, v94, v95
    v_permlane16_swap_b32 v152, v154
    v_permlane16_swap_b32 v153, v155
    s_add_u32 s71, s70, 0
    buffer_store_dwordx4 v[152:155], v213, s[40:43], s71 offen offset:0 sc1
    v_cvt_pk_bf16_f32 v160, v12, v13
    v_cvt_pk_bf16_f32 v161, v14, v15
    v_cvt_pk_bf16_f32 v162, v40, v41
    v_cvt_pk_bf16_f32 v163, v42, v43
    v_permlane16_swap_b32 v156, v158
    v_permlane16_swap_b32 v157, v159
    buffer_store_dwordx4 v[156:159], v213, s[40:43], s71 offen offset:1024 sc1
    v_cvt_pk_bf16_f32 v164, v68, v69
    v_cvt_pk_bf16_f32 v165, v70, v71
    v_cvt_pk_bf16_f32 v166, v96, v97
    v_cvt_pk_bf16_f32 v167, v98, v99
    v_permlane16_swap_b32 v160, v162
    v_permlane16_swap_b32 v161, v163
    s_add_u32 s71, s70, 65536
    buffer_store_dwordx4 v[160:163], v213, s[40:43], s71 offen offset:0 sc1
    v_cvt_pk_bf16_f32 v168, v16, v17
    v_cvt_pk_bf16_f32 v169, v18, v19
    v_cvt_pk_bf16_f32 v170, v44, v45
    v_cvt_pk_bf16_f32 v171, v46, v47
    v_permlane16_swap_b32 v164, v166
    v_permlane16_swap_b32 v165, v167
    buffer_store_dwordx4 v[164:167], v213, s[40:43], s71 offen offset:1024 sc1
    v_cvt_pk_bf16_f32 v172, v72, v73
    v_cvt_pk_bf16_f32 v173, v74, v75
    v_cvt_pk_bf16_f32 v174, v100, v101
    v_cvt_pk_bf16_f32 v175, v102, v103
    v_permlane16_swap_b32 v168, v170
    v_permlane16_swap_b32 v169, v171
    s_add_u32 s71, s70, 131072
    buffer_store_dwordx4 v[168:171], v213, s[40:43], s71 offen offset:0 sc1
    v_cvt_pk_bf16_f32 v176, v20, v21
    v_cvt_pk_bf16_f32 v177, v22, v23
    v_cvt_pk_bf16_f32 v178, v48, v49
    v_cvt_pk_bf16_f32 v179, v50, v51
    v_permlane16_swap_b32 v172, v174
    v_permlane16_swap_b32 v173, v175
    buffer_store_dwordx4 v[172:175], v213, s[40:43], s71 offen offset:1024 sc1
    v_cvt_pk_bf16_f32 v180, v76, v77
    v_cvt_pk_bf16_f32 v181, v78, v79
    v_cvt_pk_bf16_f32 v182, v104, v105
    v_cvt_pk_bf16_f32 v183, v106, v107
    v_permlane16_swap_b32 v176, v178
    v_permlane16_swap_b32 v177, v179
    s_add_u32 s71, s70, 196608
    buffer_store_dwordx4 v[176:179], v213, s[40:43], s71 offen offset:0 sc1
    s_nop 1
    v_permlane16_swap_b32 v180, v182
    v_permlane16_swap_b32 v181, v183
    buffer_store_dwordx4 v[180:183], v213, s[40:43], s71 offen offset:1024 sc1
    s_branch adaLN_cond__mha_block__mixer_gmlp__prompt_kernel_w_fin
adaLN_cond__mha_block__mixer_gmlp__prompt_kernel_w_e1:
    v_pk_fma_f32 v[130:131], v[136:137], v[192:193], v[164:165] op_sel:[0,1,0] op_sel_hi:[1,1,1]
    v_pk_fma_f32 v[132:133], v[138:139], v[192:193], v[166:167] op_sel:[0,1,0] op_sel_hi:[1,1,1]
    v_pk_fma_f32 v[8:9], v[8:9], v[192:193], v[130:131] op_sel:[0,0,0] op_sel_hi:[1,0,1]
    v_pk_fma_f32 v[10:11], v[10:11], v[192:193], v[132:133] op_sel:[0,0,0] op_sel_hi:[1,0,1]
    v_pk_fma_f32 v[130:131], v[136:137], v[194:195], v[164:165] op_sel:[0,1,0] op_sel_hi:[1,1,1]
    v_pk_fma_f32 v[132:133], v[138:139], v[194:195], v[166:167] op_sel:[0,1,0] op_sel_hi:[1,1,1]
    v_pk_fma_f32 v[36:37], v[36:37], v[194:195], v[130:131] op_sel:[0,0,0] op_sel_hi:[1,0,1]
    v_pk_fma_f32 v[38:39], v[38:39], v[194:195], v[132:133] op_sel:[0,0,0] op_sel_hi:[1,0,1]
    v_pk_fma_f32 v[130:131], v[136:137], v[196:197], v[164:165] op_sel:[0,1,0] op_sel_hi:[1,1,1]
    v_pk_fma_f32 v[132:133], v[138:139], v[196:197], v[166:167] op_sel:[0,1,0] op_sel_hi:[1,1,1]
    v_pk_fma_f32 v[64:65], v[64:65], v[196:197], v[130:131] op_sel:[0,0,0] op_sel_hi:[1,0,1]
    v_pk_fma_f32 v[66:67], v[66:67], v[196:197], v[132:133] op_sel:[0,0,0] op_sel_hi:[1,0,1]
    v_pk_fma_f32 v[130:131], v[136:137], v[198:199], v[164:165] op_sel:[0,1,0] op_sel_hi:[1,1,1]
    v_pk_fma_f32 v[132:133], v[138:139], v[198:199], v[166:167] op_sel:[0,1,0] op_sel_hi:[1,1,1]
    v_pk_fma_f32 v[92:93], v[92:93], v[198:199], v[130:131] op_sel:[0,0,0] op_sel_hi:[1,0,1]
    v_pk_fma_f32 v[94:95], v[94:95], v[198:199], v[132:133] op_sel:[0,0,0] op_sel_hi:[1,0,1]
    v_pk_mul_f32 v[120:121], v[8:9], v[8:9]
    v_pk_mul_f32 v[122:123], v[10:11], v[10:11]
    v_pk_mul_f32 v[124:125], v[36:37], v[36:37]
    v_pk_mul_f32 v[126:127], v[38:39], v[38:39]
    v_pk_fma_f32 v[120:121], v[120:121], s[64:65], v[128:129]
    v_pk_fma_f32 v[122:123], v[122:123], s[64:65], v[128:129]
    v_pk_fma_f32 v[124:125], v[124:125], s[64:65], v[128:129]
    v_pk_fma_f32 v[126:127], v[126:127], s[64:65], v[128:129]
    v_pk_mul_f32 v[120:121], v[120:121], v[8:9]
    v_pk_mul_f32 v[122:123], v[122:123], v[10:11]
    v_pk_mul_f32 v[124:125], v[124:125], v[36:37]
    v_pk_mul_f32 v[126:127], v[126:127], v[38:39]
    v_exp_f32 v120, v120
    v_exp_f32 v121, v121
    v_exp_f32 v122, v122
    v_exp_f32 v123, v123
    v_exp_f32 v124, v124
    v_exp_f32 v125, v125
    v_exp_f32 v126, v126
    v_exp_f32 v127, v127
    v_pk_add_f32 v[120:121], v[120:121], 1.0 op_sel_hi:[1,0]
    v_pk_add_f32 v[122:123], v[122:123], 1.0 op_sel_hi:[1,0]
    v_pk_add_f32 v[124:125], v[124:125], 1.0 op_sel_hi:[1,0]
    v_pk_add_f32 v[126:127], v[126:127], 1.0 op_sel_hi:[1,0]
    v_rcp_f32 v120, v120
    v_rcp_f32 v121, v121
    v_rcp_f32 v122, v122
    v_rcp_f32 v123, v123
    v_rcp_f32 v124, v124
    v_rcp_f32 v125, v125
    v_rcp_f32 v126, v126
    v_rcp_f32 v127, v127
    v_pk_mul_f32 v[8:9], v[8:9], v[120:121]
    v_pk_mul_f32 v[10:11], v[10:11], v[122:123]
    v_pk_mul_f32 v[36:37], v[36:37], v[124:125]
    v_pk_mul_f32 v[38:39], v[38:39], v[126:127]
    v_pk_mul_f32 v[120:121], v[64:65], v[64:65]
    v_pk_mul_f32 v[122:123], v[66:67], v[66:67]
    v_pk_mul_f32 v[124:125], v[92:93], v[92:93]
    v_pk_mul_f32 v[126:127], v[94:95], v[94:95]
    v_pk_fma_f32 v[120:121], v[120:121], s[64:65], v[128:129]
    v_pk_fma_f32 v[122:123], v[122:123], s[64:65], v[128:129]
    v_pk_fma_f32 v[124:125], v[124:125], s[64:65], v[128:129]
    v_pk_fma_f32 v[126:127], v[126:127], s[64:65], v[128:129]
    v_pk_mul_f32 v[120:121], v[120:121], v[64:65]
    v_pk_mul_f32 v[122:123], v[122:123], v[66:67]
    v_pk_mul_f32 v[124:125], v[124:125], v[92:93]
    v_pk_mul_f32 v[126:127], v[126:127], v[94:95]
    v_exp_f32 v120, v120
    v_exp_f32 v121, v121
    v_exp_f32 v122, v122
    v_exp_f32 v123, v123
    v_exp_f32 v124, v124
    v_exp_f32 v125, v125
    v_exp_f32 v126, v126
    v_exp_f32 v127, v127
    v_pk_add_f32 v[120:121], v[120:121], 1.0 op_sel_hi:[1,0]
    v_pk_add_f32 v[122:123], v[122:123], 1.0 op_sel_hi:[1,0]
    v_pk_add_f32 v[124:125], v[124:125], 1.0 op_sel_hi:[1,0]
    v_pk_add_f32 v[126:127], v[126:127], 1.0 op_sel_hi:[1,0]
    v_rcp_f32 v120, v120
    v_rcp_f32 v121, v121
    v_rcp_f32 v122, v122
    v_rcp_f32 v123, v123
    v_rcp_f32 v124, v124
    v_rcp_f32 v125, v125
    v_rcp_f32 v126, v126
    v_rcp_f32 v127, v127
    v_pk_mul_f32 v[64:65], v[64:65], v[120:121]
    v_pk_mul_f32 v[66:67], v[66:67], v[122:123]
    v_pk_mul_f32 v[92:93], v[92:93], v[124:125]
    v_pk_mul_f32 v[94:95], v[94:95], v[126:127]
    v_pk_add_f32 v[220:221], v[8:9], v[10:11]
    v_pk_mul_f32 v[222:223], v[8:9], v[8:9]
    v_pk_fma_f32 v[222:223], v[10:11], v[10:11], v[222:223]
    v_pk_add_f32 v[224:225], v[36:37], v[38:39]
    v_pk_mul_f32 v[226:227], v[36:37], v[36:37]
    v_pk_fma_f32 v[226:227], v[38:39], v[38:39], v[226:227]
    v_pk_add_f32 v[228:229], v[64:65], v[66:67]
    v_pk_mul_f32 v[230:231], v[64:65], v[64:65]
    v_pk_fma_f32 v[230:231], v[66:67], v[66:67], v[230:231]
    v_pk_add_f32 v[232:233], v[92:93], v[94:95]
    v_pk_mul_f32 v[234:235], v[92:93], v[92:93]
    v_pk_fma_f32 v[234:235], v[94:95], v[94:95], v[234:235]
    v_pk_fma_f32 v[130:131], v[140:141], v[192:193], v[168:169] op_sel:[0,1,0] op_sel_hi:[1,1,1]
    v_pk_fma_f32 v[132:133], v[142:143], v[192:193], v[170:171] op_sel:[0,1,0] op_sel_hi:[1,1,1]
    v_pk_fma_f32 v[12:13], v[12:13], v[192:193], v[130:131] op_sel:[0,0,0] op_sel_hi:[1,0,1]
    v_pk_fma_f32 v[14:15], v[14:15], v[192:193], v[132:133] op_sel:[0,0,0] op_sel_hi:[1,0,1]
    v_pk_fma_f32 v[130:131], v[140:141], v[194:195], v[168:169] op_sel:[0,1,0] op_sel_hi:[1,1,1]
    v_pk_fma_f32 v[132:133], v[142:143], v[194:195], v[170:171] op_sel:[0,1,0] op_sel_hi:[1,1,1]
    v_pk_fma_f32 v[40:41], v[40:41], v[194:195], v[130:131] op_sel:[0,0,0] op_sel_hi:[1,0,1]
    v_pk_fma_f32 v[42:43], v[42:43], v[194:195], v[132:133] op_sel:[0,0,0] op_sel_hi:[1,0,1]
    v_pk_fma_f32 v[130:131], v[140:141], v[196:197], v[168:169] op_sel:[0,1,0] op_sel_hi:[1,1,1]
    v_pk_fma_f32 v[132:133], v[142:143], v[196:197], v[170:171] op_sel:[0,1,0] op_sel_hi:[1,1,1]
    v_pk_fma_f32 v[68:69], v[68:69], v[196:197], v[130:131] op_sel:[0,0,0] op_sel_hi:[1,0,1]
    v_pk_fma_f32 v[70:71], v[70:71], v[196:197], v[132:133] op_sel:[0,0,0] op_sel_hi:[1,0,1]
    v_pk_fma_f32 v[130:131], v[140:141], v[198:199], v[168:169] op_sel:[0,1,0] op_sel_hi:[1,1,1]
    v_pk_fma_f32 v[132:133], v[142:143], v[198:199], v[170:171] op_sel:[0,1,0] op_sel_hi:[1,1,1]
    v_pk_fma_f32 v[96:97], v[96:97], v[198:199], v[130:131] op_sel:[0,0,0] op_sel_hi:[1,0,1]
    v_pk_fma_f32 v[98:99], v[98:99], v[198:199], v[132:133] op_sel:[0,0,0] op_sel_hi:[1,0,1]
    v_pk_mul_f32 v[120:121], v[12:13], v[12:13]
    v_pk_mul_f32 v[122:123], v[14:15], v[14:15]
    v_pk_mul_f32 v[124:125], v[40:41], v[40:41]
    v_pk_mul_f32 v[126:127], v[42:43], v[42:43]
    v_pk_fma_f32 v[120:121], v[120:121], s[64:65], v[128:129]
    v_pk_fma_f32 v[122:123], v[122:123], s[64:65], v[128:129]
    v_pk_fma_f32 v[124:125], v[124:125], s[64:65], v[128:129]
    v_pk_fma_f32 v[126:127], v[126:127], s[64:65], v[128:129]
    v_pk_mul_f32 v[120:121], v[120:121], v[12:13]
    v_pk_mul_f32 v[122:123], v[122:123], v[14:15]
    v_pk_mul_f32 v[124:125], v[124:125], v[40:41]
    v_pk_mul_f32 v[126:127], v[126:127], v[42:43]
    v_exp_f32 v120, v120
    v_exp_f32 v121, v121
    v_exp_f32 v122, v122
    v_exp_f32 v123, v123
    v_exp_f32 v124, v124
    v_exp_f32 v125, v125
    v_exp_f32 v126, v126
    v_exp_f32 v127, v127
    v_pk_add_f32 v[120:121], v[120:121], 1.0 op_sel_hi:[1,0]
    v_pk_add_f32 v[122:123], v[122:123], 1.0 op_sel_hi:[1,0]
    v_pk_add_f32 v[124:125], v[124:125], 1.0 op_sel_hi:[1,0]
    v_pk_add_f32 v[126:127], v[126:127], 1.0 op_sel_hi:[1,0]
    v_rcp_f32 v120, v120
    v_rcp_f32 v121, v121
    v_rcp_f32 v122, v122
    v_rcp_f32 v123, v123
    v_rcp_f32 v124, v124
    v_rcp_f32 v125, v125
    v_rcp_f32 v126, v126
    v_rcp_f32 v127, v127
    v_pk_mul_f32 v[12:13], v[12:13], v[120:121]
    v_pk_mul_f32 v[14:15], v[14:15], v[122:123]
    v_pk_mul_f32 v[40:41], v[40:41], v[124:125]
    v_pk_mul_f32 v[42:43], v[42:43], v[126:127]
    v_pk_mul_f32 v[120:121], v[68:69], v[68:69]
    v_pk_mul_f32 v[122:123], v[70:71], v[70:71]
    v_pk_mul_f32 v[124:125], v[96:97], v[96:97]
    v_pk_mul_f32 v[126:127], v[98:99], v[98:99]
    v_pk_fma_f32 v[120:121], v[120:121], s[64:65], v[128:129]
    v_pk_fma_f32 v[122:123], v[122:123], s[64:65], v[128:129]
    v_pk_fma_f32 v[124:125], v[124:125], s[64:65], v[128:129]
    v_pk_fma_f32 v[126:127], v[126:127], s[64:65], v[128:129]
    v_pk_mul_f32 v[120:121], v[120:121], v[68:69]
    v_pk_mul_f32 v[122:123], v[122:123], v[70:71]
    v_pk_mul_f32 v[124:125], v[124:125], v[96:97]
    v_pk_mul_f32 v[126:127], v[126:127], v[98:99]
    v_exp_f32 v120, v120
    v_exp_f32 v121, v121
    v_exp_f32 v122, v122
    v_exp_f32 v123, v123
    v_exp_f32 v124, v124
    v_exp_f32 v125, v125
    v_exp_f32 v126, v126
    v_exp_f32 v127, v127
    v_pk_add_f32 v[120:121], v[120:121], 1.0 op_sel_hi:[1,0]
    v_pk_add_f32 v[122:123], v[122:123], 1.0 op_sel_hi:[1,0]
    v_pk_add_f32 v[124:125], v[124:125], 1.0 op_sel_hi:[1,0]
    v_pk_add_f32 v[126:127], v[126:127], 1.0 op_sel_hi:[1,0]
    v_rcp_f32 v120, v120
    v_rcp_f32 v121, v121
    v_rcp_f32 v122, v122
    v_rcp_f32 v123, v123
    v_rcp_f32 v124, v124
    v_rcp_f32 v125, v125
    v_rcp_f32 v126, v126
    v_rcp_f32 v127, v127
    v_pk_mul_f32 v[68:69], v[68:69], v[120:121]
    v_pk_mul_f32 v[70:71], v[70:71], v[122:123]
    v_pk_mul_f32 v[96:97], v[96:97], v[124:125]
    v_pk_mul_f32 v[98:99], v[98:99], v[126:127]
    v_pk_add_f32 v[220:221], v[220:221], v[12:13]
    v_pk_fma_f32 v[222:223], v[12:13], v[12:13], v[222:223]
    v_pk_add_f32 v[220:221], v[220:221], v[14:15]
    v_pk_fma_f32 v[222:223], v[14:15], v[14:15], v[222:223]
    v_pk_add_f32 v[224:225], v[224:225], v[40:41]
    v_pk_fma_f32 v[226:227], v[40:41], v[40:41], v[226:227]
    v_pk_add_f32 v[224:225], v[224:225], v[42:43]
    v_pk_fma_f32 v[226:227], v[42:43], v[42:43], v[226:227]
    v_pk_add_f32 v[228:229], v[228:229], v[68:69]
    v_pk_fma_f32 v[230:231], v[68:69], v[68:69], v[230:231]
    v_pk_add_f32 v[228:229], v[228:229], v[70:71]
    v_pk_fma_f32 v[230:231], v[70:71], v[70:71], v[230:231]
    v_pk_add_f32 v[232:233], v[232:233], v[96:97]
    v_pk_fma_f32 v[234:235], v[96:97], v[96:97], v[234:235]
    v_pk_add_f32 v[232:233], v[232:233], v[98:99]
    v_pk_fma_f32 v[234:235], v[98:99], v[98:99], v[234:235]
    v_pk_fma_f32 v[130:131], v[144:145], v[192:193], v[172:173] op_sel:[0,1,0] op_sel_hi:[1,1,1]
    v_pk_fma_f32 v[132:133], v[146:147], v[192:193], v[174:175] op_sel:[0,1,0] op_sel_hi:[1,1,1]
    v_pk_fma_f32 v[16:17], v[16:17], v[192:193], v[130:131] op_sel:[0,0,0] op_sel_hi:[1,0,1]
    v_pk_fma_f32 v[18:19], v[18:19], v[192:193], v[132:133] op_sel:[0,0,0] op_sel_hi:[1,0,1]
    v_pk_fma_f32 v[130:131], v[144:145], v[194:195], v[172:173] op_sel:[0,1,0] op_sel_hi:[1,1,1]
    v_pk_fma_f32 v[132:133], v[146:147], v[194:195], v[174:175] op_sel:[0,1,0] op_sel_hi:[1,1,1]
    v_pk_fma_f32 v[44:45], v[44:45], v[194:195], v[130:131] op_sel:[0,0,0] op_sel_hi:[1,0,1]
    v_pk_fma_f32 v[46:47], v[46:47], v[194:195], v[132:133] op_sel:[0,0,0] op_sel_hi:[1,0,1]
    v_pk_fma_f32 v[130:131], v[144:145], v[196:197], v[172:173] op_sel:[0,1,0] op_sel_hi:[1,1,1]
    v_pk_fma_f32 v[132:133], v[146:147], v[196:197], v[174:175] op_sel:[0,1,0] op_sel_hi:[1,1,1]
    v_pk_fma_f32 v[72:73], v[72:73], v[196:197], v[130:131] op_sel:[0,0,0] op_sel_hi:[1,0,1]
    v_pk_fma_f32 v[74:75], v[74:75], v[196:197], v[132:133] op_sel:[0,0,0] op_sel_hi:[1,0,1]
    v_pk_fma_f32 v[130:131], v[144:145], v[198:199], v[172:173] op_sel:[0,1,0] op_sel_hi:[1,1,1]
    v_pk_fma_f32 v[132:133], v[146:147], v[198:199], v[174:175] op_sel:[0,1,0] op_sel_hi:[1,1,1]
    v_pk_fma_f32 v[100:101], v[100:101], v[198:199], v[130:131] op_sel:[0,0,0] op_sel_hi:[1,0,1]
    v_pk_fma_f32 v[102:103], v[102:103], v[198:199], v[132:133] op_sel:[0,0,0] op_sel_hi:[1,0,1]
    v_pk_mul_f32 v[120:121], v[16:17], v[16:17]
    v_pk_mul_f32 v[122:123], v[18:19], v[18:19]
    v_pk_mul_f32 v[124:125], v[44:45], v[44:45]
    v_pk_mul_f32 v[126:127], v[46:47], v[46:47]
    v_pk_fma_f32 v[120:121], v[120:121], s[64:65], v[128:129]
    v_pk_fma_f32 v[122:123], v[122:123], s[64:65], v[128:129]
    v_pk_fma_f32 v[124:125], v[124:125], s[64:65], v[128:129]
    v_pk_fma_f32 v[126:127], v[126:127], s[64:65], v[128:129]
    v_pk_mul_f32 v[120:121], v[120:121], v[16:17]
    v_pk_mul_f32 v[122:123], v[122:123], v[18:19]
    v_pk_mul_f32 v[124:125], v[124:125], v[44:45]
    v_pk_mul_f32 v[126:127], v[126:127], v[46:47]
    v_exp_f32 v120, v120
    v_exp_f32 v121, v121
    v_exp_f32 v122, v122
    v_exp_f32 v123, v123
    v_exp_f32 v124, v124
    v_exp_f32 v125, v125
    v_exp_f32 v126, v126
    v_exp_f32 v127, v127
    v_pk_add_f32 v[120:121], v[120:121], 1.0 op_sel_hi:[1,0]
    v_pk_add_f32 v[122:123], v[122:123], 1.0 op_sel_hi:[1,0]
    v_pk_add_f32 v[124:125], v[124:125], 1.0 op_sel_hi:[1,0]
    v_pk_add_f32 v[126:127], v[126:127], 1.0 op_sel_hi:[1,0]
    v_rcp_f32 v120, v120
    v_rcp_f32 v121, v121
    v_rcp_f32 v122, v122
    v_rcp_f32 v123, v123
    v_rcp_f32 v124, v124
    v_rcp_f32 v125, v125
    v_rcp_f32 v126, v126
    v_rcp_f32 v127, v127
    v_pk_mul_f32 v[16:17], v[16:17], v[120:121]
    v_pk_mul_f32 v[18:19], v[18:19], v[122:123]
    v_pk_mul_f32 v[44:45], v[44:45], v[124:125]
    v_pk_mul_f32 v[46:47], v[46:47], v[126:127]
    v_pk_mul_f32 v[120:121], v[72:73], v[72:73]
    v_pk_mul_f32 v[122:123], v[74:75], v[74:75]
    v_pk_mul_f32 v[124:125], v[100:101], v[100:101]
    v_pk_mul_f32 v[126:127], v[102:103], v[102:103]
    v_pk_fma_f32 v[120:121], v[120:121], s[64:65], v[128:129]
    v_pk_fma_f32 v[122:123], v[122:123], s[64:65], v[128:129]
    v_pk_fma_f32 v[124:125], v[124:125], s[64:65], v[128:129]
    v_pk_fma_f32 v[126:127], v[126:127], s[64:65], v[128:129]
    v_pk_mul_f32 v[120:121], v[120:121], v[72:73]
    v_pk_mul_f32 v[122:123], v[122:123], v[74:75]
    v_pk_mul_f32 v[124:125], v[124:125], v[100:101]
    v_pk_mul_f32 v[126:127], v[126:127], v[102:103]
    v_exp_f32 v120, v120
    v_exp_f32 v121, v121
    v_exp_f32 v122, v122
    v_exp_f32 v123, v123
    v_exp_f32 v124, v124
    v_exp_f32 v125, v125
    v_exp_f32 v126, v126
    v_exp_f32 v127, v127
    v_pk_add_f32 v[120:121], v[120:121], 1.0 op_sel_hi:[1,0]
    v_pk_add_f32 v[122:123], v[122:123], 1.0 op_sel_hi:[1,0]
    v_pk_add_f32 v[124:125], v[124:125], 1.0 op_sel_hi:[1,0]
    v_pk_add_f32 v[126:127], v[126:127], 1.0 op_sel_hi:[1,0]
    v_rcp_f32 v120, v120
    v_rcp_f32 v121, v121
    v_rcp_f32 v122, v122
    v_rcp_f32 v123, v123
    v_rcp_f32 v124, v124
    v_rcp_f32 v125, v125
    v_rcp_f32 v126, v126
    v_rcp_f32 v127, v127
    v_pk_mul_f32 v[72:73], v[72:73], v[120:121]
    v_pk_mul_f32 v[74:75], v[74:75], v[122:123]
    v_pk_mul_f32 v[100:101], v[100:101], v[124:125]
    v_pk_mul_f32 v[102:103], v[102:103], v[126:127]
    v_pk_add_f32 v[220:221], v[220:221], v[16:17]
    v_pk_fma_f32 v[222:223], v[16:17], v[16:17], v[222:223]
    v_pk_add_f32 v[220:221], v[220:221], v[18:19]
    v_pk_fma_f32 v[222:223], v[18:19], v[18:19], v[222:223]
    v_pk_add_f32 v[224:225], v[224:225], v[44:45]
    v_pk_fma_f32 v[226:227], v[44:45], v[44:45], v[226:227]
    v_pk_add_f32 v[224:225], v[224:225], v[46:47]
    v_pk_fma_f32 v[226:227], v[46:47], v[46:47], v[226:227]
    v_pk_add_f32 v[228:229], v[228:229], v[72:73]
    v_pk_fma_f32 v[230:231], v[72:73], v[72:73], v[230:231]
    v_pk_add_f32 v[228:229], v[228:229], v[74:75]
    v_pk_fma_f32 v[230:231], v[74:75], v[74:75], v[230:231]
    v_pk_add_f32 v[232:233], v[232:233], v[100:101]
    v_pk_fma_f32 v[234:235], v[100:101], v[100:101], v[234:235]
    v_pk_add_f32 v[232:233], v[232:233], v[102:103]
    v_pk_fma_f32 v[234:235], v[102:103], v[102:103], v[234:235]
    v_add_f32 v220, v220, v221
    v_add_f32 v222, v222, v223
    v_add_f32 v224, v224, v225
    v_add_f32 v226, v226, v227
    v_add_f32 v228, v228, v229
    v_add_f32 v230, v230, v231
    v_add_f32 v232, v232, v233
    v_add_f32 v234, v234, v235
    s_nop 0
    v_permlane16_swap_b32 v220, v222
    v_permlane16_swap_b32 v224, v226
    v_permlane16_swap_b32 v228, v230
    v_permlane16_swap_b32 v232, v234
    v_add_f32 v220, v220, v222
    v_add_f32 v224, v224, v226
    v_add_f32 v228, v228, v230
    v_add_f32 v232, v232, v234
    s_nop 1
    v_permlane32_swap_b32 v220, v224
    v_permlane32_swap_b32 v228, v232
    s_bfm_b64 vcc, 32, 32
    v_add_f32 v220, v220, v224
    v_add_f32 v228, v228, v232
    v_cndmask_b32 v221, v220, v219, vcc
    v_cndmask_b32 v222, v219, v220, vcc
    v_cndmask_b32 v229, v228, v219, vcc
    v_cndmask_b32 v230, v219, v228, vcc
    buffer_atomic_add_f32 v221, v214, s[44:47], s60 offen offset:0
    buffer_atomic_add_f32 v222, v215, s[44:47], s60 offen offset:256
    buffer_atomic_add_f32 v229, v214, s[44:47], s60 offen offset:512
    buffer_atomic_add_f32 v230, v215, s[44:47], s60 offen offset:768
    v_pk_fma_f32 v[130:131], v[148:149], v[192:193], v[176:177] op_sel:[0,1,0] op_sel_hi:[1,1,1]
    v_pk_fma_f32 v[132:133], v[150:151], v[192:193], v[178:179] op_sel:[0,1,0] op_sel_hi:[1,1,1]
    v_pk_fma_f32 v[20:21], v[20:21], v[192:193], v[130:131] op_sel:[0,0,0] op_sel_hi:[1,0,1]
    v_pk_fma_f32 v[22:23], v[22:23], v[192:193], v[132:133] op_sel:[0,0,0] op_sel_hi:[1,0,1]
    v_pk_fma_f32 v[130:131], v[148:149], v[194:195], v[176:177] op_sel:[0,1,0] op_sel_hi:[1,1,1]
    v_pk_fma_f32 v[132:133], v[150:151], v[194:195], v[178:179] op_sel:[0,1,0] op_sel_hi:[1,1,1]
    v_pk_fma_f32 v[48:49], v[48:49], v[194:195], v[130:131] op_sel:[0,0,0] op_sel_hi:[1,0,1]
    v_pk_fma_f32 v[50:51], v[50:51], v[194:195], v[132:133] op_sel:[0,0,0] op_sel_hi:[1,0,1]
    v_pk_fma_f32 v[130:131], v[148:149], v[196:197], v[176:177] op_sel:[0,1,0] op_sel_hi:[1,1,1]
    v_pk_fma_f32 v[132:133], v[150:151], v[196:197], v[178:179] op_sel:[0,1,0] op_sel_hi:[1,1,1]
    v_pk_fma_f32 v[76:77], v[76:77], v[196:197], v[130:131] op_sel:[0,0,0] op_sel_hi:[1,0,1]
    v_pk_fma_f32 v[78:79], v[78:79], v[196:197], v[132:133] op_sel:[0,0,0] op_sel_hi:[1,0,1]
    v_pk_fma_f32 v[130:131], v[148:149], v[198:199], v[176:177] op_sel:[0,1,0] op_sel_hi:[1,1,1]
    v_pk_fma_f32 v[132:133], v[150:151], v[198:199], v[178:179] op_sel:[0,1,0] op_sel_hi:[1,1,1]
    v_pk_fma_f32 v[104:105], v[104:105], v[198:199], v[130:131] op_sel:[0,0,0] op_sel_hi:[1,0,1]
    v_pk_fma_f32 v[106:107], v[106:107], v[198:199], v[132:133] op_sel:[0,0,0] op_sel_hi:[1,0,1]
    v_pk_mul_f32 v[120:121], v[20:21], v[20:21]
    v_pk_mul_f32 v[122:123], v[22:23], v[22:23]
    v_pk_mul_f32 v[124:125], v[48:49], v[48:49]
    v_pk_mul_f32 v[126:127], v[50:51], v[50:51]
    v_pk_fma_f32 v[120:121], v[120:121], s[64:65], v[128:129]
    v_pk_fma_f32 v[122:123], v[122:123], s[64:65], v[128:129]
    v_pk_fma_f32 v[124:125], v[124:125], s[64:65], v[128:129]
    v_pk_fma_f32 v[126:127], v[126:127], s[64:65], v[128:129]
    v_pk_mul_f32 v[120:121], v[120:121], v[20:21]
    v_pk_mul_f32 v[122:123], v[122:123], v[22:23]
    v_pk_mul_f32 v[124:125], v[124:125], v[48:49]
    v_pk_mul_f32 v[126:127], v[126:127], v[50:51]
    v_exp_f32 v120, v120
    v_exp_f32 v121, v121
    v_exp_f32 v122, v122
    v_exp_f32 v123, v123
    v_exp_f32 v124, v124
    v_exp_f32 v125, v125
    v_exp_f32 v126, v126
    v_exp_f32 v127, v127
    v_pk_add_f32 v[120:121], v[120:121], 1.0 op_sel_hi:[1,0]
    v_pk_add_f32 v[122:123], v[122:123], 1.0 op_sel_hi:[1,0]
    v_pk_add_f32 v[124:125], v[124:125], 1.0 op_sel_hi:[1,0]
    v_pk_add_f32 v[126:127], v[126:127], 1.0 op_sel_hi:[1,0]
    v_rcp_f32 v120, v120
    v_rcp_f32 v121, v121
    v_rcp_f32 v122, v122
    v_rcp_f32 v123, v123
    v_rcp_f32 v124, v124
    v_rcp_f32 v125, v125
    v_rcp_f32 v126, v126
    v_rcp_f32 v127, v127
    v_pk_mul_f32 v[20:21], v[20:21], v[120:121]
    v_pk_mul_f32 v[22:23], v[22:23], v[122:123]
    v_pk_mul_f32 v[48:49], v[48:49], v[124:125]
    v_pk_mul_f32 v[50:51], v[50:51], v[126:127]
    v_pk_mul_f32 v[120:121], v[76:77], v[76:77]
    v_pk_mul_f32 v[122:123], v[78:79], v[78:79]
    v_pk_mul_f32 v[124:125], v[104:105], v[104:105]
    v_pk_mul_f32 v[126:127], v[106:107], v[106:107]
    v_pk_fma_f32 v[120:121], v[120:121], s[64:65], v[128:129]
    v_pk_fma_f32 v[122:123], v[122:123], s[64:65], v[128:129]
    v_pk_fma_f32 v[124:125], v[124:125], s[64:65], v[128:129]
    v_pk_fma_f32 v[126:127], v[126:127], s[64:65], v[128:129]
    v_pk_mul_f32 v[120:121], v[120:121], v[76:77]
    v_pk_mul_f32 v[122:123], v[122:123], v[78:79]
    v_pk_mul_f32 v[124:125], v[124:125], v[104:105]
    v_pk_mul_f32 v[126:127], v[126:127], v[106:107]
    v_exp_f32 v120, v120
    v_exp_f32 v121, v121
    v_exp_f32 v122, v122
    v_exp_f32 v123, v123
    v_exp_f32 v124, v124
    v_exp_f32 v125, v125
    v_exp_f32 v126, v126
    v_exp_f32 v127, v127
    v_pk_add_f32 v[120:121], v[120:121], 1.0 op_sel_hi:[1,0]
    v_pk_add_f32 v[122:123], v[122:123], 1.0 op_sel_hi:[1,0]
    v_pk_add_f32 v[124:125], v[124:125], 1.0 op_sel_hi:[1,0]
    v_pk_add_f32 v[126:127], v[126:127], 1.0 op_sel_hi:[1,0]
    v_rcp_f32 v120, v120
    v_rcp_f32 v121, v121
    v_rcp_f32 v122, v122
    v_rcp_f32 v123, v123
    v_rcp_f32 v124, v124
    v_rcp_f32 v125, v125
    v_rcp_f32 v126, v126
    v_rcp_f32 v127, v127
    v_pk_mul_f32 v[76:77], v[76:77], v[120:121]
    v_pk_mul_f32 v[78:79], v[78:79], v[122:123]
    v_pk_mul_f32 v[104:105], v[104:105], v[124:125]
    v_pk_mul_f32 v[106:107], v[106:107], v[126:127]
    v_cvt_pk_bf16_f32 v244, v20, v21
    v_cvt_pk_bf16_f32 v245, v22, v23
    v_cvt_pk_bf16_f32 v246, v48, v49
    v_cvt_pk_bf16_f32 v247, v50, v51
    v_cvt_pk_bf16_f32 v248, v76, v77
    v_cvt_pk_bf16_f32 v249, v78, v79
    v_cvt_pk_bf16_f32 v250, v104, v105
    v_cvt_pk_bf16_f32 v251, v106, v107
    v_permlane16_swap_b32 v244, v246
    v_permlane16_swap_b32 v245, v247
    buffer_store_dwordx4 v[244:247], v212, s[24:27], s68 offen offset:1536 sc1
    s_nop 1
    v_permlane16_swap_b32 v248, v250
    v_permlane16_swap_b32 v249, v251
    buffer_store_dwordx4 v[248:251], v212, s[24:27], s69 offen offset:1536 sc1
    v_pk_fma_f32 v[130:131], v[152:153], v[192:193], v[180:181] op_sel:[0,1,0] op_sel_hi:[1,1,1]
    v_pk_fma_f32 v[132:133], v[154:155], v[192:193], v[182:183] op_sel:[0,1,0] op_sel_hi:[1,1,1]
    v_pk_fma_f32 v[24:25], v[24:25], v[192:193], v[130:131] op_sel:[0,0,0] op_sel_hi:[1,0,1]
    v_pk_fma_f32 v[26:27], v[26:27], v[192:193], v[132:133] op_sel:[0,0,0] op_sel_hi:[1,0,1]
    v_pk_fma_f32 v[130:131], v[152:153], v[194:195], v[180:181] op_sel:[0,1,0] op_sel_hi:[1,1,1]
    v_pk_fma_f32 v[132:133], v[154:155], v[194:195], v[182:183] op_sel:[0,1,0] op_sel_hi:[1,1,1]
    v_pk_fma_f32 v[52:53], v[52:53], v[194:195], v[130:131] op_sel:[0,0,0] op_sel_hi:[1,0,1]
    v_pk_fma_f32 v[54:55], v[54:55], v[194:195], v[132:133] op_sel:[0,0,0] op_sel_hi:[1,0,1]
    v_pk_fma_f32 v[130:131], v[152:153], v[196:197], v[180:181] op_sel:[0,1,0] op_sel_hi:[1,1,1]
    v_pk_fma_f32 v[132:133], v[154:155], v[196:197], v[182:183] op_sel:[0,1,0] op_sel_hi:[1,1,1]
    v_pk_fma_f32 v[80:81], v[80:81], v[196:197], v[130:131] op_sel:[0,0,0] op_sel_hi:[1,0,1]
    v_pk_fma_f32 v[82:83], v[82:83], v[196:197], v[132:133] op_sel:[0,0,0] op_sel_hi:[1,0,1]
    v_pk_fma_f32 v[130:131], v[152:153], v[198:199], v[180:181] op_sel:[0,1,0] op_sel_hi:[1,1,1]
    v_pk_fma_f32 v[132:133], v[154:155], v[198:199], v[182:183] op_sel:[0,1,0] op_sel_hi:[1,1,1]
    v_pk_fma_f32 v[108:109], v[108:109], v[198:199], v[130:131] op_sel:[0,0,0] op_sel_hi:[1,0,1]
    v_pk_fma_f32 v[110:111], v[110:111], v[198:199], v[132:133] op_sel:[0,0,0] op_sel_hi:[1,0,1]
    v_pk_mul_f32 v[120:121], v[24:25], v[24:25]
    v_pk_mul_f32 v[122:123], v[26:27], v[26:27]
    v_pk_mul_f32 v[124:125], v[52:53], v[52:53]
    v_pk_mul_f32 v[126:127], v[54:55], v[54:55]
    v_pk_fma_f32 v[120:121], v[120:121], s[64:65], v[128:129]
    v_pk_fma_f32 v[122:123], v[122:123], s[64:65], v[128:129]
    v_pk_fma_f32 v[124:125], v[124:125], s[64:65], v[128:129]
    v_pk_fma_f32 v[126:127], v[126:127], s[64:65], v[128:129]
    v_pk_mul_f32 v[120:121], v[120:121], v[24:25]
    v_pk_mul_f32 v[122:123], v[122:123], v[26:27]
    v_pk_mul_f32 v[124:125], v[124:125], v[52:53]
    v_pk_mul_f32 v[126:127], v[126:127], v[54:55]
    v_exp_f32 v120, v120
    v_exp_f32 v121, v121
    v_exp_f32 v122, v122
    v_exp_f32 v123, v123
    v_exp_f32 v124, v124
    v_exp_f32 v125, v125
    v_exp_f32 v126, v126
    v_exp_f32 v127, v127
    v_pk_add_f32 v[120:121], v[120:121], 1.0 op_sel_hi:[1,0]
    v_pk_add_f32 v[122:123], v[122:123], 1.0 op_sel_hi:[1,0]
    v_pk_add_f32 v[124:125], v[124:125], 1.0 op_sel_hi:[1,0]
    v_pk_add_f32 v[126:127], v[126:127], 1.0 op_sel_hi:[1,0]
    v_rcp_f32 v120, v120
    v_rcp_f32 v121, v121
    v_rcp_f32 v122, v122
    v_rcp_f32 v123, v123
    v_rcp_f32 v124, v124
    v_rcp_f32 v125, v125
    v_rcp_f32 v126, v126
    v_rcp_f32 v127, v127
    v_pk_mul_f32 v[24:25], v[24:25], v[120:121]
    v_pk_mul_f32 v[26:27], v[26:27], v[122:123]
    v_pk_mul_f32 v[52:53], v[52:53], v[124:125]
    v_pk_mul_f32 v[54:55], v[54:55], v[126:127]
    v_pk_mul_f32 v[120:121], v[80:81], v[80:81]
    v_pk_mul_f32 v[122:123], v[82:83], v[82:83]
    v_pk_mul_f32 v[124:125], v[108:109], v[108:109]
    v_pk_mul_f32 v[126:127], v[110:111], v[110:111]
    v_pk_fma_f32 v[120:121], v[120:121], s[64:65], v[128:129]
    v_pk_fma_f32 v[122:123], v[122:123], s[64:65], v[128:129]
    v_pk_fma_f32 v[124:125], v[124:125], s[64:65], v[128:129]
    v_pk_fma_f32 v[126:127], v[126:127], s[64:65], v[128:129]
    v_pk_mul_f32 v[120:121], v[120:121], v[80:81]
    v_pk_mul_f32 v[122:123], v[122:123], v[82:83]
    v_pk_mul_f32 v[124:125], v[124:125], v[108:109]
    v_pk_mul_f32 v[126:127], v[126:127], v[110:111]
    v_exp_f32 v120, v120
    v_exp_f32 v121, v121
    v_exp_f32 v122, v122
    v_exp_f32 v123, v123
    v_exp_f32 v124, v124
    v_exp_f32 v125, v125
    v_exp_f32 v126, v126
    v_exp_f32 v127, v127
    v_pk_add_f32 v[120:121], v[120:121], 1.0 op_sel_hi:[1,0]
    v_pk_add_f32 v[122:123], v[122:123], 1.0 op_sel_hi:[1,0]
    v_pk_add_f32 v[124:125], v[124:125], 1.0 op_sel_hi:[1,0]
    v_pk_add_f32 v[126:127], v[126:127], 1.0 op_sel_hi:[1,0]
    v_rcp_f32 v120, v120
    v_rcp_f32 v121, v121
    v_rcp_f32 v122, v122
    v_rcp_f32 v123, v123
    v_rcp_f32 v124, v124
    v_rcp_f32 v125, v125
    v_rcp_f32 v126, v126
    v_rcp_f32 v127, v127
    v_pk_mul_f32 v[80:81], v[80:81], v[120:121]
    v_pk_mul_f32 v[82:83], v[82:83], v[122:123]
    v_pk_mul_f32 v[108:109], v[108:109], v[124:125]
    v_pk_mul_f32 v[110:111], v[110:111], v[126:127]
    v_cvt_pk_bf16_f32 v236, v24, v25
    v_cvt_pk_bf16_f32 v237, v26, v27
    v_cvt_pk_bf16_f32 v238, v52, v53
    v_cvt_pk_bf16_f32 v239, v54, v55
    v_cvt_pk_bf16_f32 v240, v80, v81
    v_cvt_pk_bf16_f32 v241, v82, v83
    v_cvt_pk_bf16_f32 v242, v108, v109
    v_cvt_pk_bf16_f32 v243, v110, v111
    v_permlane16_swap_b32 v236, v238
    v_permlane16_swap_b32 v237, v239
    buffer_store_dwordx4 v[236:239], v212, s[24:27], s68 offen offset:2048 sc1
    s_nop 1
    v_permlane16_swap_b32 v240, v242
    v_permlane16_swap_b32 v241, v243
    buffer_store_dwordx4 v[240:243], v212, s[24:27], s69 offen offset:2048 sc1
    v_pk_fma_f32 v[130:131], v[156:157], v[192:193], v[184:185] op_sel:[0,1,0] op_sel_hi:[1,1,1]
    v_pk_fma_f32 v[132:133], v[158:159], v[192:193], v[186:187] op_sel:[0,1,0] op_sel_hi:[1,1,1]
    v_pk_fma_f32 v[28:29], v[28:29], v[192:193], v[130:131] op_sel:[0,0,0] op_sel_hi:[1,0,1]
    v_pk_fma_f32 v[30:31], v[30:31], v[192:193], v[132:133] op_sel:[0,0,0] op_sel_hi:[1,0,1]
    v_pk_fma_f32 v[130:131], v[156:157], v[194:195], v[184:185] op_sel:[0,1,0] op_sel_hi:[1,1,1]
    v_pk_fma_f32 v[132:133], v[158:159], v[194:195], v[186:187] op_sel:[0,1,0] op_sel_hi:[1,1,1]
    v_pk_fma_f32 v[56:57], v[56:57], v[194:195], v[130:131] op_sel:[0,0,0] op_sel_hi:[1,0,1]
    v_pk_fma_f32 v[58:59], v[58:59], v[194:195], v[132:133] op_sel:[0,0,0] op_sel_hi:[1,0,1]
    v_pk_fma_f32 v[130:131], v[156:157], v[196:197], v[184:185] op_sel:[0,1,0] op_sel_hi:[1,1,1]
    v_pk_fma_f32 v[132:133], v[158:159], v[196:197], v[186:187] op_sel:[0,1,0] op_sel_hi:[1,1,1]
    v_pk_fma_f32 v[84:85], v[84:85], v[196:197], v[130:131] op_sel:[0,0,0] op_sel_hi:[1,0,1]
    v_pk_fma_f32 v[86:87], v[86:87], v[196:197], v[132:133] op_sel:[0,0,0] op_sel_hi:[1,0,1]
    v_pk_fma_f32 v[130:131], v[156:157], v[198:199], v[184:185] op_sel:[0,1,0] op_sel_hi:[1,1,1]
    v_pk_fma_f32 v[132:133], v[158:159], v[198:199], v[186:187] op_sel:[0,1,0] op_sel_hi:[1,1,1]
    v_pk_fma_f32 v[112:113], v[112:113], v[198:199], v[130:131] op_sel:[0,0,0] op_sel_hi:[1,0,1]
    v_pk_fma_f32 v[114:115], v[114:115], v[198:199], v[132:133] op_sel:[0,0,0] op_sel_hi:[1,0,1]
    v_pk_mul_f32 v[120:121], v[28:29], v[28:29]
    v_pk_mul_f32 v[122:123], v[30:31], v[30:31]
    v_pk_mul_f32 v[124:125], v[56:57], v[56:57]
    v_pk_mul_f32 v[126:127], v[58:59], v[58:59]
    v_pk_fma_f32 v[120:121], v[120:121], s[64:65], v[128:129]
    v_pk_fma_f32 v[122:123], v[122:123], s[64:65], v[128:129]
    v_pk_fma_f32 v[124:125], v[124:125], s[64:65], v[128:129]
    v_pk_fma_f32 v[126:127], v[126:127], s[64:65], v[128:129]
    v_pk_mul_f32 v[120:121], v[120:121], v[28:29]
    v_pk_mul_f32 v[122:123], v[122:123], v[30:31]
    v_pk_mul_f32 v[124:125], v[124:125], v[56:57]
    v_pk_mul_f32 v[126:127], v[126:127], v[58:59]
    v_exp_f32 v120, v120
    v_exp_f32 v121, v121
    v_exp_f32 v122, v122
    v_exp_f32 v123, v123
    v_exp_f32 v124, v124
    v_exp_f32 v125, v125
    v_exp_f32 v126, v126
    v_exp_f32 v127, v127
    v_pk_add_f32 v[120:121], v[120:121], 1.0 op_sel_hi:[1,0]
    v_pk_add_f32 v[122:123], v[122:123], 1.0 op_sel_hi:[1,0]
    v_pk_add_f32 v[124:125], v[124:125], 1.0 op_sel_hi:[1,0]
    v_pk_add_f32 v[126:127], v[126:127], 1.0 op_sel_hi:[1,0]
    v_rcp_f32 v120, v120
    v_rcp_f32 v121, v121
    v_rcp_f32 v122, v122
    v_rcp_f32 v123, v123
    v_rcp_f32 v124, v124
    v_rcp_f32 v125, v125
    v_rcp_f32 v126, v126
    v_rcp_f32 v127, v127
    v_pk_mul_f32 v[28:29], v[28:29], v[120:121]
    v_pk_mul_f32 v[30:31], v[30:31], v[122:123]
    v_pk_mul_f32 v[56:57], v[56:57], v[124:125]
    v_pk_mul_f32 v[58:59], v[58:59], v[126:127]
    v_pk_mul_f32 v[120:121], v[84:85], v[84:85]
    v_pk_mul_f32 v[122:123], v[86:87], v[86:87]
    v_pk_mul_f32 v[124:125], v[112:113], v[112:113]
    v_pk_mul_f32 v[126:127], v[114:115], v[114:115]
    v_pk_fma_f32 v[120:121], v[120:121], s[64:65], v[128:129]
    v_pk_fma_f32 v[122:123], v[122:123], s[64:65], v[128:129]
    v_pk_fma_f32 v[124:125], v[124:125], s[64:65], v[128:129]
    v_pk_fma_f32 v[126:127], v[126:127], s[64:65], v[128:129]
    v_pk_mul_f32 v[120:121], v[120:121], v[84:85]
    v_pk_mul_f32 v[122:123], v[122:123], v[86:87]
    v_pk_mul_f32 v[124:125], v[124:125], v[112:113]
    v_pk_mul_f32 v[126:127], v[126:127], v[114:115]
    v_exp_f32 v120, v120
    v_exp_f32 v121, v121
    v_exp_f32 v122, v122
    v_exp_f32 v123, v123
    v_exp_f32 v124, v124
    v_exp_f32 v125, v125
    v_exp_f32 v126, v126
    v_exp_f32 v127, v127
    v_pk_add_f32 v[120:121], v[120:121], 1.0 op_sel_hi:[1,0]
    v_pk_add_f32 v[122:123], v[122:123], 1.0 op_sel_hi:[1,0]
    v_pk_add_f32 v[124:125], v[124:125], 1.0 op_sel_hi:[1,0]
    v_pk_add_f32 v[126:127], v[126:127], 1.0 op_sel_hi:[1,0]
    v_rcp_f32 v120, v120
    v_rcp_f32 v121, v121
    v_rcp_f32 v122, v122
    v_rcp_f32 v123, v123
    v_rcp_f32 v124, v124
    v_rcp_f32 v125, v125
    v_rcp_f32 v126, v126
    v_rcp_f32 v127, v127
    v_pk_mul_f32 v[84:85], v[84:85], v[120:121]
    v_pk_mul_f32 v[86:87], v[86:87], v[122:123]
    v_pk_mul_f32 v[112:113], v[112:113], v[124:125]
    v_pk_mul_f32 v[114:115], v[114:115], v[126:127]
    v_cvt_pk_bf16_f32 v244, v28, v29
    v_cvt_pk_bf16_f32 v245, v30, v31
    v_cvt_pk_bf16_f32 v246, v56, v57
    v_cvt_pk_bf16_f32 v247, v58, v59
    v_cvt_pk_bf16_f32 v248, v84, v85
    v_cvt_pk_bf16_f32 v249, v86, v87
    v_cvt_pk_bf16_f32 v250, v112, v113
    v_cvt_pk_bf16_f32 v251, v114, v115
    v_permlane16_swap_b32 v244, v246
    v_permlane16_swap_b32 v245, v247
    buffer_store_dwordx4 v[244:247], v212, s[24:27], s68 offen offset:2560 sc1
    s_nop 1
    v_permlane16_swap_b32 v248, v250
    v_permlane16_swap_b32 v249, v251
    buffer_store_dwordx4 v[248:251], v212, s[24:27], s69 offen offset:2560 sc1
    s_barrier
    v_pk_fma_f32 v[130:131], v[160:161], v[192:193], v[188:189] op_sel:[0,1,0] op_sel_hi:[1,1,1]
    v_pk_fma_f32 v[132:133], v[162:163], v[192:193], v[190:191] op_sel:[0,1,0] op_sel_hi:[1,1,1]
    v_pk_fma_f32 v[32:33], v[32:33], v[192:193], v[130:131] op_sel:[0,0,0] op_sel_hi:[1,0,1]
    v_pk_fma_f32 v[34:35], v[34:35], v[192:193], v[132:133] op_sel:[0,0,0] op_sel_hi:[1,0,1]
    v_pk_fma_f32 v[130:131], v[160:161], v[194:195], v[188:189] op_sel:[0,1,0] op_sel_hi:[1,1,1]
    v_pk_fma_f32 v[132:133], v[162:163], v[194:195], v[190:191] op_sel:[0,1,0] op_sel_hi:[1,1,1]
    v_pk_fma_f32 v[60:61], v[60:61], v[194:195], v[130:131] op_sel:[0,0,0] op_sel_hi:[1,0,1]
    v_pk_fma_f32 v[62:63], v[62:63], v[194:195], v[132:133] op_sel:[0,0,0] op_sel_hi:[1,0,1]
    v_pk_fma_f32 v[130:131], v[160:161], v[196:197], v[188:189] op_sel:[0,1,0] op_sel_hi:[1,1,1]
    v_pk_fma_f32 v[132:133], v[162:163], v[196:197], v[190:191] op_sel:[0,1,0] op_sel_hi:[1,1,1]
    v_pk_fma_f32 v[88:89], v[88:89], v[196:197], v[130:131] op_sel:[0,0,0] op_sel_hi:[1,0,1]
    v_pk_fma_f32 v[90:91], v[90:91], v[196:197], v[132:133] op_sel:[0,0,0] op_sel_hi:[1,0,1]
    v_pk_fma_f32 v[130:131], v[160:161], v[198:199], v[188:189] op_sel:[0,1,0] op_sel_hi:[1,1,1]
    v_pk_fma_f32 v[132:133], v[162:163], v[198:199], v[190:191] op_sel:[0,1,0] op_sel_hi:[1,1,1]
    v_pk_fma_f32 v[116:117], v[116:117], v[198:199], v[130:131] op_sel:[0,0,0] op_sel_hi:[1,0,1]
    v_pk_fma_f32 v[118:119], v[118:119], v[198:199], v[132:133] op_sel:[0,0,0] op_sel_hi:[1,0,1]
    v_pk_mul_f32 v[120:121], v[32:33], v[32:33]
    v_pk_mul_f32 v[122:123], v[34:35], v[34:35]
    v_pk_mul_f32 v[124:125], v[60:61], v[60:61]
    v_pk_mul_f32 v[126:127], v[62:63], v[62:63]
    v_pk_fma_f32 v[120:121], v[120:121], s[64:65], v[128:129]
    v_pk_fma_f32 v[122:123], v[122:123], s[64:65], v[128:129]
    v_pk_fma_f32 v[124:125], v[124:125], s[64:65], v[128:129]
    v_pk_fma_f32 v[126:127], v[126:127], s[64:65], v[128:129]
    v_pk_mul_f32 v[120:121], v[120:121], v[32:33]
    v_pk_mul_f32 v[122:123], v[122:123], v[34:35]
    v_pk_mul_f32 v[124:125], v[124:125], v[60:61]
    v_pk_mul_f32 v[126:127], v[126:127], v[62:63]
    v_exp_f32 v120, v120
    v_exp_f32 v121, v121
    v_exp_f32 v122, v122
    v_exp_f32 v123, v123
    v_exp_f32 v124, v124
    v_exp_f32 v125, v125
    v_exp_f32 v126, v126
    v_exp_f32 v127, v127
    v_pk_add_f32 v[120:121], v[120:121], 1.0 op_sel_hi:[1,0]
    v_pk_add_f32 v[122:123], v[122:123], 1.0 op_sel_hi:[1,0]
    v_pk_add_f32 v[124:125], v[124:125], 1.0 op_sel_hi:[1,0]
    v_pk_add_f32 v[126:127], v[126:127], 1.0 op_sel_hi:[1,0]
    v_rcp_f32 v120, v120
    v_rcp_f32 v121, v121
    v_rcp_f32 v122, v122
    v_rcp_f32 v123, v123
    v_rcp_f32 v124, v124
    v_rcp_f32 v125, v125
    v_rcp_f32 v126, v126
    v_rcp_f32 v127, v127
    v_pk_mul_f32 v[32:33], v[32:33], v[120:121]
    v_pk_mul_f32 v[34:35], v[34:35], v[122:123]
    v_pk_mul_f32 v[60:61], v[60:61], v[124:125]
    v_pk_mul_f32 v[62:63], v[62:63], v[126:127]
    v_pk_mul_f32 v[120:121], v[88:89], v[88:89]
    v_pk_mul_f32 v[122:123], v[90:91], v[90:91]
    v_pk_mul_f32 v[124:125], v[116:117], v[116:117]
    v_pk_mul_f32 v[126:127], v[118:119], v[118:119]
    v_pk_fma_f32 v[120:121], v[120:121], s[64:65], v[128:129]
    v_pk_fma_f32 v[122:123], v[122:123], s[64:65], v[128:129]
    v_pk_fma_f32 v[124:125], v[124:125], s[64:65], v[128:129]
    v_pk_fma_f32 v[126:127], v[126:127], s[64:65], v[128:129]
    v_pk_mul_f32 v[120:121], v[120:121], v[88:89]
    v_pk_mul_f32 v[122:123], v[122:123], v[90:91]
    v_pk_mul_f32 v[124:125], v[124:125], v[116:117]
    v_pk_mul_f32 v[126:127], v[126:127], v[118:119]
    v_exp_f32 v120, v120
    v_exp_f32 v121, v121
    v_exp_f32 v122, v122
    v_exp_f32 v123, v123
    v_exp_f32 v124, v124
    v_exp_f32 v125, v125
    v_exp_f32 v126, v126
    v_exp_f32 v127, v127
    v_pk_add_f32 v[120:121], v[120:121], 1.0 op_sel_hi:[1,0]
    v_pk_add_f32 v[122:123], v[122:123], 1.0 op_sel_hi:[1,0]
    v_pk_add_f32 v[124:125], v[124:125], 1.0 op_sel_hi:[1,0]
    v_pk_add_f32 v[126:127], v[126:127], 1.0 op_sel_hi:[1,0]
    v_rcp_f32 v120, v120
    v_rcp_f32 v121, v121
    v_rcp_f32 v122, v122
    v_rcp_f32 v123, v123
    v_rcp_f32 v124, v124
    v_rcp_f32 v125, v125
    v_rcp_f32 v126, v126
    v_rcp_f32 v127, v127
    v_pk_mul_f32 v[88:89], v[88:89], v[120:121]
    v_pk_mul_f32 v[90:91], v[90:91], v[122:123]
    v_pk_mul_f32 v[116:117], v[116:117], v[124:125]
    v_pk_mul_f32 v[118:119], v[118:119], v[126:127]
    v_cvt_pk_bf16_f32 v236, v32, v33
    v_cvt_pk_bf16_f32 v237, v34, v35
    v_cvt_pk_bf16_f32 v238, v60, v61
    v_cvt_pk_bf16_f32 v239, v62, v63
    v_cvt_pk_bf16_f32 v240, v88, v89
    v_cvt_pk_bf16_f32 v241, v90, v91
    v_cvt_pk_bf16_f32 v242, v116, v117
    v_cvt_pk_bf16_f32 v243, v118, v119
    v_permlane16_swap_b32 v236, v238
    v_permlane16_swap_b32 v237, v239
    buffer_store_dwordx4 v[236:239], v212, s[24:27], s68 offen offset:3072 sc1
    s_nop 1
    v_permlane16_swap_b32 v240, v242
    v_permlane16_swap_b32 v241, v243
    buffer_store_dwordx4 v[240:243], v212, s[24:27], s69 offen offset:3072 sc1
    s_barrier
    ds_read_b64 v[136:137], v217 offset:1024
    ds_read_b64 v[140:141], v217 offset:1152
    ds_read_b64 v[144:145], v217 offset:1280
    ds_read_b64 v[148:149], v217 offset:1408
    s_waitcnt lgkmcnt(0)
    s_barrier
    v_pk_fma_f32 v[8:9], v[8:9], v[136:137], v[136:137] op_sel:[0,0,1] op_sel_hi:[1,0,1]
    v_pk_fma_f32 v[10:11], v[10:11], v[136:137], v[136:137] op_sel:[0,0,1] op_sel_hi:[1,0,1]
    v_pk_fma_f32 v[36:37], v[36:37], v[140:141], v[140:141] op_sel:[0,0,1] op_sel_hi:[1,0,1]
    v_pk_fma_f32 v[38:39], v[38:39], v[140:141], v[140:141] op_sel:[0,0,1] op_sel_hi:[1,0,1]
    v_pk_fma_f32 v[64:65], v[64:65], v[144:145], v[144:145] op_sel:[0,0,1] op_sel_hi:[1,0,1]
    v_pk_fma_f32 v[66:67], v[66:67], v[144:145], v[144:145] op_sel:[0,0,1] op_sel_hi:[1,0,1]
    v_pk_fma_f32 v[92:93], v[92:93], v[148:149], v[148:149] op_sel:[0,0,1] op_sel_hi:[1,0,1]
    v_pk_fma_f32 v[94:95], v[94:95], v[148:149], v[148:149] op_sel:[0,0,1] op_sel_hi:[1,0,1]
    v_pk_fma_f32 v[12:13], v[12:13], v[136:137], v[136:137] op_sel:[0,0,1] op_sel_hi:[1,0,1]
    v_pk_fma_f32 v[14:15], v[14:15], v[136:137], v[136:137] op_sel:[0,0,1] op_sel_hi:[1,0,1]
    v_pk_fma_f32 v[40:41], v[40:41], v[140:141], v[140:141] op_sel:[0,0,1] op_sel_hi:[1,0,1]
    v_pk_fma_f32 v[42:43], v[42:43], v[140:141], v[140:141] op_sel:[0,0,1] op_sel_hi:[1,0,1]
    v_pk_fma_f32 v[68:69], v[68:69], v[144:145], v[144:145] op_sel:[0,0,1] op_sel_hi:[1,0,1]
    v_pk_fma_f32 v[70:71], v[70:71], v[144:145], v[144:145] op_sel:[0,0,1] op_sel_hi:[1,0,1]
    v_pk_fma_f32 v[96:97], v[96:97], v[148:149], v[148:149] op_sel:[0,0,1] op_sel_hi:[1,0,1]
    v_pk_fma_f32 v[98:99], v[98:99], v[148:149], v[148:149] op_sel:[0,0,1] op_sel_hi:[1,0,1]
    v_pk_fma_f32 v[16:17], v[16:17], v[136:137], v[136:137] op_sel:[0,0,1] op_sel_hi:[1,0,1]
    v_pk_fma_f32 v[18:19], v[18:19], v[136:137], v[136:137] op_sel:[0,0,1] op_sel_hi:[1,0,1]
    v_pk_fma_f32 v[44:45], v[44:45], v[140:141], v[140:141] op_sel:[0,0,1] op_sel_hi:[1,0,1]
    v_pk_fma_f32 v[46:47], v[46:47], v[140:141], v[140:141] op_sel:[0,0,1] op_sel_hi:[1,0,1]
    v_pk_fma_f32 v[72:73], v[72:73], v[144:145], v[144:145] op_sel:[0,0,1] op_sel_hi:[1,0,1]
    v_pk_fma_f32 v[74:75], v[74:75], v[144:145], v[144:145] op_sel:[0,0,1] op_sel_hi:[1,0,1]
    v_pk_fma_f32 v[100:101], v[100:101], v[148:149], v[148:149] op_sel:[0,0,1] op_sel_hi:[1,0,1]
    v_pk_fma_f32 v[102:103], v[102:103], v[148:149], v[148:149] op_sel:[0,0,1] op_sel_hi:[1,0,1]
    v_cvt_pk_bf16_f32 v152, v8, v9
    v_cvt_pk_bf16_f32 v153, v10, v11
    v_cvt_pk_bf16_f32 v154, v36, v37
    v_cvt_pk_bf16_f32 v155, v38, v39
    v_cvt_pk_bf16_f32 v156, v64, v65
    v_cvt_pk_bf16_f32 v157, v66, v67
    v_cvt_pk_bf16_f32 v158, v92, v93
    v_cvt_pk_bf16_f32 v159, v94, v95
    v_permlane16_swap_b32 v152, v154
    v_permlane16_swap_b32 v153, v155
    s_add_u32 s71, s70, 262144
    buffer_store_dwordx4 v[152:155], v213, s[40:43], s71 offen offset:0 sc1
    v_cvt_pk_bf16_f32 v160, v12, v13
    v_cvt_pk_bf16_f32 v161, v14, v15
    v_cvt_pk_bf16_f32 v162, v40, v41
    v_cvt_pk_bf16_f32 v163, v42, v43
    v_permlane16_swap_b32 v156, v158
    v_permlane16_swap_b32 v157, v159
    buffer_store_dwordx4 v[156:159], v213, s[40:43], s71 offen offset:1024 sc1
    v_cvt_pk_bf16_f32 v164, v68, v69
    v_cvt_pk_bf16_f32 v165, v70, v71
    v_cvt_pk_bf16_f32 v166, v96, v97
    v_cvt_pk_bf16_f32 v167, v98, v99
    v_permlane16_swap_b32 v160, v162
    v_permlane16_swap_b32 v161, v163
    s_add_u32 s71, s70, 327680
    buffer_store_dwordx4 v[160:163], v213, s[40:43], s71 offen offset:0 sc1
    v_cvt_pk_bf16_f32 v168, v16, v17
    v_cvt_pk_bf16_f32 v169, v18, v19
    v_cvt_pk_bf16_f32 v170, v44, v45
    v_cvt_pk_bf16_f32 v171, v46, v47
    v_permlane16_swap_b32 v164, v166
    v_permlane16_swap_b32 v165, v167
    buffer_store_dwordx4 v[164:167], v213, s[40:43], s71 offen offset:1024 sc1
    v_cvt_pk_bf16_f32 v172, v72, v73
    v_cvt_pk_bf16_f32 v173, v74, v75
    v_cvt_pk_bf16_f32 v174, v100, v101
    v_cvt_pk_bf16_f32 v175, v102, v103
    v_permlane16_swap_b32 v168, v170
    v_permlane16_swap_b32 v169, v171
    s_add_u32 s71, s70, 393216
    buffer_store_dwordx4 v[168:171], v213, s[40:43], s71 offen offset:0 sc1
    s_nop 1
    v_permlane16_swap_b32 v172, v174
    v_permlane16_swap_b32 v173, v175
    buffer_store_dwordx4 v[172:175], v213, s[40:43], s71 offen offset:1024 sc1
adaLN_cond__mha_block__mixer_gmlp__prompt_kernel_w_fin:
    s_mov_b32 s21, s4
    s_add_u32 s20, s5, 64
    s_mul_i32 s20, s20, 4352
    s_lshl_b32 s21, s21, 7
    s_add_u32 s20, s20, s21
    v_mov_b32 v2, s101
    v_mov_b32 v3, 0
    s_cmp_eq_u32 s3, 0
    s_waitcnt vmcnt(0)
    s_barrier
    s_cbranch_scc0 sig_4
    s_mov_b64 exec, 1
    buffer_store_dword v2, v3, s[96:99], s20 offen sc1
    s_mov_b64 exec, -1
sig_4:
    s_and_b32 s20, s2, 7
    s_lshr_b32 s21, s2, 3
    s_and_b32 s4, s20, 3
    s_lshl_b32 s4, s4, 2
    s_and_b32 s22, s21, 3
    s_add_u32 s4, s4, s22
    s_lshr_b32 s5, s20, 2
    s_mul_i32 s5, s5, 8
    s_lshr_b32 s22, s21, 2
    s_add_u32 s5, s5, s22
    s_cmp_eq_u32 s3, 0
    s_cbranch_scc0 adaLN_cond__mha_block__mixer_gmlp__prompt_kernel_s_np
    s_add_u32 s20, s5, 64
    s_mul_i32 s20, s20, 4352
    v_and_b32 v2, 63, v0
    v_lshlrev_b32 v2, 7, v2
    s_bfm_b64 exec, 16, 0
    s_mov_b32 s19, 0x80000
adaLN_cond__mha_block__mixer_gmlp__prompt_kernel_s_dp:
    buffer_load_dword v240, v2, s[96:99], s20 offen sc1
    s_waitcnt vmcnt(0)
    v_cmp_ne_u32 vcc, s101, v240
    s_sub_u32 s19, s19, 1
    s_cmp_eq_u32 s19, 0
    s_cbranch_scc1 adaLN_cond__mha_block__mixer_gmlp__prompt_kernel_s_dp_d
    s_cbranch_vccz adaLN_cond__mha_block__mixer_gmlp__prompt_kernel_s_dp_d
    s_sleep 4
    s_branch adaLN_cond__mha_block__mixer_gmlp__prompt_kernel_s_dp
adaLN_cond__mha_block__mixer_gmlp__prompt_kernel_s_dp_d:
    s_mov_b64 exec, -1
adaLN_cond__mha_block__mixer_gmlp__prompt_kernel_s_np:
    s_barrier
    v_and_b32 v1, 63, v0
    s_and_b32 s6, s3, 1
    s_lshr_b32 s7, s3, 1
    v_and_b32 v2, 15, v1
    v_lshrrev_b32 v3, 4, v1
    v_lshrrev_b32 v4, 1, v2
    v_xor_b32 v3, v3, v4
    v_lshlrev_b32 v3, 4, v3
    v_lshl_add_u32 v136, v2, 7, v3
    s_lshl_b32 s20, s6, 13
    s_lshl_b32 s22, s7, 12
    s_add_u32 s20, s20, s22
    v_add_u32 v136, s20, v136
    v_bfe_u32 v2, v1, 2, 3
    v_lshrrev_b32 v3, 5, v1
    v_lshl_add_u32 v2, v3, 4, v2
    v_and_b32 v3, 3, v1
    v_lshlrev_b32 v3, 3, v3
    v_lshl_add_u32 v140, v2, 5, v3
    s_mov_b32 s20, 16384
    v_add_u32 v140, s20, v140
    v_mov_b32 v8, 0
    v_mov_b32 v9, 0
    v_mov_b32 v10, 0
    v_mov_b32 v11, 0
    v_mov_b32 v12, 0
    v_mov_b32 v13, 0
    v_mov_b32 v14, 0
    v_mov_b32 v15, 0
    v_mov_b32 v16, 0
    v_mov_b32 v17, 0
    v_mov_b32 v18, 0
    v_mov_b32 v19, 0
    v_mov_b32 v20, 0
    v_mov_b32 v21, 0
    v_mov_b32 v22, 0
    v_mov_b32 v23, 0
    v_mov_b32 v24, 0
    v_mov_b32 v25, 0
    v_mov_b32 v26, 0
    v_mov_b32 v27, 0
    v_mov_b32 v28, 0
    v_mov_b32 v29, 0
    v_mov_b32 v30, 0
    v_mov_b32 v31, 0
    v_mov_b32 v32, 0
    v_mov_b32 v33, 0
    v_mov_b32 v34, 0
    v_mov_b32 v35, 0
    v_mov_b32 v36, 0
    v_mov_b32 v37, 0
    v_mov_b32 v38, 0
    v_mov_b32 v39, 0
    v_mov_b32 v40, 0
    v_mov_b32 v41, 0
    v_mov_b32 v42, 0
    v_mov_b32 v43, 0
    v_mov_b32 v44, 0
    v_mov_b32 v45, 0
    v_mov_b32 v46, 0
    v_mov_b32 v47, 0
    v_mov_b32 v48, 0
    v_mov_b32 v49, 0
    v_mov_b32 v50, 0
    v_mov_b32 v51, 0
    v_mov_b32 v52, 0
    v_mov_b32 v53, 0
    v_mov_b32 v54, 0
    v_mov_b32 v55, 0
    v_mov_b32 v56, 0
    v_mov_b32 v57, 0
    v_mov_b32 v58, 0
    v_mov_b32 v59, 0
    v_mov_b32 v60, 0
    v_mov_b32 v61, 0
    v_mov_b32 v62, 0
    v_mov_b32 v63, 0
    s_add_u32 s40, s36, 2097152
    s_addc_u32 s41, s37, 0
    s_mov_b32 s42, 7340032
    s_mov_b32 s43, 0x20000
    s_lshl_b32 s56, s4, 7
    s_lshl_b32 s20, s6, 6
    s_add_u32 s56, s56, s20
    s_lshl_b32 s20, s7, 5
    s_add_u32 s56, s56, s20
    s_lshr_b32 s57, s56, 4
    s_mul_i32 s57, s57, 224
    s_mul_i32 s20, s5, 14
    s_add_u32 s57, s57, s20
    s_lshl_b32 s57, s57, 8
    s_add_u32 s58, s57, 57344
    v_and_b32 v2, 15, v1
    v_lshlrev_b32 v173, 4, v2
    v_bfe_u32 v3, v1, 4, 1
    v_lshl_add_u32 v173, v3, 3, v173
    v_lshrrev_b32 v3, 5, v1
    v_lshl_add_u32 v173, v3, 8, v173
    s_lshl_b32 s20, s6, 2
    s_lshl_b32 s21, s7, 1
    s_add_u32 s20, s20, s21
    s_mul_i32 s21, s20, 3584
    s_add_u32 s21, s21, 61440
    v_add_u32 v173, s21, v173
    s_lshl_b32 s20, s20, 5
    s_add_u32 s20, s20, 90112
    v_lshl_add_u32 v174, v2, 1, s20
    v_bfe_u32 v172, v1, 4, 1
    v_mul_u32_u24 v172, 57344, v172
    v_lshrrev_b32 v3, 5, v1
    v_lshl_add_u32 v172, v3, 8, v172
    v_and_b32 v3, 15, v1
    v_lshl_add_u32 v172, v3, 4, v172
    s_setprio 1
    s_mov_b32 s18, 0
    v_add_u32 v137, s18, v136
    v_xor_b32 v138, 64, v137
    v_add_u32 v141, s18, v140
    s_barrier
    ds_read_b128 v[64:67], v137 offset:0
    ds_read_b128 v[68:71], v137 offset:2048
    ds_read_b64_tr_b16 v[72:73], v141 offset:0
    ds_read_b64_tr_b16 v[74:75], v141 offset:256
    ds_read_b64_tr_b16 v[76:77], v141 offset:2048
    ds_read_b64_tr_b16 v[78:79], v141 offset:2304
    ds_read_b64_tr_b16 v[80:81], v141 offset:4096
    ds_read_b64_tr_b16 v[82:83], v141 offset:4352
    ds_read_b64_tr_b16 v[84:85], v141 offset:6144
    ds_read_b64_tr_b16 v[86:87], v141 offset:6400
    ds_read_b64_tr_b16 v[88:89], v141 offset:8192
    ds_read_b64_tr_b16 v[90:91], v141 offset:8448
    ds_read_b64_tr_b16 v[92:93], v141 offset:10240
    ds_read_b64_tr_b16 v[94:95], v141 offset:10496
    ds_read_b64_tr_b16 v[96:97], v141 offset:12288
    ds_read_b64_tr_b16 v[98:99], v141 offset:12544
    s_mov_b32 s19, 32
    s_waitcnt lgkmcnt(0)
.p2align 6
adaLN_cond__mha_block__mixer_gmlp__prompt_kernel_s_c_loop:
    v_mfma_f32_16x16x32_bf16 v[8:11], v[72:75], v[64:67], v[8:11]
    ds_read_b128 v[100:103], v138 offset:0
    ds_read_b128 v[104:107], v138 offset:2048
    v_mfma_f32_16x16x32_bf16 v[36:39], v[72:75], v[68:71], v[36:39]
    ds_read_b64_tr_b16 v[108:109], v141 offset:1024
    ds_read_b64_tr_b16 v[110:111], v141 offset:1280
    v_mfma_f32_16x16x32_bf16 v[12:15], v[76:79], v[64:67], v[12:15]
    ds_read_b64_tr_b16 v[112:113], v141 offset:3072
    ds_read_b64_tr_b16 v[114:115], v141 offset:3328
    v_mfma_f32_16x16x32_bf16 v[40:43], v[76:79], v[68:71], v[40:43]
    ds_read_b64_tr_b16 v[116:117], v141 offset:5120
    ds_read_b64_tr_b16 v[118:119], v141 offset:5376
    v_mfma_f32_16x16x32_bf16 v[16:19], v[80:83], v[64:67], v[16:19]
    ds_read_b64_tr_b16 v[120:121], v141 offset:7168
    ds_read_b64_tr_b16 v[122:123], v141 offset:7424
    v_mfma_f32_16x16x32_bf16 v[44:47], v[80:83], v[68:71], v[44:47]
    ds_read_b64_tr_b16 v[124:125], v141 offset:9216
    ds_read_b64_tr_b16 v[126:127], v141 offset:9472
    v_mfma_f32_16x16x32_bf16 v[20:23], v[84:87], v[64:67], v[20:23]
    ds_read_b64_tr_b16 v[128:129], v141 offset:11264
    ds_read_b64_tr_b16 v[130:131], v141 offset:11520
    v_mfma_f32_16x16x32_bf16 v[48:51], v[84:87], v[68:71], v[48:51]
    ds_read_b64_tr_b16 v[132:133], v141 offset:13312
    ds_read_b64_tr_b16 v[134:135], v141 offset:13568
    v_mfma_f32_16x16x32_bf16 v[24:27], v[88:91], v[64:67], v[24:27]
    s_add_u32 s18, s18, 30720
    s_cmp_ge_u32 s18, 153600
    v_mfma_f32_16x16x32_bf16 v[52:55], v[88:91], v[68:71], v[52:55]
    s_cselect_b32 s18, 0, s18
    v_add_u32 v137, s18, v136
    v_mfma_f32_16x16x32_bf16 v[28:31], v[92:95], v[64:67], v[28:31]
    v_xor_b32 v138, 64, v137
    v_add_u32 v141, s18, v140
    v_mfma_f32_16x16x32_bf16 v[56:59], v[92:95], v[68:71], v[56:59]
    v_mfma_f32_16x16x32_bf16 v[32:35], v[96:99], v[64:67], v[32:35]
    v_mfma_f32_16x16x32_bf16 v[60:63], v[96:99], v[68:71], v[60:63]
    s_waitcnt lgkmcnt(0)
    s_barrier
    v_mfma_f32_16x16x32_bf16 v[8:11], v[108:111], v[100:103], v[8:11]
    ds_read_b128 v[64:67], v137 offset:0
    ds_read_b128 v[68:71], v137 offset:2048
    v_mfma_f32_16x16x32_bf16 v[36:39], v[108:111], v[104:107], v[36:39]
    ds_read_b64_tr_b16 v[72:73], v141 offset:0
    ds_read_b64_tr_b16 v[74:75], v141 offset:256
    v_mfma_f32_16x16x32_bf16 v[12:15], v[112:115], v[100:103], v[12:15]
    ds_read_b64_tr_b16 v[76:77], v141 offset:2048
    ds_read_b64_tr_b16 v[78:79], v141 offset:2304
    v_mfma_f32_16x16x32_bf16 v[40:43], v[112:115], v[104:107], v[40:43]
    ds_read_b64_tr_b16 v[80:81], v141 offset:4096
    ds_read_b64_tr_b16 v[82:83], v141 offset:4352
    v_mfma_f32_16x16x32_bf16 v[16:19], v[116:119], v[100:103], v[16:19]
    ds_read_b64_tr_b16 v[84:85], v141 offset:6144
    ds_read_b64_tr_b16 v[86:87], v141 offset:6400
    v_mfma_f32_16x16x32_bf16 v[44:47], v[116:119], v[104:107], v[44:47]
    ds_read_b64_tr_b16 v[88:89], v141 offset:8192
    ds_read_b64_tr_b16 v[90:91], v141 offset:8448
    v_mfma_f32_16x16x32_bf16 v[20:23], v[120:123], v[100:103], v[20:23]
    ds_read_b64_tr_b16 v[92:93], v141 offset:10240
    ds_read_b64_tr_b16 v[94:95], v141 offset:10496
    v_mfma_f32_16x16x32_bf16 v[48:51], v[120:123], v[104:107], v[48:51]
    ds_read_b64_tr_b16 v[96:97], v141 offset:12288
    ds_read_b64_tr_b16 v[98:99], v141 offset:12544
    v_mfma_f32_16x16x32_bf16 v[24:27], v[124:127], v[100:103], v[24:27]
    s_sub_u32 s19, s19, 1
    s_cmp_lg_u32 s19, 0
    v_mfma_f32_16x16x32_bf16 v[52:55], v[124:127], v[104:107], v[52:55]
    v_mfma_f32_16x16x32_bf16 v[28:31], v[128:131], v[100:103], v[28:31]
    v_mfma_f32_16x16x32_bf16 v[56:59], v[128:131], v[104:107], v[56:59]
    v_mfma_f32_16x16x32_bf16 v[32:35], v[132:135], v[100:103], v[32:35]
    v_mfma_f32_16x16x32_bf16 v[60:63], v[132:135], v[104:107], v[60:63]
    s_waitcnt lgkmcnt(0)
    s_cbranch_scc1 adaLN_cond__mha_block__mixer_gmlp__prompt_kernel_s_c_loop
    s_nop 7
    ds_read_b64 v[142:143], v173 offset:0
    ds_read_b64 v[144:145], v173 offset:512
    ds_read_b64 v[146:147], v173 offset:1024
    ds_read_b64 v[148:149], v173 offset:1536
    ds_read_b64 v[150:151], v173 offset:2048
    ds_read_b64 v[152:153], v173 offset:2560
    ds_read_b64 v[154:155], v173 offset:3072
    ds_read_b64 v[156:157], v173 offset:3584
    ds_read_b64 v[158:159], v173 offset:4096
    ds_read_b64 v[160:161], v173 offset:4608
    ds_read_b64 v[162:163], v173 offset:5120
    ds_read_b64 v[164:165], v173 offset:5632
    ds_read_b64 v[166:167], v173 offset:6144
    ds_read_b64 v[168:169], v173 offset:6656
    s_waitcnt lgkmcnt(8)
    ds_read_u16 v170, v174 offset:0
    ds_read_u16 v171, v174 offset:32
    s_waitcnt lgkmcnt(0)
    s_barrier
    v_lshlrev_b32 v170, 16, v170
    v_lshlrev_b32 v171, 16, v171
    v_lshlrev_b32 v2, 16, v142
    v_and_b32 v3, 0xffff0000, v142
    v_pk_add_f32 v[8:9], v[8:9], v[170:171] op_sel:[0,0] op_sel_hi:[1,0]
    v_pk_mul_f32 v[8:9], v[8:9], v[2:3]
    v_lshlrev_b32 v2, 16, v143
    v_and_b32 v3, 0xffff0000, v143
    v_pk_add_f32 v[10:11], v[10:11], v[170:171] op_sel:[0,0] op_sel_hi:[1,0]
    v_pk_mul_f32 v[10:11], v[10:11], v[2:3]
    v_lshlrev_b32 v2, 16, v144
    v_and_b32 v3, 0xffff0000, v144
    v_pk_add_f32 v[12:13], v[12:13], v[170:171] op_sel:[0,0] op_sel_hi:[1,0]
    v_pk_mul_f32 v[12:13], v[12:13], v[2:3]
    v_lshlrev_b32 v2, 16, v145
    v_and_b32 v3, 0xffff0000, v145
    v_pk_add_f32 v[14:15], v[14:15], v[170:171] op_sel:[0,0] op_sel_hi:[1,0]
    v_pk_mul_f32 v[14:15], v[14:15], v[2:3]
    v_lshlrev_b32 v2, 16, v146
    v_and_b32 v3, 0xffff0000, v146
    v_pk_add_f32 v[16:17], v[16:17], v[170:171] op_sel:[0,0] op_sel_hi:[1,0]
    v_pk_mul_f32 v[16:17], v[16:17], v[2:3]
    v_lshlrev_b32 v2, 16, v147
    v_and_b32 v3, 0xffff0000, v147
    v_pk_add_f32 v[18:19], v[18:19], v[170:171] op_sel:[0,0] op_sel_hi:[1,0]
    v_pk_mul_f32 v[18:19], v[18:19], v[2:3]
    v_lshlrev_b32 v2, 16, v148
    v_and_b32 v3, 0xffff0000, v148
    v_pk_add_f32 v[20:21], v[20:21], v[170:171] op_sel:[0,0] op_sel_hi:[1,0]
    v_pk_mul_f32 v[20:21], v[20:21], v[2:3]
    v_lshlrev_b32 v2, 16, v149
    v_and_b32 v3, 0xffff0000, v149
    v_pk_add_f32 v[22:23], v[22:23], v[170:171] op_sel:[0,0] op_sel_hi:[1,0]
    v_pk_mul_f32 v[22:23], v[22:23], v[2:3]
    v_lshlrev_b32 v2, 16, v150
    v_and_b32 v3, 0xffff0000, v150
    v_pk_add_f32 v[24:25], v[24:25], v[170:171] op_sel:[0,0] op_sel_hi:[1,0]
    v_pk_mul_f32 v[24:25], v[24:25], v[2:3]
    v_lshlrev_b32 v2, 16, v151
    v_and_b32 v3, 0xffff0000, v151
    v_pk_add_f32 v[26:27], v[26:27], v[170:171] op_sel:[0,0] op_sel_hi:[1,0]
    v_pk_mul_f32 v[26:27], v[26:27], v[2:3]
    v_lshlrev_b32 v2, 16, v152
    v_and_b32 v3, 0xffff0000, v152
    v_pk_add_f32 v[28:29], v[28:29], v[170:171] op_sel:[0,0] op_sel_hi:[1,0]
    v_pk_mul_f32 v[28:29], v[28:29], v[2:3]
    v_lshlrev_b32 v2, 16, v153
    v_and_b32 v3, 0xffff0000, v153
    v_pk_add_f32 v[30:31], v[30:31], v[170:171] op_sel:[0,0] op_sel_hi:[1,0]
    v_pk_mul_f32 v[30:31], v[30:31], v[2:3]
    v_lshlrev_b32 v2, 16, v154
    v_and_b32 v3, 0xffff0000, v154
    v_pk_add_f32 v[32:33], v[32:33], v[170:171] op_sel:[0,0] op_sel_hi:[1,0]
    v_pk_mul_f32 v[32:33], v[32:33], v[2:3]
    v_lshlrev_b32 v2, 16, v155
    v_and_b32 v3, 0xffff0000, v155
    v_pk_add_f32 v[34:35], v[34:35], v[170:171] op_sel:[0,0] op_sel_hi:[1,0]
    v_pk_mul_f32 v[34:35], v[34:35], v[2:3]
    v_lshlrev_b32 v2, 16, v156
    v_and_b32 v3, 0xffff0000, v156
    v_pk_add_f32 v[36:37], v[36:37], v[170:171] op_sel:[0,1] op_sel_hi:[1,1]
    v_pk_mul_f32 v[36:37], v[36:37], v[2:3]
    v_lshlrev_b32 v2, 16, v157
    v_and_b32 v3, 0xffff0000, v157
    v_pk_add_f32 v[38:39], v[38:39], v[170:171] op_sel:[0,1] op_sel_hi:[1,1]
    v_pk_mul_f32 v[38:39], v[38:39], v[2:3]
    v_lshlrev_b32 v2, 16, v158
    v_and_b32 v3, 0xffff0000, v158
    v_pk_add_f32 v[40:41], v[40:41], v[170:171] op_sel:[0,1] op_sel_hi:[1,1]
    v_pk_mul_f32 v[40:41], v[40:41], v[2:3]
    v_lshlrev_b32 v2, 16, v159
    v_and_b32 v3, 0xffff0000, v159
    v_pk_add_f32 v[42:43], v[42:43], v[170:171] op_sel:[0,1] op_sel_hi:[1,1]
    v_pk_mul_f32 v[42:43], v[42:43], v[2:3]
    v_lshlrev_b32 v2, 16, v160
    v_and_b32 v3, 0xffff0000, v160
    v_pk_add_f32 v[44:45], v[44:45], v[170:171] op_sel:[0,1] op_sel_hi:[1,1]
    v_pk_mul_f32 v[44:45], v[44:45], v[2:3]
    v_lshlrev_b32 v2, 16, v161
    v_and_b32 v3, 0xffff0000, v161
    v_pk_add_f32 v[46:47], v[46:47], v[170:171] op_sel:[0,1] op_sel_hi:[1,1]
    v_pk_mul_f32 v[46:47], v[46:47], v[2:3]
    v_lshlrev_b32 v2, 16, v162
    v_and_b32 v3, 0xffff0000, v162
    v_pk_add_f32 v[48:49], v[48:49], v[170:171] op_sel:[0,1] op_sel_hi:[1,1]
    v_pk_mul_f32 v[48:49], v[48:49], v[2:3]
    v_lshlrev_b32 v2, 16, v163
    v_and_b32 v3, 0xffff0000, v163
    v_pk_add_f32 v[50:51], v[50:51], v[170:171] op_sel:[0,1] op_sel_hi:[1,1]
    v_pk_mul_f32 v[50:51], v[50:51], v[2:3]
    v_lshlrev_b32 v2, 16, v164
    v_and_b32 v3, 0xffff0000, v164
    v_pk_add_f32 v[52:53], v[52:53], v[170:171] op_sel:[0,1] op_sel_hi:[1,1]
    v_pk_mul_f32 v[52:53], v[52:53], v[2:3]
    v_lshlrev_b32 v2, 16, v165
    v_and_b32 v3, 0xffff0000, v165
    v_pk_add_f32 v[54:55], v[54:55], v[170:171] op_sel:[0,1] op_sel_hi:[1,1]
    v_pk_mul_f32 v[54:55], v[54:55], v[2:3]
    v_lshlrev_b32 v2, 16, v166
    v_and_b32 v3, 0xffff0000, v166
    v_pk_add_f32 v[56:57], v[56:57], v[170:171] op_sel:[0,1] op_sel_hi:[1,1]
    v_pk_mul_f32 v[56:57], v[56:57], v[2:3]
    v_lshlrev_b32 v2, 16, v167
    v_and_b32 v3, 0xffff0000, v167
    v_pk_add_f32 v[58:59], v[58:59], v[170:171] op_sel:[0,1] op_sel_hi:[1,1]
    v_pk_mul_f32 v[58:59], v[58:59], v[2:3]
    v_lshlrev_b32 v2, 16, v168
    v_and_b32 v3, 0xffff0000, v168
    v_pk_add_f32 v[60:61], v[60:61], v[170:171] op_sel:[0,1] op_sel_hi:[1,1]
    v_pk_mul_f32 v[60:61], v[60:61], v[2:3]
    v_lshlrev_b32 v2, 16, v169
    v_and_b32 v3, 0xffff0000, v169
    v_pk_add_f32 v[62:63], v[62:63], v[170:171] op_sel:[0,1] op_sel_hi:[1,1]
    v_pk_mul_f32 v[62:63], v[62:63], v[2:3]
    v_cvt_pk_bf16_f32 v64, v8, v9
    v_cvt_pk_bf16_f32 v65, v10, v11
    v_cvt_pk_bf16_f32 v66, v36, v37
    v_cvt_pk_bf16_f32 v67, v38, v39
    v_cvt_pk_bf16_f32 v68, v12, v13
    v_cvt_pk_bf16_f32 v69, v14, v15
    v_cvt_pk_bf16_f32 v70, v40, v41
    v_cvt_pk_bf16_f32 v71, v42, v43
    v_permlane16_swap_b32 v64, v66
    v_permlane16_swap_b32 v65, v67
    buffer_store_dwordx4 v[64:67], v172, s[40:43], s57 offen offset:0 sc1
    v_cvt_pk_bf16_f32 v72, v16, v17
    v_cvt_pk_bf16_f32 v73, v18, v19
    v_cvt_pk_bf16_f32 v74, v44, v45
    v_cvt_pk_bf16_f32 v75, v46, v47
    v_permlane16_swap_b32 v68, v70
    v_permlane16_swap_b32 v69, v71
    buffer_store_dwordx4 v[68:71], v172, s[40:43], s57 offen offset:512 sc1
    v_cvt_pk_bf16_f32 v76, v20, v21
    v_cvt_pk_bf16_f32 v77, v22, v23
    v_cvt_pk_bf16_f32 v78, v48, v49
    v_cvt_pk_bf16_f32 v79, v50, v51
    v_permlane16_swap_b32 v72, v74
    v_permlane16_swap_b32 v73, v75
    buffer_store_dwordx4 v[72:75], v172, s[40:43], s57 offen offset:1024 sc1
    v_cvt_pk_bf16_f32 v80, v24, v25
    v_cvt_pk_bf16_f32 v81, v26, v27
    v_cvt_pk_bf16_f32 v82, v52, v53
    v_cvt_pk_bf16_f32 v83, v54, v55
    v_permlane16_swap_b32 v76, v78
    v_permlane16_swap_b32 v77, v79
    buffer_store_dwordx4 v[76:79], v172, s[40:43], s57 offen offset:1536 sc1
    v_cvt_pk_bf16_f32 v84, v28, v29
    v_cvt_pk_bf16_f32 v85, v30, v31
    v_cvt_pk_bf16_f32 v86, v56, v57
    v_cvt_pk_bf16_f32 v87, v58, v59
    v_permlane16_swap_b32 v80, v82
    v_permlane16_swap_b32 v81, v83
    buffer_store_dwordx4 v[80:83], v172, s[40:43], s57 offen offset:2048 sc1
    v_cvt_pk_bf16_f32 v88, v32, v33
    v_cvt_pk_bf16_f32 v89, v34, v35
    v_cvt_pk_bf16_f32 v90, v60, v61
    v_cvt_pk_bf16_f32 v91, v62, v63
    v_permlane16_swap_b32 v84, v86
    v_permlane16_swap_b32 v85, v87
    buffer_store_dwordx4 v[84:87], v172, s[40:43], s57 offen offset:2560 sc1
    s_nop 1
    v_permlane16_swap_b32 v88, v90
    v_permlane16_swap_b32 v89, v91
    buffer_store_dwordx4 v[88:91], v172, s[40:43], s57 offen offset:3072 sc1
    s_mov_b32 s21, s5
    s_add_u32 s20, s4, 80
    s_mul_i32 s20, s20, 4352
    s_lshl_b32 s21, s21, 7
    s_add_u32 s20, s20, s21
    v_mov_b32 v2, s101
    v_mov_b32 v3, 0
    s_cmp_eq_u32 s3, 0
    s_waitcnt vmcnt(0)
    s_barrier
    s_cbranch_scc0 sig_5
    s_mov_b64 exec, 1
    buffer_store_dword v2, v3, s[96:99], s20 offen sc1
    s_mov_b64 exec, -1
sig_5:
    s_and_b32 s20, s2, 7
    s_lshr_b32 s21, s2, 3
    s_and_b32 s4, s20, 3
    s_lshl_b32 s4, s4, 3
    s_and_b32 s22, s21, 7
    s_add_u32 s4, s4, s22
    s_lshr_b32 s5, s20, 2
    s_mul_i32 s5, s5, 4
    s_lshr_b32 s22, s21, 3
    s_add_u32 s5, s5, s22
    s_cmp_eq_u32 s3, 0
    s_cbranch_scc0 adaLN_cond__mha_block__mixer_gmlp__prompt_kernel_o_np
    s_lshr_b32 s20, s4, 1
    s_add_u32 s20, s20, 80
    s_mul_i32 s20, s20, 4352
    v_and_b32 v2, 63, v0
    v_lshlrev_b32 v2, 7, v2
    s_bfm_b64 exec, 16, 0
    s_mov_b32 s19, 0x80000
adaLN_cond__mha_block__mixer_gmlp__prompt_kernel_o_dp:
    buffer_load_dword v240, v2, s[96:99], s20 offen sc1
    s_waitcnt vmcnt(0)
    v_cmp_ne_u32 vcc, s101, v240
    s_sub_u32 s19, s19, 1
    s_cmp_eq_u32 s19, 0
    s_cbranch_scc1 adaLN_cond__mha_block__mixer_gmlp__prompt_kernel_o_dp_d
    s_cbranch_vccz adaLN_cond__mha_block__mixer_gmlp__prompt_kernel_o_dp_d
    s_sleep 4
    s_branch adaLN_cond__mha_block__mixer_gmlp__prompt_kernel_o_dp
adaLN_cond__mha_block__mixer_gmlp__prompt_kernel_o_dp_d:
    s_mov_b64 exec, -1
adaLN_cond__mha_block__mixer_gmlp__prompt_kernel_o_np:
    s_barrier
    v_and_b32 v1, 63, v0
    s_and_b32 s6, s3, 1
    s_lshr_b32 s7, s3, 1
    v_lshlrev_b32 v88, 4, v1
    s_lshl_b32 s20, s7, 12
    v_add_u32 v88, s20, v88
    v_lshlrev_b32 v90, 4, v1
    s_mov_b32 s20, 8192
    s_mul_i32 s22, s6, 8192
    s_add_u32 s20, s20, s22
    v_add_u32 v90, s20, v90
    v_mov_b32 v8, 0
    v_mov_b32 v9, 0
    v_mov_b32 v10, 0
    v_mov_b32 v11, 0
    v_mov_b32 v12, 0
    v_mov_b32 v13, 0
    v_mov_b32 v14, 0
    v_mov_b32 v15, 0
    v_mov_b32 v16, 0
    v_mov_b32 v17, 0
    v_mov_b32 v18, 0
    v_mov_b32 v19, 0
    v_mov_b32 v20, 0
    v_mov_b32 v21, 0
    v_mov_b32 v22, 0
    v_mov_b32 v23, 0
    v_mov_b32 v24, 0
    v_mov_b32 v25, 0
    v_mov_b32 v26, 0
    v_mov_b32 v27, 0
    v_mov_b32 v28, 0
    v_mov_b32 v29, 0
    v_mov_b32 v30, 0
    v_mov_b32 v31, 0
    v_mov_b32 v32, 0
    v_mov_b32 v33, 0
    v_mov_b32 v34, 0
    v_mov_b32 v35, 0
    v_mov_b32 v36, 0
    v_mov_b32 v37, 0
    v_mov_b32 v38, 0
    v_mov_b32 v39, 0
    s_mov_b32 s24, s92
    s_mov_b32 s25, s93
    s_mov_b32 s26, 4194304
    s_mov_b32 s27, 0x20000
    s_lshl_b32 s56, s4, 6
    s_lshl_b32 s20, s7, 5
    s_add_u32 s56, s56, s20
    s_lshl_b32 s57, s5, 7
    s_lshl_b32 s20, s6, 6
    s_add_u32 s57, s57, s20
    s_lshl_b32 s62, s56, 11
    s_lshl_b32 s20, s57, 5
    s_add_u32 s60, s62, s20
    s_add_u32 s61, s60, 32768
    s_lshl_b32 s20, s57, 1
    s_add_u32 s62, s62, s20
    s_add_u32 s63, s62, 32768
    v_and_b32 v2, 15, v1
    v_lshlrev_b32 v125, 4, v2
    v_bfe_u32 v3, v1, 4, 1
    v_lshl_add_u32 v125, v3, 3, v125
    v_lshlrev_b32 v124, 11, v2
    v_lshl_add_u32 v124, v3, 5, v124
    v_lshrrev_b32 v3, 5, v1
    v_lshl_add_u32 v125, v3, 8, v125
    v_lshl_add_u32 v124, v3, 4, v124
    s_lshl_b32 s20, s7, 13
    s_lshl_b32 s21, s6, 11
    s_add_u32 s20, s20, s21
    s_add_u32 s20, s20, 98304
    v_add_u32 v125, s20, v125
    v_lshrrev_b32 v3, 4, v1
    s_lshl_b32 s20, s6, 8
    s_add_u32 s20, s20, 114688
    v_lshl_add_u32 v126, v3, 4, s20
    s_setprio 1
    s_mov_b32 s18, 0
    v_add_u32 v89, s18, v88
    v_add_u32 v91, s18, v90
    s_barrier
    ds_read_b128 v[40:43], v89 offset:0
    ds_read_b128 v[44:47], v89 offset:2048
    ds_read_b128 v[48:51], v91 offset:0
    ds_read_b128 v[52:55], v91 offset:2048
    ds_read_b128 v[56:59], v91 offset:4096
    ds_read_b128 v[60:63], v91 offset:6144
    s_mov_b32 s19, 28
    s_waitcnt lgkmcnt(0)
.p2align 6
adaLN_cond__mha_block__mixer_gmlp__prompt_kernel_o_c_loop:
    v_mfma_f32_16x16x32_bf16 v[8:11], v[48:51], v[40:43], v[8:11]
    ds_read_b128 v[64:67], v89 offset:1024
    ds_read_b128 v[68:71], v89 offset:3072
    v_mfma_f32_16x16x32_bf16 v[24:27], v[48:51], v[44:47], v[24:27]
    ds_read_b128 v[72:75], v91 offset:1024
    ds_read_b128 v[76:79], v91 offset:3072
    v_mfma_f32_16x16x32_bf16 v[12:15], v[52:55], v[40:43], v[12:15]
    ds_read_b128 v[80:83], v91 offset:5120
    ds_read_b128 v[84:87], v91 offset:7168
    v_mfma_f32_16x16x32_bf16 v[28:31], v[52:55], v[44:47], v[28:31]
    s_add_u32 s18, s18, 24576
    s_cmp_ge_u32 s18, 147456
    v_mfma_f32_16x16x32_bf16 v[16:19], v[56:59], v[40:43], v[16:19]
    s_cselect_b32 s18, 0, s18
    v_add_u32 v89, s18, v88
    v_mfma_f32_16x16x32_bf16 v[32:35], v[56:59], v[44:47], v[32:35]
    v_add_u32 v91, s18, v90
    v_mfma_f32_16x16x32_bf16 v[20:23], v[60:63], v[40:43], v[20:23]
    v_mfma_f32_16x16x32_bf16 v[36:39], v[60:63], v[44:47], v[36:39]
    s_waitcnt lgkmcnt(0)
    s_barrier
    v_mfma_f32_16x16x32_bf16 v[8:11], v[72:75], v[64:67], v[8:11]
    ds_read_b128 v[40:43], v89 offset:0
    ds_read_b128 v[44:47], v89 offset:2048
    v_mfma_f32_16x16x32_bf16 v[24:27], v[72:75], v[68:71], v[24:27]
    ds_read_b128 v[48:51], v91 offset:0
    ds_read_b128 v[52:55], v91 offset:2048
    v_mfma_f32_16x16x32_bf16 v[12:15], v[76:79], v[64:67], v[12:15]
    ds_read_b128 v[56:59], v91 offset:4096
    ds_read_b128 v[60:63], v91 offset:6144
    v_mfma_f32_16x16x32_bf16 v[28:31], v[76:79], v[68:71], v[28:31]
    s_sub_u32 s19, s19, 1
    s_cmp_lg_u32 s19, 0
    v_mfma_f32_16x16x32_bf16 v[16:19], v[80:83], v[64:67], v[16:19]
    v_mfma_f32_16x16x32_bf16 v[32:35], v[80:83], v[68:71], v[32:35]
    v_mfma_f32_16x16x32_bf16 v[20:23], v[84:87], v[64:67], v[20:23]
    v_mfma_f32_16x16x32_bf16 v[36:39], v[84:87], v[68:71], v[36:39]
    s_waitcnt lgkmcnt(0)
    s_cbranch_scc1 adaLN_cond__mha_block__mixer_gmlp__prompt_kernel_o_c_loop
    s_nop 7
    ds_read_b64 v[92:93], v125 offset:0
    ds_read_b64 v[94:95], v125 offset:512
    ds_read_b64 v[96:97], v125 offset:1024
    ds_read_b64 v[98:99], v125 offset:1536
    ds_read_b64 v[100:101], v125 offset:4096
    ds_read_b64 v[102:103], v125 offset:4608
    ds_read_b64 v[104:105], v125 offset:5120
    ds_read_b64 v[106:107], v125 offset:5632
    ds_read_b128 v[108:111], v126 offset:0
    ds_read_b128 v[112:115], v126 offset:64
    ds_read_b128 v[116:119], v126 offset:128
    ds_read_b128 v[120:123], v126 offset:192
    s_waitcnt lgkmcnt(0)
    s_barrier
    v_lshlrev_b32 v2, 16, v92
    v_and_b32 v3, 0xffff0000, v92
    v_pk_fma_f32 v[8:9], v[8:9], v[108:109], v[2:3]
    v_lshlrev_b32 v2, 16, v93
    v_and_b32 v3, 0xffff0000, v93
    v_pk_fma_f32 v[10:11], v[10:11], v[110:111], v[2:3]
    v_lshlrev_b32 v2, 16, v94
    v_and_b32 v3, 0xffff0000, v94
    v_pk_fma_f32 v[12:13], v[12:13], v[112:113], v[2:3]
    v_lshlrev_b32 v2, 16, v95
    v_and_b32 v3, 0xffff0000, v95
    v_pk_fma_f32 v[14:15], v[14:15], v[114:115], v[2:3]
    v_lshlrev_b32 v2, 16, v96
    v_and_b32 v3, 0xffff0000, v96
    v_pk_fma_f32 v[16:17], v[16:17], v[116:117], v[2:3]
    v_lshlrev_b32 v2, 16, v97
    v_and_b32 v3, 0xffff0000, v97
    v_pk_fma_f32 v[18:19], v[18:19], v[118:119], v[2:3]
    v_lshlrev_b32 v2, 16, v98
    v_and_b32 v3, 0xffff0000, v98
    v_pk_fma_f32 v[20:21], v[20:21], v[120:121], v[2:3]
    v_lshlrev_b32 v2, 16, v99
    v_and_b32 v3, 0xffff0000, v99
    v_pk_fma_f32 v[22:23], v[22:23], v[122:123], v[2:3]
    v_lshlrev_b32 v2, 16, v100
    v_and_b32 v3, 0xffff0000, v100
    v_pk_fma_f32 v[24:25], v[24:25], v[108:109], v[2:3]
    v_lshlrev_b32 v2, 16, v101
    v_and_b32 v3, 0xffff0000, v101
    v_pk_fma_f32 v[26:27], v[26:27], v[110:111], v[2:3]
    v_lshlrev_b32 v2, 16, v102
    v_and_b32 v3, 0xffff0000, v102
    v_pk_fma_f32 v[28:29], v[28:29], v[112:113], v[2:3]
    v_lshlrev_b32 v2, 16, v103
    v_and_b32 v3, 0xffff0000, v103
    v_pk_fma_f32 v[30:31], v[30:31], v[114:115], v[2:3]
    v_lshlrev_b32 v2, 16, v104
    v_and_b32 v3, 0xffff0000, v104
    v_pk_fma_f32 v[32:33], v[32:33], v[116:117], v[2:3]
    v_lshlrev_b32 v2, 16, v105
    v_and_b32 v3, 0xffff0000, v105
    v_pk_fma_f32 v[34:35], v[34:35], v[118:119], v[2:3]
    v_lshlrev_b32 v2, 16, v106
    v_and_b32 v3, 0xffff0000, v106
    v_pk_fma_f32 v[36:37], v[36:37], v[120:121], v[2:3]
    v_lshlrev_b32 v2, 16, v107
    v_and_b32 v3, 0xffff0000, v107
    v_pk_fma_f32 v[38:39], v[38:39], v[122:123], v[2:3]
    v_cvt_pk_bf16_f32 v40, v8, v9
    v_cvt_pk_bf16_f32 v41, v10, v11
    v_cvt_pk_bf16_f32 v42, v12, v13
    v_cvt_pk_bf16_f32 v43, v14, v15
    v_cvt_pk_bf16_f32 v44, v16, v17
    v_cvt_pk_bf16_f32 v45, v18, v19
    v_cvt_pk_bf16_f32 v46, v20, v21
    v_cvt_pk_bf16_f32 v47, v22, v23
    v_permlane16_swap_b32 v40, v42
    v_permlane16_swap_b32 v41, v43
    buffer_store_dwordx4 v[40:43], v124, s[24:27], s62 offen offset:0
    v_cvt_pk_bf16_f32 v48, v24, v25
    v_cvt_pk_bf16_f32 v49, v26, v27
    v_cvt_pk_bf16_f32 v50, v28, v29
    v_cvt_pk_bf16_f32 v51, v30, v31
    v_permlane16_swap_b32 v44, v46
    v_permlane16_swap_b32 v45, v47
    buffer_store_dwordx4 v[44:47], v124, s[24:27], s62 offen offset:64
    v_cvt_pk_bf16_f32 v52, v32, v33
    v_cvt_pk_bf16_f32 v53, v34, v35
    v_cvt_pk_bf16_f32 v54, v36, v37
    v_cvt_pk_bf16_f32 v55, v38, v39
    v_permlane16_swap_b32 v48, v50
    v_permlane16_swap_b32 v49, v51
    buffer_store_dwordx4 v[48:51], v124, s[24:27], s63 offen offset:0
    s_nop 1
    v_permlane16_swap_b32 v52, v54
    v_permlane16_swap_b32 v53, v55
    buffer_store_dwordx4 v[52:55], v124, s[24:27], s63 offen offset:64
    s_endpgm
code_end:
.section .rodata,"a"
.p2align 6
.amdhsa_kernel adaLN_cond__mha_block__mixer_gmlp__prompt_kernel
  .amdhsa_next_free_vgpr 256
  .amdhsa_next_free_sgpr 102
  .amdhsa_accum_offset 256
  .amdhsa_group_segment_fixed_size 0
  .amdhsa_kernarg_size 104
  .amdhsa_user_sgpr_count 2
  .amdhsa_user_sgpr_kernarg_segment_ptr 1
  .amdhsa_system_sgpr_workgroup_id_x 1
.end_amdhsa_kernel
```
